```python
import torch

def _softmax(x, axis=-1):
    return torch.softmax(x, dim=axis)
def _gelu(x):
    return torch.nn.functional.gelu(x, approximate="tanh")
def _silu(x):
    return torch.nn.functional.silu(x)
def _sigmoid(x):
    return torch.sigmoid(x)
def _layernorm(x, axis=-1, eps=1e-5):
    m = x.mean(dim=axis, keepdim=True)
    v = x.var(dim=axis, keepdim=True, unbiased=False)
    return (x - m) / torch.sqrt(v + eps)
def _scatter_add(tgt, idx, src, axis=0):
    return tgt.clone().index_add_(axis, idx, src)
def _segment_sum(src, seg, n):
    out = torch.zeros((n,) + src.shape[1:], dtype=src.dtype)
    return out.index_add_(0, seg, src)
def _pad(x, pw):
    flat = tuple(v for pair in reversed(pw) for v in pair)
    return torch.nn.functional.pad(x, flat)

kernel_name = 'gated_mix__linear_kernel_hedgehog__compressed_kv_cla__prompt'

def setup_inputs():

    _w = (lambda a: (lambda t: t.to(torch.bfloat16) if t.is_floating_point() else t)(torch.as_tensor(a)))
    def _A_setup():
        B, S, D, H = 1, 2048, 512, 32
        Dh = D // H
        return {
            "x": _w((lambda *s: torch.randn(*s, dtype=torch.bfloat16) * 0.05)(B, S, D)),
            "wqkv": _w((lambda *s: torch.randn(*s, dtype=torch.bfloat16) * 1.6)(D, 3 * D)),
            "w_phi": _w((lambda *s: torch.randn(*s, dtype=torch.bfloat16) * 1.6)(H, Dh, Dh) * (Dh ** -0.5)),
            "wo": _w((lambda *s: torch.randn(*s, dtype=torch.bfloat16) * 0.05)(D, D)),
        }
    _A_in = _A_setup()

    def _B_setup():
        B, H, Sq, Sk, D, M = 1, 32, 2048, 2048, 128, 512
        Dc = 4 * D
        return {
            "x": _w((lambda *s: torch.randn(*s, dtype=torch.bfloat16) * 0.05)(B, Sq, M)),
            "c_kv": _w((lambda *s: torch.randn(*s, dtype=torch.bfloat16) * 0.8)(B, Sk, Dc)),
            "w_q": _w((lambda *s: torch.randn(*s, dtype=torch.bfloat16) * 6.4)(M, H, D) * (M ** -0.5)),
            "w_uk": _w((lambda *s: torch.randn(*s, dtype=torch.bfloat16) * 6.4)(Dc, H, D) * (Dc ** -0.5)),
            "w_uv": _w((lambda *s: torch.randn(*s, dtype=torch.bfloat16) * 0.8)(Dc, H, D) * (Dc ** -0.5)),
            "w_o": _w((lambda *s: torch.randn(*s, dtype=torch.bfloat16) * 0.8)(H, D, M) * ((H * D) ** -0.5)),
        }
    _B_in = _B_setup()

    return {
        "A_x": _A_in["x"],
        "A_wqkv": _A_in["wqkv"],
        "A_w_phi": _A_in["w_phi"],
        "A_wo": _A_in["wo"],
        "B_x": _B_in["x"],
        "B_c_kv": _B_in["c_kv"],
        "B_w_q": _B_in["w_q"],
        "B_w_uk": _B_in["w_uk"],
        "B_w_uv": _B_in["w_uv"],
        "B_w_o": _B_in["w_o"],
        "gate_w": _w((lambda *s: torch.randn(*s, dtype=torch.bfloat16) * 0.05)(512) * 16.0),
    }

def reference(A_x, A_wqkv, A_w_phi, A_wo, B_x, B_c_kv, B_w_q, B_w_uk, B_w_uv, B_w_o, gate_w):
    def _A_ref(x, wqkv, w_phi, wo):
        B, S, D = x.shape
        H = 32; Dh = D // H
        qkv = (lambda x, *d: x.permute(*d))((x @ wqkv).reshape(B, S, 3, H, Dh), 2, 0, 3, 1, 4)
        q, k, v = qkv[0], qkv[1], qkv[2]
        pq = torch.einsum("bhsd,hdf->bhsf", q, w_phi)
        pk = torch.einsum("bhsd,hdf->bhsf", k, w_phi)
        phi_q = torch.concatenate([_softmax(pq, axis=-1), _softmax(-pq, axis=-1)], axis=-1)
        phi_k = torch.concatenate([_softmax(pk, axis=-1), _softmax(-pk, axis=-1)], axis=-1)
        kv = torch.einsum("bhsf,bhsd->bhfd", phi_k, v)
        z  = torch.einsum("bhsf->bhf", phi_k)
        num = torch.einsum("bhqf,bhfd->bhqd", phi_q, kv)
        den = torch.einsum("bhqf,bhf->bhq", phi_q, z)[..., None] + 1e-6
        o = num / den
        return (lambda x, *d: x.permute(*d))(o, 0, 2, 1, 3).reshape(B, S, D) @ wo

    def _B_ref(x, c_kv, w_q, w_uk, w_uv, w_o):
        B, Sq, M = x.shape[0], x.shape[1], x.shape[2]
        Sk = c_kv.shape[1]
        H, D = w_q.shape[1], w_q.shape[2]
        q = torch.einsum("bqm,mhd->bhqd", x, w_q)
        k = torch.einsum("bkc,chd->bhkd", c_kv, w_uk)
        v = torch.einsum("bkc,chd->bhkd", c_kv, w_uv)
        scores = torch.einsum("bhqd,bhkd->bhqk", q, k) * (D ** -0.5)
        off = Sk - Sq
        qi = torch.arange(Sq)[:, None]
        kj = torch.arange(Sk)[None, :]
        cmask = kj <= (qi + off)
        scores = torch.where(cmask[None, None], scores, -1e9)
        p = _softmax(scores, axis=-1)
        ctx = torch.einsum("bhqk,bhkd->bhqd", p, v)
        return torch.einsum("bhqd,hdm->bqm", ctx, w_o)

    x = A_x
    g = _sigmoid((x * gate_w).sum(-1, keepdims=True))
    a = _A_ref(x, A_wqkv, A_w_phi, A_wo)
    b = _B_ref(x, B_c_kv, B_w_q, B_w_uk, B_w_uv, B_w_o)
    return g * a + (1 - g) * b
```

```asm
; @launch kernel=f_kernel grid=(256,1,1) block=(512,1,1) lds=158720
; @launch kernel=k3_kernel grid=(256,1,1) block=(512,1,1) lds=131072
.amdgcn_target "amdgcn-amd-amdhsa--gfx950"
.text
.globl f_kernel
.p2align 8
.type f_kernel,@function
f_kernel:
    s_cmp_ge_u32 s2, 256
    s_cbranch_scc1 f_end
    s_load_dwordx2 s[8:9], s[0:1], 40
    s_load_dwordx2 s[16:17], s[0:1], 56
    s_load_dwordx2 s[54:55], s[0:1], 64
    s_load_dwordx2 s[28:29], s[0:1], 104
    s_load_dwordx2 s[4:5], s[0:1], 96
    s_load_dwordx2 s[12:13], s[0:1], 0
    s_load_dwordx2 s[20:21], s[0:1], 48
    s_load_dwordx2 s[24:25], s[0:1], 8
    s_load_dwordx2 s[56:57], s[0:1], 72
    s_load_dwordx2 s[58:59], s[0:1], 24
    s_load_dwordx2 s[60:61], s[0:1], 80
    s_load_dwordx2 s[62:63], s[0:1], 16
    v_lshrrev_b32 v1, 6, v0
    v_mov_b32 v203, v0
    v_and_b32 v200, 63, v0
    v_readfirstlane_b32 s36, v1
    s_and_b32 s48, s2, 7
    s_lshr_b32 s49, s2, 3
    s_lshr_b32 s50, s49, 3
    s_lshl_b32 s37, s48, 2
    s_add_u32 s37, s37, s50
    s_and_b32 s38, s49, 7
    s_lshl_b32 s44, s36, 12
    s_lshl_b32 s45, s36, 11
    s_lshl_b32 s46, s36, 10
    s_sub_u32 s48, 15, s38
    s_cmp_lt_u32 s36, 4
    s_cselect_b32 s39, s48, s38
    s_lshl_b32 s47, s39, 2
    s_and_b32 s48, s36, 3
    s_add_u32 s47, s47, s48
    s_lshl_b32 s3, s47, 15
    v_lshrrev_b32 v128, 3, v200
    v_and_b32 v129, 7, v200
    v_lshrrev_b32 v130, 4, v200
    v_xor_b32 v131, v129, v130
    v_lshlrev_b32 v131, 4, v131
    v_lshl_add_u32 v196, v128, 10, v131
    v_xor_b32 v197, 64, v196
    v_and_b32 v130, 1, v130
    v_lshlrev_b32 v130, 2, v130
    v_xor_b32 v129, v129, v130
    v_lshlrev_b32 v131, 4, v129
    v_lshl_add_u32 v198, v128, 13, v131
    v_mul_u32_u24 v199, 3072, v128
    v_lshrrev_b32 v130, 1, v129
    v_lshl_add_u32 v199, v130, 10, v199
    v_and_b32 v130, 1, v129
    v_lshl_add_u32 v199, v130, 4, v199
    v_mov_b32 v131, 0x40000000
    v_cmp_lt_u32 vcc, 5, v129
    v_lshlrev_b32 v201, 4, v200
    v_lshrrev_b32 v213, 5, v200
    v_cndmask_b32 v199, v199, v131, vcc
    v_and_b32 v214, 31, v200
    s_lshl_b32 s40, s38, 18
    s_lshl_b32 s48, s36, 15
    s_add_u32 s40, s40, s48
    s_and_b32 s48, s36, 1
    s_lshl_b32 s41, s48, 18
    s_lshl_b32 s49, s37, 8
    s_add_u32 s41, s41, s49
    s_bfe_u32 s48, s36, 0x10001
    s_lshl_b32 s48, s48, 7
    s_add_u32 s41, s41, s48
    s_and_b32 s48, s36, 3
    s_lshl_b32 s42, s48, 17
    s_add_u32 s42, s42, s49
    s_lshr_b32 s48, s36, 2
    s_lshl_b32 s48, s48, 7
    s_add_u32 s42, s42, s48
    s_mul_i32 s43, s36, 24576
    s_lshl_b32 s48, s37, 5
    s_add_u32 s43, s43, s48
    s_waitcnt lgkmcnt(0)
    s_and_b32 s9, s9, 0xffff
    s_mov_b32 s10, 2097152
    s_mov_b32 s11, 0x00020000
    s_cmp_lt_u32 s36, 4
    s_cselect_b32 s16, s16, s54
    s_cselect_b32 s17, s17, s55
    s_and_b32 s17, s17, 0xffff
    s_mov_b32 s18, 4194304
    s_mov_b32 s19, 0x00020000
    s_add_u32 m0, s44, 0
    s_add_u32 s48, s40, 0
    buffer_load_dwordx4 v196, s[8:11], s48 offen lds
    s_add_u32 m0, s44, 1024
    s_add_u32 s48, s40, 8192
    buffer_load_dwordx4 v197, s[8:11], s48 offen lds
    s_add_u32 m0, s44, 2048
    s_add_u32 s48, s40, 16384
    buffer_load_dwordx4 v196, s[8:11], s48 offen lds
    s_add_u32 m0, s44, 3072
    s_add_u32 s48, s40, 24576
    buffer_load_dwordx4 v197, s[8:11], s48 offen lds
    s_add_u32 m0, s44, 32768
    s_add_u32 s48, s41, 0
    buffer_load_dwordx4 v198, s[16:19], s48 offen lds
    s_add_u32 m0, s44, 33792
    s_add_u32 s48, s41, 65536
    buffer_load_dwordx4 v198, s[16:19], s48 offen lds
    s_add_u32 m0, s44, 34816
    s_add_u32 s48, s41, 131072
    buffer_load_dwordx4 v198, s[16:19], s48 offen lds
    s_add_u32 m0, s44, 35840
    s_add_u32 s48, s41, 196608
    buffer_load_dwordx4 v198, s[16:19], s48 offen lds
    s_and_b32 s13, s13, 0xffff
    s_mov_b32 s14, 2097152
    s_mov_b32 s15, 0x00020000
    s_and_b32 s21, s21, 0xffff
    s_mov_b32 s22, 4194304
    s_mov_b32 s23, 0x00020000
    s_and_b32 s25, s25, 0xffff
    s_mov_b32 s26, 1572864
    s_mov_b32 s27, 0x00020000
    s_and_b32 s29, s29, 0xffff
    s_mov_b32 s30, 268435456
    s_mov_b32 s31, 0x00020000
    s_and_b32 s5, s5, 0xffff
    s_mov_b32 s6, 256
    s_mov_b32 s7, 0x00020000
    s_mov_b32 s32, s60
    s_mov_b32 s33, s61
    s_and_b32 s33, s33, 0xffff
    s_mov_b32 s34, 1024
    s_mov_b32 s35, 0x00020000
    s_mov_b32 m0, 131072
    s_nop 0
    buffer_load_dwordx4 v201, s[32:35], 0 offen lds
    s_mov_b32 s32, s62
    s_mov_b32 s33, s63
    s_and_b32 s33, s33, 0xffff
    s_mov_b32 s34, 16384
    s_mov_b32 s35, 0x00020000
    s_lshl_b32 s51, s37, 9
    s_mov_b32 m0, 156672
    s_nop 0
    buffer_load_dwordx4 v201, s[32:35], s51 offen lds
    s_add_u32 m0, s44, 65536
    s_add_u32 s48, s40, 128
    buffer_load_dwordx4 v196, s[8:11], s48 offen lds
    s_add_u32 m0, s44, 66560
    s_add_u32 s48, s40, 8320
    buffer_load_dwordx4 v197, s[8:11], s48 offen lds
    s_add_u32 m0, s44, 67584
    s_add_u32 s48, s40, 16512
    buffer_load_dwordx4 v196, s[8:11], s48 offen lds
    s_add_u32 m0, s44, 68608
    s_add_u32 s48, s40, 24704
    buffer_load_dwordx4 v197, s[8:11], s48 offen lds
    s_add_u32 m0, s44, 98304
    s_add_u32 s48, s41, 524288
    buffer_load_dwordx4 v198, s[16:19], s48 offen lds
    s_add_u32 m0, s44, 99328
    s_add_u32 s48, s41, 589824
    buffer_load_dwordx4 v198, s[16:19], s48 offen lds
    s_add_u32 m0, s44, 100352
    s_add_u32 s48, s41, 655360
    buffer_load_dwordx4 v198, s[16:19], s48 offen lds
    s_add_u32 m0, s44, 101376
    s_add_u32 s48, s41, 720896
    buffer_load_dwordx4 v198, s[16:19], s48 offen lds
    s_lshr_b32 s64, s2, 3
    s_lshl_b32 s65, s64, 16
    s_lshl_b32 s66, s36, 7
    s_add_u32 s95, s65, s66
    v_lshlrev_b32 v250, 10, v200
    s_and_b32 s65, s36, 3
    s_lshl_b32 s66, s64, 2
    s_add_u32 s65, s65, s66
    s_lshl_b32 s65, s65, 15
    s_and_b32 s66, s2, 7
    s_lshl_b32 s66, s66, 10
    s_add_u32 s96, s65, s66
    v_lshrrev_b32 v128, 3, v200
    v_and_b32 v129, 7, v200
    v_lshlrev_b32 v251, 13, v128
    v_lshl_add_u32 v251, v129, 7, v251
    v_mov_b32 v130, 0x40000000
    v_cmp_lt_u32 s[68:69], 15, v200
    v_cmp_lt_u32 vcc, 31, v200
    s_nop 0
    v_cndmask_b32 v215, v251, v130, s[68:69]
    v_cndmask_b32 v251, v251, v130, vcc
    s_lshl_b32 s65, s64, 3
    s_add_u32 s65, s65, s36
    s_lshl_b32 s97, s65, 14
    s_add_u32 s97, s97, s66
    v_lshrrev_b32 v128, 2, v200
    v_mul_u32_u24 v128, 3072, v128
    v_and_b32 v129, 3, v200
    v_lshl_add_u32 v216, v129, 10, v128
    v_cmp_eq_u32 s[68:69], 3, v129
    v_cmp_lt_u32 vcc, 7, v200
    s_mul_i32 s98, s65, 6144
    s_lshr_b32 s66, s66, 3
    s_add_u32 s98, s98, s66
    v_cndmask_b32 v216, v216, v130, s[68:69]
    v_cndmask_b32 v216, v216, v130, vcc
    s_lshr_b32 s99, s2, 5
    v_lshrrev_b32 v128, 1, v214
    v_and_b32 v128, 7, v128
    v_xor_b32 v128, v128, v213
    v_lshlrev_b32 v128, 4, v128
    v_lshl_add_u32 v134, v214, 7, v128
    v_bfe_u32 v129, v200, 2, 2
    v_lshl_add_u32 v130, v213, 3, v129
    v_lshlrev_b32 v130, 7, v130
    v_bfe_u32 v131, v200, 4, 1
    v_lshlrev_b32 v131, 5, v131
    v_and_b32 v132, 3, v200
    v_lshl_add_u32 v131, v132, 3, v131
    v_lshrrev_b32 v132, 1, v129
    v_lshlrev_b32 v132, 6, v132
    v_xor_b32 v131, v131, v132
    v_add_u32 v135, v130, v131
    s_bfe_u32 s52, s36, 0x10001
    s_lshl_b32 s52, s52, 14
    s_lshr_b32 s49, s36, 2
    s_lshl_b32 s49, s49, 1
    s_and_b32 s50, s36, 1
    s_add_u32 s49, s49, s50
    s_lshl_b32 s49, s49, 13
    s_add_u32 s53, s49, 32768
    v_xor_b32 v184, 0, v134
    v_add_u32 v184, s52, v184
    v_xor_b32 v185, 32, v134
    v_add_u32 v185, s52, v185
    v_xor_b32 v186, 64, v134
    v_add_u32 v186, s52, v186
    v_xor_b32 v187, 96, v134
    v_add_u32 v187, s52, v187
    v_xor_b32 v192, 0, v135
    v_add_u32 v192, s53, v192
    v_xor_b32 v193, 64, v135
    v_add_u32 v193, s53, v193
    v_xor_b32 v188, 0, v134
    v_add_u32 v188, s52, v188
    v_add_u32 v188, 0x10000, v188
    v_xor_b32 v189, 32, v134
    v_add_u32 v189, s52, v189
    v_add_u32 v189, 0x10000, v189
    v_xor_b32 v190, 64, v134
    v_add_u32 v190, s52, v190
    v_add_u32 v190, 0x10000, v190
    v_xor_b32 v191, 96, v134
    v_add_u32 v191, s52, v191
    v_add_u32 v191, 0x10000, v191
    v_xor_b32 v194, 0, v135
    v_add_u32 v194, s53, v194
    v_add_u32 v194, 0x10000, v194
    v_xor_b32 v195, 64, v135
    v_add_u32 v195, s53, v195
    v_add_u32 v195, 0x10000, v195
    v_lshlrev_b32 v202, 4, v213
    v_add_u32 v202, 131072, v202
    v_and_b32 v128, 17, v200
    v_cmp_eq_u32 s[64:65], 16, v128
    v_cmp_eq_u32 s[66:67], 1, v128
    v_mov_b32 v129, 157696
    s_or_b64 s[64:65], s[64:65], s[66:67]
    v_cndmask_b32 v202, v202, v129, s[64:65]
    v_mov_b32 v136, 0
    v_mov_b32 v137, 0
    v_mov_b32 v138, 0
    v_mov_b32 v139, 0
    v_add_u32 v129, 157696, v201
    ds_write_b128 v129, v[136:139]
    s_waitcnt lgkmcnt(0)
    s_lshl_b32 s48, s37, 20
    s_lshl_b32 s49, s38, 17
    s_add_u32 s48, s48, s49
    s_bfe_u32 s49, s36, 0x10001
    s_lshl_b32 s49, s49, 16
    s_add_u32 s48, s48, s49
    s_and_b32 s49, s36, 1
    s_cmp_lt_u32 s36, 4
    s_cselect_b32 s50, 12, 11
    s_lshl_b32 s49, s49, s50
    s_add_u32 s48, s48, s49
    s_cselect_b32 s49, 0, 16384
    s_cmp_lt_u32 s36, 4
    s_cselect_b32 s49, 0, 16384
    s_add_u32 s72, s48, s49
    s_cmp_lt_u32 s36, 4
    s_cselect_b32 s49, 1, 4
    s_cselect_b32 s50, 2, 1
    s_lshl_b32 s49, s49, 10
    s_lshl_b32 s50, s50, 10
    s_add_u32 s73, s72, s49
    s_add_u32 s74, s72, s50
    s_add_u32 s75, s74, s49
    s_waitcnt vmcnt(8)
    s_barrier
    ds_read_b64_tr_b16 v[144:145], v192 offset:0
    ds_read_b64_tr_b16 v[146:147], v192 offset:512
    ds_read_b128 v[128:131], v184 offset:0
    ds_read_b64_tr_b16 v[148:149], v193 offset:0
    ds_read_b64_tr_b16 v[150:151], v193 offset:512
    ds_read_b128 v[132:135], v184 offset:4096
    ds_read_b128 v[136:139], v184 offset:8192
    ds_read_b128 v[140:143], v184 offset:12288
    s_cmp_lt_u32 s36, 4
    s_cbranch_scc0 f_vwave
    s_waitcnt lgkmcnt(5)
    v_mfma_f32_32x32x16_bf16 v[0:15], v[144:147], v[128:131], 0
    ds_read_b64_tr_b16 v[172:173], v192 offset:2048
    ds_read_b64_tr_b16 v[174:175], v192 offset:2560
    s_cmp_eq_u32 s36, 2
    s_cselect_b32 s68, s95, 0x40000000
    buffer_load_dword v254, v250, s[8:11], s68 offen
    s_waitcnt lgkmcnt(5)
    v_mfma_f32_32x32x16_bf16 v[16:31], v[148:151], v[128:131], 0
    ds_read_b128 v[156:159], v185 offset:0
    ds_read_b64_tr_b16 v[176:177], v193 offset:2048
    s_cmp_eq_u32 s99, 2
    s_cselect_b32 s68, s96, 0x40000000
    buffer_load_dword v254, v251, s[16:19], s68 offen
    s_waitcnt lgkmcnt(6)
    v_mfma_f32_32x32x16_bf16 v[32:47], v[144:147], v[132:135], 0
    ds_read_b64_tr_b16 v[178:179], v193 offset:2560
    ds_read_b128 v[160:163], v185 offset:4096
    s_cmp_eq_u32 s36, 3
    s_cselect_b32 s68, s95, 0x40000000
    buffer_load_dword v254, v250, s[8:11], s68 offen
    v_mfma_f32_32x32x16_bf16 v[48:63], v[148:151], v[132:135], 0
    ds_read_b128 v[164:167], v185 offset:8192
    ds_read_b128 v[168:171], v185 offset:12288
    s_cmp_eq_u32 s99, 3
    s_cselect_b32 s68, s96, 0x40000000
    buffer_load_dword v254, v251, s[16:19], s68 offen
    s_waitcnt lgkmcnt(9)
    v_mfma_f32_32x32x16_bf16 v[64:79], v[144:147], v[136:139], 0
    v_mfma_f32_32x32x16_bf16 v[80:95], v[148:151], v[136:139], 0
    s_waitcnt lgkmcnt(8)
    v_mfma_f32_32x32x16_bf16 v[96:111], v[144:147], v[140:143], 0
    v_mfma_f32_32x32x16_bf16 v[112:127], v[148:151], v[140:143], 0
    s_waitcnt lgkmcnt(5)
    v_mfma_f32_32x32x16_bf16 v[0:15], v[172:175], v[156:159], v[0:15]
    ds_read_b64_tr_b16 v[144:145], v192 offset:4096
    ds_read_b64_tr_b16 v[146:147], v192 offset:4608
    s_waitcnt lgkmcnt(5)
    v_mfma_f32_32x32x16_bf16 v[16:31], v[176:179], v[156:159], v[16:31]
    ds_read_b128 v[128:131], v186 offset:0
    ds_read_b64_tr_b16 v[148:149], v193 offset:4096
    s_waitcnt lgkmcnt(6)
    v_mfma_f32_32x32x16_bf16 v[32:47], v[172:175], v[160:163], v[32:47]
    ds_read_b64_tr_b16 v[150:151], v193 offset:4608
    ds_read_b128 v[132:135], v186 offset:4096
    v_mfma_f32_32x32x16_bf16 v[48:63], v[176:179], v[160:163], v[48:63]
    ds_read_b128 v[136:139], v186 offset:8192
    ds_read_b128 v[140:143], v186 offset:12288
    s_waitcnt lgkmcnt(9)
    v_mfma_f32_32x32x16_bf16 v[64:79], v[172:175], v[164:167], v[64:79]
    v_mfma_f32_32x32x16_bf16 v[80:95], v[176:179], v[164:167], v[80:95]
    s_waitcnt lgkmcnt(8)
    v_mfma_f32_32x32x16_bf16 v[96:111], v[172:175], v[168:171], v[96:111]
    v_mfma_f32_32x32x16_bf16 v[112:127], v[176:179], v[168:171], v[112:127]
    s_waitcnt lgkmcnt(5)
    v_mfma_f32_32x32x16_bf16 v[0:15], v[144:147], v[128:131], v[0:15]
    ds_read_b64_tr_b16 v[172:173], v192 offset:6144
    ds_read_b64_tr_b16 v[174:175], v192 offset:6656
    s_waitcnt lgkmcnt(5)
    v_mfma_f32_32x32x16_bf16 v[16:31], v[148:151], v[128:131], v[16:31]
    ds_read_b128 v[156:159], v187 offset:0
    ds_read_b64_tr_b16 v[176:177], v193 offset:6144
    s_waitcnt lgkmcnt(6)
    v_mfma_f32_32x32x16_bf16 v[32:47], v[144:147], v[132:135], v[32:47]
    ds_read_b64_tr_b16 v[178:179], v193 offset:6656
    ds_read_b128 v[160:163], v187 offset:4096
    v_mfma_f32_32x32x16_bf16 v[48:63], v[148:151], v[132:135], v[48:63]
    ds_read_b128 v[164:167], v187 offset:8192
    ds_read_b128 v[168:171], v187 offset:12288
    s_waitcnt lgkmcnt(9)
    v_mfma_f32_32x32x16_bf16 v[64:79], v[144:147], v[136:139], v[64:79]
    v_mfma_f32_32x32x16_bf16 v[80:95], v[148:151], v[136:139], v[80:95]
    s_waitcnt lgkmcnt(8)
    v_mfma_f32_32x32x16_bf16 v[96:111], v[144:147], v[140:143], v[96:111]
    v_mfma_f32_32x32x16_bf16 v[112:127], v[148:151], v[140:143], v[112:127]
    s_waitcnt lgkmcnt(0)
    s_waitcnt vmcnt(4)
    s_barrier
    v_mfma_f32_32x32x16_bf16 v[0:15], v[172:175], v[156:159], v[0:15]
    ds_read_b64_tr_b16 v[144:145], v194 offset:0
    ds_read_b64_tr_b16 v[146:147], v194 offset:512
    s_add_u32 m0, s44, 0
    s_add_u32 s48, s40, 256
    buffer_load_dwordx4 v196, s[8:11], s48 offen lds
    v_mfma_f32_32x32x16_bf16 v[16:31], v[176:179], v[156:159], v[16:31]
    ds_read_b128 v[128:131], v188 offset:0
    ds_read_b64_tr_b16 v[148:149], v195 offset:0
    s_add_u32 m0, s44, 1024
    s_add_u32 s48, s40, 8448
    buffer_load_dwordx4 v197, s[8:11], s48 offen lds
    v_mfma_f32_32x32x16_bf16 v[32:47], v[172:175], v[160:163], v[32:47]
    ds_read_b64_tr_b16 v[150:151], v195 offset:512
    ds_read_b128 v[132:135], v188 offset:4096
    s_add_u32 m0, s44, 2048
    s_add_u32 s48, s40, 16640
    buffer_load_dwordx4 v196, s[8:11], s48 offen lds
    v_mfma_f32_32x32x16_bf16 v[48:63], v[176:179], v[160:163], v[48:63]
    ds_read_b128 v[136:139], v188 offset:8192
    ds_read_b128 v[140:143], v188 offset:12288
    s_add_u32 m0, s44, 3072
    s_add_u32 s48, s40, 24832
    buffer_load_dwordx4 v197, s[8:11], s48 offen lds
    v_mfma_f32_32x32x16_bf16 v[64:79], v[172:175], v[164:167], v[64:79]
    s_add_u32 m0, s44, 32768
    s_add_u32 s48, s41, 1048576
    buffer_load_dwordx4 v198, s[16:19], s48 offen lds
    v_mfma_f32_32x32x16_bf16 v[80:95], v[176:179], v[164:167], v[80:95]
    s_add_u32 m0, s44, 33792
    s_add_u32 s48, s41, 1114112
    buffer_load_dwordx4 v198, s[16:19], s48 offen lds
    v_mfma_f32_32x32x16_bf16 v[96:111], v[172:175], v[168:171], v[96:111]
    s_add_u32 m0, s44, 34816
    s_add_u32 s48, s41, 1179648
    buffer_load_dwordx4 v198, s[16:19], s48 offen lds
    v_mfma_f32_32x32x16_bf16 v[112:127], v[176:179], v[168:171], v[112:127]
    s_add_u32 m0, s44, 35840
    s_add_u32 s48, s41, 1245184
    buffer_load_dwordx4 v198, s[16:19], s48 offen lds
    s_waitcnt lgkmcnt(5)
    v_mfma_f32_32x32x16_bf16 v[0:15], v[144:147], v[128:131], v[0:15]
    ds_read_b64_tr_b16 v[172:173], v194 offset:2048
    ds_read_b64_tr_b16 v[174:175], v194 offset:2560
    s_cmp_eq_u32 s36, 4
    s_cselect_b32 s68, s95, 0x40000000
    buffer_load_dword v254, v250, s[8:11], s68 offen
    s_waitcnt lgkmcnt(5)
    v_mfma_f32_32x32x16_bf16 v[16:31], v[148:151], v[128:131], v[16:31]
    ds_read_b128 v[156:159], v189 offset:0
    ds_read_b64_tr_b16 v[176:177], v195 offset:2048
    s_cmp_eq_u32 s99, 4
    s_cselect_b32 s68, s96, 0x40000000
    buffer_load_dword v254, v251, s[16:19], s68 offen
    s_waitcnt lgkmcnt(6)
    v_mfma_f32_32x32x16_bf16 v[32:47], v[144:147], v[132:135], v[32:47]
    ds_read_b64_tr_b16 v[178:179], v195 offset:2560
    ds_read_b128 v[160:163], v189 offset:4096
    v_mfma_f32_32x32x16_bf16 v[48:63], v[148:151], v[132:135], v[48:63]
    ds_read_b128 v[164:167], v189 offset:8192
    ds_read_b128 v[168:171], v189 offset:12288
    s_waitcnt lgkmcnt(9)
    v_mfma_f32_32x32x16_bf16 v[64:79], v[144:147], v[136:139], v[64:79]
    v_mfma_f32_32x32x16_bf16 v[80:95], v[148:151], v[136:139], v[80:95]
    s_waitcnt lgkmcnt(8)
    v_mfma_f32_32x32x16_bf16 v[96:111], v[144:147], v[140:143], v[96:111]
    v_mfma_f32_32x32x16_bf16 v[112:127], v[148:151], v[140:143], v[112:127]
    s_waitcnt lgkmcnt(5)
    v_mfma_f32_32x32x16_bf16 v[0:15], v[172:175], v[156:159], v[0:15]
    ds_read_b64_tr_b16 v[144:145], v194 offset:4096
    ds_read_b64_tr_b16 v[146:147], v194 offset:4608
    s_waitcnt lgkmcnt(5)
    v_mfma_f32_32x32x16_bf16 v[16:31], v[176:179], v[156:159], v[16:31]
    ds_read_b128 v[128:131], v190 offset:0
    ds_read_b64_tr_b16 v[148:149], v195 offset:4096
    s_waitcnt lgkmcnt(6)
    v_mfma_f32_32x32x16_bf16 v[32:47], v[172:175], v[160:163], v[32:47]
    ds_read_b64_tr_b16 v[150:151], v195 offset:4608
    ds_read_b128 v[132:135], v190 offset:4096
    v_mfma_f32_32x32x16_bf16 v[48:63], v[176:179], v[160:163], v[48:63]
    ds_read_b128 v[136:139], v190 offset:8192
    ds_read_b128 v[140:143], v190 offset:12288
    s_waitcnt lgkmcnt(9)
    v_mfma_f32_32x32x16_bf16 v[64:79], v[172:175], v[164:167], v[64:79]
    v_mfma_f32_32x32x16_bf16 v[80:95], v[176:179], v[164:167], v[80:95]
    s_waitcnt lgkmcnt(8)
    v_mfma_f32_32x32x16_bf16 v[96:111], v[172:175], v[168:171], v[96:111]
    v_mfma_f32_32x32x16_bf16 v[112:127], v[176:179], v[168:171], v[112:127]
    s_waitcnt lgkmcnt(5)
    v_mfma_f32_32x32x16_bf16 v[0:15], v[144:147], v[128:131], v[0:15]
    ds_read_b64_tr_b16 v[172:173], v194 offset:6144
    ds_read_b64_tr_b16 v[174:175], v194 offset:6656
    s_waitcnt lgkmcnt(5)
    v_mfma_f32_32x32x16_bf16 v[16:31], v[148:151], v[128:131], v[16:31]
    ds_read_b128 v[156:159], v191 offset:0
    ds_read_b64_tr_b16 v[176:177], v195 offset:6144
    s_waitcnt lgkmcnt(6)
    v_mfma_f32_32x32x16_bf16 v[32:47], v[144:147], v[132:135], v[32:47]
    ds_read_b64_tr_b16 v[178:179], v195 offset:6656
    ds_read_b128 v[160:163], v191 offset:4096
    v_mfma_f32_32x32x16_bf16 v[48:63], v[148:151], v[132:135], v[48:63]
    ds_read_b128 v[164:167], v191 offset:8192
    ds_read_b128 v[168:171], v191 offset:12288
    s_waitcnt lgkmcnt(9)
    v_mfma_f32_32x32x16_bf16 v[64:79], v[144:147], v[136:139], v[64:79]
    v_mfma_f32_32x32x16_bf16 v[80:95], v[148:151], v[136:139], v[80:95]
    s_waitcnt lgkmcnt(8)
    v_mfma_f32_32x32x16_bf16 v[96:111], v[144:147], v[140:143], v[96:111]
    v_mfma_f32_32x32x16_bf16 v[112:127], v[148:151], v[140:143], v[112:127]
    s_waitcnt lgkmcnt(0)
    s_waitcnt vmcnt(2)
    s_barrier
    v_mfma_f32_32x32x16_bf16 v[0:15], v[172:175], v[156:159], v[0:15]
    ds_read_b64_tr_b16 v[144:145], v192 offset:0
    ds_read_b64_tr_b16 v[146:147], v192 offset:512
    s_add_u32 m0, s44, 65536
    s_add_u32 s48, s40, 384
    buffer_load_dwordx4 v196, s[8:11], s48 offen lds
    v_mfma_f32_32x32x16_bf16 v[16:31], v[176:179], v[156:159], v[16:31]
    ds_read_b128 v[128:131], v184 offset:0
    ds_read_b64_tr_b16 v[148:149], v193 offset:0
    s_add_u32 m0, s44, 66560
    s_add_u32 s48, s40, 8576
    buffer_load_dwordx4 v197, s[8:11], s48 offen lds
    v_mfma_f32_32x32x16_bf16 v[32:47], v[172:175], v[160:163], v[32:47]
    ds_read_b64_tr_b16 v[150:151], v193 offset:512
    ds_read_b128 v[132:135], v184 offset:4096
    s_add_u32 m0, s44, 67584
    s_add_u32 s48, s40, 16768
    buffer_load_dwordx4 v196, s[8:11], s48 offen lds
    v_mfma_f32_32x32x16_bf16 v[48:63], v[176:179], v[160:163], v[48:63]
    ds_read_b128 v[136:139], v184 offset:8192
    ds_read_b128 v[140:143], v184 offset:12288
    s_add_u32 m0, s44, 68608
    s_add_u32 s48, s40, 24960
    buffer_load_dwordx4 v197, s[8:11], s48 offen lds
    v_mfma_f32_32x32x16_bf16 v[64:79], v[172:175], v[164:167], v[64:79]
    s_add_u32 m0, s44, 98304
    s_add_u32 s48, s41, 1572864
    buffer_load_dwordx4 v198, s[16:19], s48 offen lds
    v_mfma_f32_32x32x16_bf16 v[80:95], v[176:179], v[164:167], v[80:95]
    s_add_u32 m0, s44, 99328
    s_add_u32 s48, s41, 1638400
    buffer_load_dwordx4 v198, s[16:19], s48 offen lds
    v_mfma_f32_32x32x16_bf16 v[96:111], v[172:175], v[168:171], v[96:111]
    s_add_u32 m0, s44, 100352
    s_add_u32 s48, s41, 1703936
    buffer_load_dwordx4 v198, s[16:19], s48 offen lds
    v_mfma_f32_32x32x16_bf16 v[112:127], v[176:179], v[168:171], v[112:127]
    s_add_u32 m0, s44, 101376
    s_add_u32 s48, s41, 1769472
    buffer_load_dwordx4 v198, s[16:19], s48 offen lds
    s_waitcnt lgkmcnt(5)
    v_mfma_f32_32x32x16_bf16 v[0:15], v[144:147], v[128:131], v[0:15]
    ds_read_b64_tr_b16 v[172:173], v192 offset:2048
    ds_read_b64_tr_b16 v[174:175], v192 offset:2560
    s_cmp_eq_u32 s36, 5
    s_cselect_b32 s68, s95, 0x40000000
    buffer_load_dword v254, v250, s[8:11], s68 offen
    s_waitcnt lgkmcnt(5)
    v_mfma_f32_32x32x16_bf16 v[16:31], v[148:151], v[128:131], v[16:31]
    ds_read_b128 v[156:159], v185 offset:0
    ds_read_b64_tr_b16 v[176:177], v193 offset:2048
    s_cmp_eq_u32 s99, 5
    s_cselect_b32 s68, s96, 0x40000000
    buffer_load_dword v254, v251, s[16:19], s68 offen
    s_waitcnt lgkmcnt(6)
    v_mfma_f32_32x32x16_bf16 v[32:47], v[144:147], v[132:135], v[32:47]
    ds_read_b64_tr_b16 v[178:179], v193 offset:2560
    ds_read_b128 v[160:163], v185 offset:4096
    v_mfma_f32_32x32x16_bf16 v[48:63], v[148:151], v[132:135], v[48:63]
    ds_read_b128 v[164:167], v185 offset:8192
    ds_read_b128 v[168:171], v185 offset:12288
    s_waitcnt lgkmcnt(9)
    v_mfma_f32_32x32x16_bf16 v[64:79], v[144:147], v[136:139], v[64:79]
    v_mfma_f32_32x32x16_bf16 v[80:95], v[148:151], v[136:139], v[80:95]
    s_waitcnt lgkmcnt(8)
    v_mfma_f32_32x32x16_bf16 v[96:111], v[144:147], v[140:143], v[96:111]
    v_mfma_f32_32x32x16_bf16 v[112:127], v[148:151], v[140:143], v[112:127]
    s_waitcnt lgkmcnt(5)
    v_mfma_f32_32x32x16_bf16 v[0:15], v[172:175], v[156:159], v[0:15]
    ds_read_b64_tr_b16 v[144:145], v192 offset:4096
    ds_read_b64_tr_b16 v[146:147], v192 offset:4608
    s_waitcnt lgkmcnt(5)
    v_mfma_f32_32x32x16_bf16 v[16:31], v[176:179], v[156:159], v[16:31]
    ds_read_b128 v[128:131], v186 offset:0
    ds_read_b64_tr_b16 v[148:149], v193 offset:4096
    s_waitcnt lgkmcnt(6)
    v_mfma_f32_32x32x16_bf16 v[32:47], v[172:175], v[160:163], v[32:47]
    ds_read_b64_tr_b16 v[150:151], v193 offset:4608
    ds_read_b128 v[132:135], v186 offset:4096
    v_mfma_f32_32x32x16_bf16 v[48:63], v[176:179], v[160:163], v[48:63]
    ds_read_b128 v[136:139], v186 offset:8192
    ds_read_b128 v[140:143], v186 offset:12288
    s_waitcnt lgkmcnt(9)
    v_mfma_f32_32x32x16_bf16 v[64:79], v[172:175], v[164:167], v[64:79]
    v_mfma_f32_32x32x16_bf16 v[80:95], v[176:179], v[164:167], v[80:95]
    s_waitcnt lgkmcnt(8)
    v_mfma_f32_32x32x16_bf16 v[96:111], v[172:175], v[168:171], v[96:111]
    v_mfma_f32_32x32x16_bf16 v[112:127], v[176:179], v[168:171], v[112:127]
    s_waitcnt lgkmcnt(5)
    v_mfma_f32_32x32x16_bf16 v[0:15], v[144:147], v[128:131], v[0:15]
    ds_read_b64_tr_b16 v[172:173], v192 offset:6144
    ds_read_b64_tr_b16 v[174:175], v192 offset:6656
    s_waitcnt lgkmcnt(5)
    v_mfma_f32_32x32x16_bf16 v[16:31], v[148:151], v[128:131], v[16:31]
    ds_read_b128 v[156:159], v187 offset:0
    ds_read_b64_tr_b16 v[176:177], v193 offset:6144
    s_waitcnt lgkmcnt(6)
    v_mfma_f32_32x32x16_bf16 v[32:47], v[144:147], v[132:135], v[32:47]
    ds_read_b64_tr_b16 v[178:179], v193 offset:6656
    ds_read_b128 v[160:163], v187 offset:4096
    v_mfma_f32_32x32x16_bf16 v[48:63], v[148:151], v[132:135], v[48:63]
    ds_read_b128 v[164:167], v187 offset:8192
    ds_read_b128 v[168:171], v187 offset:12288
    s_waitcnt lgkmcnt(9)
    v_mfma_f32_32x32x16_bf16 v[64:79], v[144:147], v[136:139], v[64:79]
    v_mfma_f32_32x32x16_bf16 v[80:95], v[148:151], v[136:139], v[80:95]
    s_waitcnt lgkmcnt(8)
    v_mfma_f32_32x32x16_bf16 v[96:111], v[144:147], v[140:143], v[96:111]
    v_mfma_f32_32x32x16_bf16 v[112:127], v[148:151], v[140:143], v[112:127]
    s_waitcnt lgkmcnt(0)
    s_waitcnt vmcnt(2)
    s_barrier
    v_mfma_f32_32x32x16_bf16 v[0:15], v[172:175], v[156:159], v[0:15]
    ds_read_b64_tr_b16 v[144:145], v194 offset:0
    ds_read_b64_tr_b16 v[146:147], v194 offset:512
    s_add_u32 m0, s44, 0
    s_add_u32 s48, s40, 512
    buffer_load_dwordx4 v196, s[8:11], s48 offen lds
    v_mfma_f32_32x32x16_bf16 v[16:31], v[176:179], v[156:159], v[16:31]
    ds_read_b128 v[128:131], v188 offset:0
    ds_read_b64_tr_b16 v[148:149], v195 offset:0
    s_add_u32 m0, s44, 1024
    s_add_u32 s48, s40, 8704
    buffer_load_dwordx4 v197, s[8:11], s48 offen lds
    v_mfma_f32_32x32x16_bf16 v[32:47], v[172:175], v[160:163], v[32:47]
    ds_read_b64_tr_b16 v[150:151], v195 offset:512
    ds_read_b128 v[132:135], v188 offset:4096
    s_add_u32 m0, s44, 2048
    s_add_u32 s48, s40, 16896
    buffer_load_dwordx4 v196, s[8:11], s48 offen lds
    v_mfma_f32_32x32x16_bf16 v[48:63], v[176:179], v[160:163], v[48:63]
    ds_read_b128 v[136:139], v188 offset:8192
    ds_read_b128 v[140:143], v188 offset:12288
    s_add_u32 m0, s44, 3072
    s_add_u32 s48, s40, 25088
    buffer_load_dwordx4 v197, s[8:11], s48 offen lds
    v_mfma_f32_32x32x16_bf16 v[64:79], v[172:175], v[164:167], v[64:79]
    s_add_u32 m0, s44, 32768
    s_add_u32 s48, s41, 2097152
    buffer_load_dwordx4 v198, s[16:19], s48 offen lds
    v_mfma_f32_32x32x16_bf16 v[80:95], v[176:179], v[164:167], v[80:95]
    s_add_u32 m0, s44, 33792
    s_add_u32 s48, s41, 2162688
    buffer_load_dwordx4 v198, s[16:19], s48 offen lds
    v_mfma_f32_32x32x16_bf16 v[96:111], v[172:175], v[168:171], v[96:111]
    s_add_u32 m0, s44, 34816
    s_add_u32 s48, s41, 2228224
    buffer_load_dwordx4 v198, s[16:19], s48 offen lds
    v_mfma_f32_32x32x16_bf16 v[112:127], v[176:179], v[168:171], v[112:127]
    s_add_u32 m0, s44, 35840
    s_add_u32 s48, s41, 2293760
    buffer_load_dwordx4 v198, s[16:19], s48 offen lds
    s_waitcnt lgkmcnt(5)
    v_mfma_f32_32x32x16_bf16 v[0:15], v[144:147], v[128:131], v[0:15]
    ds_read_b64_tr_b16 v[172:173], v194 offset:2048
    ds_read_b64_tr_b16 v[174:175], v194 offset:2560
    s_cmp_eq_u32 s36, 6
    s_cselect_b32 s68, s95, 0x40000000
    buffer_load_dword v254, v250, s[8:11], s68 offen
    s_waitcnt lgkmcnt(5)
    v_mfma_f32_32x32x16_bf16 v[16:31], v[148:151], v[128:131], v[16:31]
    ds_read_b128 v[156:159], v189 offset:0
    ds_read_b64_tr_b16 v[176:177], v195 offset:2048
    s_cmp_eq_u32 s99, 6
    s_cselect_b32 s68, s96, 0x40000000
    buffer_load_dword v254, v251, s[16:19], s68 offen
    s_waitcnt lgkmcnt(6)
    v_mfma_f32_32x32x16_bf16 v[32:47], v[144:147], v[132:135], v[32:47]
    ds_read_b64_tr_b16 v[178:179], v195 offset:2560
    ds_read_b128 v[160:163], v189 offset:4096
    s_cmp_eq_u32 s36, 0
    s_cselect_b32 s68, s95, 0x40000000
    buffer_load_dword v254, v250, s[12:15], s68 offen
    v_mfma_f32_32x32x16_bf16 v[48:63], v[148:151], v[132:135], v[48:63]
    ds_read_b128 v[164:167], v189 offset:8192
    ds_read_b128 v[168:171], v189 offset:12288
    s_cmp_eq_u32 s99, 0
    s_cselect_b32 s68, s97, 0x40000000
    buffer_load_dword v254, v215, s[20:23], s68 offen
    s_waitcnt lgkmcnt(9)
    v_mfma_f32_32x32x16_bf16 v[64:79], v[144:147], v[136:139], v[64:79]
    s_cmp_eq_u32 s99, 0
    s_cselect_b32 s68, s98, 0x40000000
    buffer_load_dword v254, v216, s[24:27], s68 offen
    v_mfma_f32_32x32x16_bf16 v[80:95], v[148:151], v[136:139], v[80:95]
    s_waitcnt lgkmcnt(8)
    v_mfma_f32_32x32x16_bf16 v[96:111], v[144:147], v[140:143], v[96:111]
    v_mfma_f32_32x32x16_bf16 v[112:127], v[148:151], v[140:143], v[112:127]
    s_waitcnt lgkmcnt(5)
    v_mfma_f32_32x32x16_bf16 v[0:15], v[172:175], v[156:159], v[0:15]
    ds_read_b64_tr_b16 v[144:145], v194 offset:4096
    ds_read_b64_tr_b16 v[146:147], v194 offset:4608
    s_waitcnt lgkmcnt(5)
    v_mfma_f32_32x32x16_bf16 v[16:31], v[176:179], v[156:159], v[16:31]
    ds_read_b128 v[128:131], v190 offset:0
    ds_read_b64_tr_b16 v[148:149], v195 offset:4096
    s_waitcnt lgkmcnt(6)
    v_mfma_f32_32x32x16_bf16 v[32:47], v[172:175], v[160:163], v[32:47]
    ds_read_b64_tr_b16 v[150:151], v195 offset:4608
    ds_read_b128 v[132:135], v190 offset:4096
    v_mfma_f32_32x32x16_bf16 v[48:63], v[176:179], v[160:163], v[48:63]
    ds_read_b128 v[136:139], v190 offset:8192
    ds_read_b128 v[140:143], v190 offset:12288
    s_waitcnt lgkmcnt(9)
    v_mfma_f32_32x32x16_bf16 v[64:79], v[172:175], v[164:167], v[64:79]
    v_mfma_f32_32x32x16_bf16 v[80:95], v[176:179], v[164:167], v[80:95]
    s_waitcnt lgkmcnt(8)
    v_mfma_f32_32x32x16_bf16 v[96:111], v[172:175], v[168:171], v[96:111]
    v_mfma_f32_32x32x16_bf16 v[112:127], v[176:179], v[168:171], v[112:127]
    s_waitcnt lgkmcnt(5)
    v_mfma_f32_32x32x16_bf16 v[0:15], v[144:147], v[128:131], v[0:15]
    ds_read_b64_tr_b16 v[172:173], v194 offset:6144
    ds_read_b64_tr_b16 v[174:175], v194 offset:6656
    s_waitcnt lgkmcnt(5)
    v_mfma_f32_32x32x16_bf16 v[16:31], v[148:151], v[128:131], v[16:31]
    ds_read_b128 v[156:159], v191 offset:0
    ds_read_b64_tr_b16 v[176:177], v195 offset:6144
    s_waitcnt lgkmcnt(6)
    v_mfma_f32_32x32x16_bf16 v[32:47], v[144:147], v[132:135], v[32:47]
    ds_read_b64_tr_b16 v[178:179], v195 offset:6656
    ds_read_b128 v[160:163], v191 offset:4096
    v_mfma_f32_32x32x16_bf16 v[48:63], v[148:151], v[132:135], v[48:63]
    ds_read_b128 v[164:167], v191 offset:8192
    ds_read_b128 v[168:171], v191 offset:12288
    s_waitcnt lgkmcnt(9)
    v_mfma_f32_32x32x16_bf16 v[64:79], v[144:147], v[136:139], v[64:79]
    v_mfma_f32_32x32x16_bf16 v[80:95], v[148:151], v[136:139], v[80:95]
    s_waitcnt lgkmcnt(8)
    v_mfma_f32_32x32x16_bf16 v[96:111], v[144:147], v[140:143], v[96:111]
    v_mfma_f32_32x32x16_bf16 v[112:127], v[148:151], v[140:143], v[112:127]
    s_waitcnt lgkmcnt(0)
    s_waitcnt vmcnt(5)
    s_barrier
    v_mfma_f32_32x32x16_bf16 v[0:15], v[172:175], v[156:159], v[0:15]
    ds_read_b64_tr_b16 v[144:145], v192 offset:0
    ds_read_b64_tr_b16 v[146:147], v192 offset:512
    s_add_u32 m0, s44, 65536
    s_add_u32 s48, s40, 640
    buffer_load_dwordx4 v196, s[8:11], s48 offen lds
    v_mfma_f32_32x32x16_bf16 v[16:31], v[176:179], v[156:159], v[16:31]
    ds_read_b128 v[128:131], v184 offset:0
    ds_read_b64_tr_b16 v[148:149], v193 offset:0
    s_add_u32 m0, s44, 66560
    s_add_u32 s48, s40, 8832
    buffer_load_dwordx4 v197, s[8:11], s48 offen lds
    v_mfma_f32_32x32x16_bf16 v[32:47], v[172:175], v[160:163], v[32:47]
    ds_read_b64_tr_b16 v[150:151], v193 offset:512
    ds_read_b128 v[132:135], v184 offset:4096
    s_add_u32 m0, s44, 67584
    s_add_u32 s48, s40, 17024
    buffer_load_dwordx4 v196, s[8:11], s48 offen lds
    v_mfma_f32_32x32x16_bf16 v[48:63], v[176:179], v[160:163], v[48:63]
    ds_read_b128 v[136:139], v184 offset:8192
    ds_read_b128 v[140:143], v184 offset:12288
    s_add_u32 m0, s44, 68608
    s_add_u32 s48, s40, 25216
    buffer_load_dwordx4 v197, s[8:11], s48 offen lds
    v_mfma_f32_32x32x16_bf16 v[64:79], v[172:175], v[164:167], v[64:79]
    s_add_u32 m0, s44, 98304
    s_add_u32 s48, s41, 2621440
    buffer_load_dwordx4 v198, s[16:19], s48 offen lds
    v_mfma_f32_32x32x16_bf16 v[80:95], v[176:179], v[164:167], v[80:95]
    s_add_u32 m0, s44, 99328
    s_add_u32 s48, s41, 2686976
    buffer_load_dwordx4 v198, s[16:19], s48 offen lds
    v_mfma_f32_32x32x16_bf16 v[96:111], v[172:175], v[168:171], v[96:111]
    s_add_u32 m0, s44, 100352
    s_add_u32 s48, s41, 2752512
    buffer_load_dwordx4 v198, s[16:19], s48 offen lds
    v_mfma_f32_32x32x16_bf16 v[112:127], v[176:179], v[168:171], v[112:127]
    s_add_u32 m0, s44, 101376
    s_add_u32 s48, s41, 2818048
    buffer_load_dwordx4 v198, s[16:19], s48 offen lds
    s_waitcnt lgkmcnt(5)
    v_mfma_f32_32x32x16_bf16 v[0:15], v[144:147], v[128:131], v[0:15]
    ds_read_b64_tr_b16 v[172:173], v192 offset:2048
    ds_read_b64_tr_b16 v[174:175], v192 offset:2560
    s_cmp_eq_u32 s36, 7
    s_cselect_b32 s68, s95, 0x40000000
    buffer_load_dword v254, v250, s[8:11], s68 offen
    s_waitcnt lgkmcnt(5)
    v_mfma_f32_32x32x16_bf16 v[16:31], v[148:151], v[128:131], v[16:31]
    ds_read_b128 v[156:159], v185 offset:0
    ds_read_b64_tr_b16 v[176:177], v193 offset:2048
    s_cmp_eq_u32 s99, 7
    s_cselect_b32 s68, s96, 0x40000000
    buffer_load_dword v254, v251, s[16:19], s68 offen
    s_waitcnt lgkmcnt(6)
    v_mfma_f32_32x32x16_bf16 v[32:47], v[144:147], v[132:135], v[32:47]
    ds_read_b64_tr_b16 v[178:179], v193 offset:2560
    ds_read_b128 v[160:163], v185 offset:4096
    s_cmp_eq_u32 s36, 1
    s_cselect_b32 s68, s95, 0x40000000
    buffer_load_dword v254, v250, s[12:15], s68 offen
    v_mfma_f32_32x32x16_bf16 v[48:63], v[148:151], v[132:135], v[48:63]
    ds_read_b128 v[164:167], v185 offset:8192
    ds_read_b128 v[168:171], v185 offset:12288
    s_cmp_eq_u32 s99, 1
    s_cselect_b32 s68, s97, 0x40000000
    buffer_load_dword v254, v215, s[20:23], s68 offen
    s_waitcnt lgkmcnt(9)
    v_mfma_f32_32x32x16_bf16 v[64:79], v[144:147], v[136:139], v[64:79]
    s_cmp_eq_u32 s99, 1
    s_cselect_b32 s68, s98, 0x40000000
    buffer_load_dword v254, v216, s[24:27], s68 offen
    v_mfma_f32_32x32x16_bf16 v[80:95], v[148:151], v[136:139], v[80:95]
    s_cmp_eq_u32 s36, 2
    s_cselect_b32 s68, s95, 0x40000000
    buffer_load_dword v254, v250, s[12:15], s68 offen
    s_waitcnt lgkmcnt(8)
    v_mfma_f32_32x32x16_bf16 v[96:111], v[144:147], v[140:143], v[96:111]
    s_cmp_eq_u32 s99, 2
    s_cselect_b32 s68, s97, 0x40000000
    buffer_load_dword v254, v215, s[20:23], s68 offen
    v_mfma_f32_32x32x16_bf16 v[112:127], v[148:151], v[140:143], v[112:127]
    s_cmp_eq_u32 s99, 2
    s_cselect_b32 s68, s98, 0x40000000
    buffer_load_dword v254, v216, s[24:27], s68 offen
    s_waitcnt lgkmcnt(5)
    v_mfma_f32_32x32x16_bf16 v[0:15], v[172:175], v[156:159], v[0:15]
    ds_read_b64_tr_b16 v[144:145], v192 offset:4096
    ds_read_b64_tr_b16 v[146:147], v192 offset:4608
    s_waitcnt lgkmcnt(5)
    v_mfma_f32_32x32x16_bf16 v[16:31], v[176:179], v[156:159], v[16:31]
    ds_read_b128 v[128:131], v186 offset:0
    ds_read_b64_tr_b16 v[148:149], v193 offset:4096
    s_waitcnt lgkmcnt(6)
    v_mfma_f32_32x32x16_bf16 v[32:47], v[172:175], v[160:163], v[32:47]
    ds_read_b64_tr_b16 v[150:151], v193 offset:4608
    ds_read_b128 v[132:135], v186 offset:4096
    v_mfma_f32_32x32x16_bf16 v[48:63], v[176:179], v[160:163], v[48:63]
    ds_read_b128 v[136:139], v186 offset:8192
    ds_read_b128 v[140:143], v186 offset:12288
    s_waitcnt lgkmcnt(9)
    v_mfma_f32_32x32x16_bf16 v[64:79], v[172:175], v[164:167], v[64:79]
    v_mfma_f32_32x32x16_bf16 v[80:95], v[176:179], v[164:167], v[80:95]
    s_waitcnt lgkmcnt(8)
    v_mfma_f32_32x32x16_bf16 v[96:111], v[172:175], v[168:171], v[96:111]
    v_mfma_f32_32x32x16_bf16 v[112:127], v[176:179], v[168:171], v[112:127]
    s_waitcnt lgkmcnt(5)
    v_mfma_f32_32x32x16_bf16 v[0:15], v[144:147], v[128:131], v[0:15]
    ds_read_b64_tr_b16 v[172:173], v192 offset:6144
    ds_read_b64_tr_b16 v[174:175], v192 offset:6656
    s_waitcnt lgkmcnt(5)
    v_mfma_f32_32x32x16_bf16 v[16:31], v[148:151], v[128:131], v[16:31]
    ds_read_b128 v[156:159], v187 offset:0
    ds_read_b64_tr_b16 v[176:177], v193 offset:6144
    s_waitcnt lgkmcnt(6)
    v_mfma_f32_32x32x16_bf16 v[32:47], v[144:147], v[132:135], v[32:47]
    ds_read_b64_tr_b16 v[178:179], v193 offset:6656
    ds_read_b128 v[160:163], v187 offset:4096
    v_mfma_f32_32x32x16_bf16 v[48:63], v[148:151], v[132:135], v[48:63]
    ds_read_b128 v[164:167], v187 offset:8192
    ds_read_b128 v[168:171], v187 offset:12288
    s_waitcnt lgkmcnt(9)
    v_mfma_f32_32x32x16_bf16 v[64:79], v[144:147], v[136:139], v[64:79]
    v_mfma_f32_32x32x16_bf16 v[80:95], v[148:151], v[136:139], v[80:95]
    s_waitcnt lgkmcnt(8)
    v_mfma_f32_32x32x16_bf16 v[96:111], v[144:147], v[140:143], v[96:111]
    v_mfma_f32_32x32x16_bf16 v[112:127], v[148:151], v[140:143], v[112:127]
    s_waitcnt lgkmcnt(0)
    s_waitcnt vmcnt(8)
    s_barrier
    v_mfma_f32_32x32x16_bf16 v[0:15], v[172:175], v[156:159], v[0:15]
    ds_read_b64_tr_b16 v[144:145], v194 offset:0
    ds_read_b64_tr_b16 v[146:147], v194 offset:512
    s_add_u32 m0, s44, 0
    s_add_u32 s48, s40, 768
    buffer_load_dwordx4 v196, s[8:11], s48 offen lds
    v_mfma_f32_32x32x16_bf16 v[16:31], v[176:179], v[156:159], v[16:31]
    ds_read_b128 v[128:131], v188 offset:0
    ds_read_b64_tr_b16 v[148:149], v195 offset:0
    s_add_u32 m0, s44, 1024
    s_add_u32 s48, s40, 8960
    buffer_load_dwordx4 v197, s[8:11], s48 offen lds
    v_mfma_f32_32x32x16_bf16 v[32:47], v[172:175], v[160:163], v[32:47]
    ds_read_b64_tr_b16 v[150:151], v195 offset:512
    ds_read_b128 v[132:135], v188 offset:4096
    s_add_u32 m0, s44, 2048
    s_add_u32 s48, s40, 17152
    buffer_load_dwordx4 v196, s[8:11], s48 offen lds
    v_mfma_f32_32x32x16_bf16 v[48:63], v[176:179], v[160:163], v[48:63]
    ds_read_b128 v[136:139], v188 offset:8192
    ds_read_b128 v[140:143], v188 offset:12288
    s_add_u32 m0, s44, 3072
    s_add_u32 s48, s40, 25344
    buffer_load_dwordx4 v197, s[8:11], s48 offen lds
    v_mfma_f32_32x32x16_bf16 v[64:79], v[172:175], v[164:167], v[64:79]
    s_add_u32 m0, s44, 32768
    s_add_u32 s48, s41, 3145728
    buffer_load_dwordx4 v198, s[16:19], s48 offen lds
    v_mfma_f32_32x32x16_bf16 v[80:95], v[176:179], v[164:167], v[80:95]
    s_add_u32 m0, s44, 33792
    s_add_u32 s48, s41, 3211264
    buffer_load_dwordx4 v198, s[16:19], s48 offen lds
    v_mfma_f32_32x32x16_bf16 v[96:111], v[172:175], v[168:171], v[96:111]
    s_add_u32 m0, s44, 34816
    s_add_u32 s48, s41, 3276800
    buffer_load_dwordx4 v198, s[16:19], s48 offen lds
    v_mfma_f32_32x32x16_bf16 v[112:127], v[176:179], v[168:171], v[112:127]
    s_add_u32 m0, s44, 35840
    s_add_u32 s48, s41, 3342336
    buffer_load_dwordx4 v198, s[16:19], s48 offen lds
    s_waitcnt lgkmcnt(5)
    v_mfma_f32_32x32x16_bf16 v[0:15], v[144:147], v[128:131], v[0:15]
    ds_read_b64_tr_b16 v[172:173], v194 offset:2048
    ds_read_b64_tr_b16 v[174:175], v194 offset:2560
    s_cmp_eq_u32 s36, 3
    s_cselect_b32 s68, s95, 0x40000000
    buffer_load_dword v254, v250, s[12:15], s68 offen
    s_waitcnt lgkmcnt(5)
    v_mfma_f32_32x32x16_bf16 v[16:31], v[148:151], v[128:131], v[16:31]
    ds_read_b128 v[156:159], v189 offset:0
    ds_read_b64_tr_b16 v[176:177], v195 offset:2048
    s_cmp_eq_u32 s99, 3
    s_cselect_b32 s68, s97, 0x40000000
    buffer_load_dword v254, v215, s[20:23], s68 offen
    s_waitcnt lgkmcnt(6)
    v_mfma_f32_32x32x16_bf16 v[32:47], v[144:147], v[132:135], v[32:47]
    ds_read_b64_tr_b16 v[178:179], v195 offset:2560
    ds_read_b128 v[160:163], v189 offset:4096
    s_cmp_eq_u32 s99, 3
    s_cselect_b32 s68, s98, 0x40000000
    buffer_load_dword v254, v216, s[24:27], s68 offen
    v_mfma_f32_32x32x16_bf16 v[48:63], v[148:151], v[132:135], v[48:63]
    ds_read_b128 v[164:167], v189 offset:8192
    ds_read_b128 v[168:171], v189 offset:12288
    s_cmp_eq_u32 s36, 4
    s_cselect_b32 s68, s95, 0x40000000
    buffer_load_dword v254, v250, s[12:15], s68 offen
    s_waitcnt lgkmcnt(9)
    v_mfma_f32_32x32x16_bf16 v[64:79], v[144:147], v[136:139], v[64:79]
    s_cmp_eq_u32 s99, 4
    s_cselect_b32 s68, s97, 0x40000000
    buffer_load_dword v254, v215, s[20:23], s68 offen
    v_mfma_f32_32x32x16_bf16 v[80:95], v[148:151], v[136:139], v[80:95]
    s_cmp_eq_u32 s99, 4
    s_cselect_b32 s68, s98, 0x40000000
    buffer_load_dword v254, v216, s[24:27], s68 offen
    s_waitcnt lgkmcnt(8)
    v_mfma_f32_32x32x16_bf16 v[96:111], v[144:147], v[140:143], v[96:111]
    v_mfma_f32_32x32x16_bf16 v[112:127], v[148:151], v[140:143], v[112:127]
    s_waitcnt lgkmcnt(5)
    v_mfma_f32_32x32x16_bf16 v[0:15], v[172:175], v[156:159], v[0:15]
    ds_read_b64_tr_b16 v[144:145], v194 offset:4096
    ds_read_b64_tr_b16 v[146:147], v194 offset:4608
    s_waitcnt lgkmcnt(5)
    v_mfma_f32_32x32x16_bf16 v[16:31], v[176:179], v[156:159], v[16:31]
    ds_read_b128 v[128:131], v190 offset:0
    ds_read_b64_tr_b16 v[148:149], v195 offset:4096
    s_waitcnt lgkmcnt(6)
    v_mfma_f32_32x32x16_bf16 v[32:47], v[172:175], v[160:163], v[32:47]
    ds_read_b64_tr_b16 v[150:151], v195 offset:4608
    ds_read_b128 v[132:135], v190 offset:4096
    v_mfma_f32_32x32x16_bf16 v[48:63], v[176:179], v[160:163], v[48:63]
    ds_read_b128 v[136:139], v190 offset:8192
    ds_read_b128 v[140:143], v190 offset:12288
    s_waitcnt lgkmcnt(9)
    v_mfma_f32_32x32x16_bf16 v[64:79], v[172:175], v[164:167], v[64:79]
    v_mfma_f32_32x32x16_bf16 v[80:95], v[176:179], v[164:167], v[80:95]
    s_waitcnt lgkmcnt(8)
    v_mfma_f32_32x32x16_bf16 v[96:111], v[172:175], v[168:171], v[96:111]
    v_mfma_f32_32x32x16_bf16 v[112:127], v[176:179], v[168:171], v[112:127]
    s_waitcnt lgkmcnt(5)
    v_mfma_f32_32x32x16_bf16 v[0:15], v[144:147], v[128:131], v[0:15]
    ds_read_b64_tr_b16 v[172:173], v194 offset:6144
    ds_read_b64_tr_b16 v[174:175], v194 offset:6656
    s_waitcnt lgkmcnt(5)
    v_mfma_f32_32x32x16_bf16 v[16:31], v[148:151], v[128:131], v[16:31]
    ds_read_b128 v[156:159], v191 offset:0
    ds_read_b64_tr_b16 v[176:177], v195 offset:6144
    s_waitcnt lgkmcnt(6)
    v_mfma_f32_32x32x16_bf16 v[32:47], v[144:147], v[132:135], v[32:47]
    ds_read_b64_tr_b16 v[178:179], v195 offset:6656
    ds_read_b128 v[160:163], v191 offset:4096
    v_mfma_f32_32x32x16_bf16 v[48:63], v[148:151], v[132:135], v[48:63]
    ds_read_b128 v[164:167], v191 offset:8192
    ds_read_b128 v[168:171], v191 offset:12288
    s_waitcnt lgkmcnt(9)
    v_mfma_f32_32x32x16_bf16 v[64:79], v[144:147], v[136:139], v[64:79]
    v_mfma_f32_32x32x16_bf16 v[80:95], v[148:151], v[136:139], v[80:95]
    s_waitcnt lgkmcnt(8)
    v_mfma_f32_32x32x16_bf16 v[96:111], v[144:147], v[140:143], v[96:111]
    v_mfma_f32_32x32x16_bf16 v[112:127], v[148:151], v[140:143], v[112:127]
    s_waitcnt lgkmcnt(0)
    s_waitcnt vmcnt(6)
    s_barrier
    v_mfma_f32_32x32x16_bf16 v[0:15], v[172:175], v[156:159], v[0:15]
    ds_read_b64_tr_b16 v[144:145], v192 offset:0
    ds_read_b64_tr_b16 v[146:147], v192 offset:512
    s_add_u32 m0, s44, 65536
    s_add_u32 s48, s40, 896
    buffer_load_dwordx4 v196, s[8:11], s48 offen lds
    v_mfma_f32_32x32x16_bf16 v[16:31], v[176:179], v[156:159], v[16:31]
    ds_read_b128 v[128:131], v184 offset:0
    ds_read_b64_tr_b16 v[148:149], v193 offset:0
    s_add_u32 m0, s44, 66560
    s_add_u32 s48, s40, 9088
    buffer_load_dwordx4 v197, s[8:11], s48 offen lds
    v_mfma_f32_32x32x16_bf16 v[32:47], v[172:175], v[160:163], v[32:47]
    ds_read_b64_tr_b16 v[150:151], v193 offset:512
    ds_read_b128 v[132:135], v184 offset:4096
    s_add_u32 m0, s44, 67584
    s_add_u32 s48, s40, 17280
    buffer_load_dwordx4 v196, s[8:11], s48 offen lds
    v_mfma_f32_32x32x16_bf16 v[48:63], v[176:179], v[160:163], v[48:63]
    ds_read_b128 v[136:139], v184 offset:8192
    ds_read_b128 v[140:143], v184 offset:12288
    s_add_u32 m0, s44, 68608
    s_add_u32 s48, s40, 25472
    buffer_load_dwordx4 v197, s[8:11], s48 offen lds
    v_mfma_f32_32x32x16_bf16 v[64:79], v[172:175], v[164:167], v[64:79]
    s_add_u32 m0, s44, 98304
    s_add_u32 s48, s41, 3670016
    buffer_load_dwordx4 v198, s[16:19], s48 offen lds
    v_mfma_f32_32x32x16_bf16 v[80:95], v[176:179], v[164:167], v[80:95]
    s_add_u32 m0, s44, 99328
    s_add_u32 s48, s41, 3735552
    buffer_load_dwordx4 v198, s[16:19], s48 offen lds
    v_mfma_f32_32x32x16_bf16 v[96:111], v[172:175], v[168:171], v[96:111]
    s_add_u32 m0, s44, 100352
    s_add_u32 s48, s41, 3801088
    buffer_load_dwordx4 v198, s[16:19], s48 offen lds
    v_mfma_f32_32x32x16_bf16 v[112:127], v[176:179], v[168:171], v[112:127]
    s_add_u32 m0, s44, 101376
    s_add_u32 s48, s41, 3866624
    buffer_load_dwordx4 v198, s[16:19], s48 offen lds
    s_waitcnt lgkmcnt(5)
    v_mfma_f32_32x32x16_bf16 v[0:15], v[144:147], v[128:131], v[0:15]
    ds_read_b64_tr_b16 v[172:173], v192 offset:2048
    ds_read_b64_tr_b16 v[174:175], v192 offset:2560
    s_cmp_eq_u32 s36, 5
    s_cselect_b32 s68, s95, 0x40000000
    buffer_load_dword v254, v250, s[12:15], s68 offen
    s_waitcnt lgkmcnt(5)
    v_mfma_f32_32x32x16_bf16 v[16:31], v[148:151], v[128:131], v[16:31]
    ds_read_b128 v[156:159], v185 offset:0
    ds_read_b64_tr_b16 v[176:177], v193 offset:2048
    s_cmp_eq_u32 s99, 5
    s_cselect_b32 s68, s97, 0x40000000
    buffer_load_dword v254, v215, s[20:23], s68 offen
    s_waitcnt lgkmcnt(6)
    v_mfma_f32_32x32x16_bf16 v[32:47], v[144:147], v[132:135], v[32:47]
    ds_read_b64_tr_b16 v[178:179], v193 offset:2560
    ds_read_b128 v[160:163], v185 offset:4096
    s_cmp_eq_u32 s99, 5
    s_cselect_b32 s68, s98, 0x40000000
    buffer_load_dword v254, v216, s[24:27], s68 offen
    v_mfma_f32_32x32x16_bf16 v[48:63], v[148:151], v[132:135], v[48:63]
    ds_read_b128 v[164:167], v185 offset:8192
    ds_read_b128 v[168:171], v185 offset:12288
    s_cmp_eq_u32 s36, 6
    s_cselect_b32 s68, s95, 0x40000000
    buffer_load_dword v254, v250, s[12:15], s68 offen
    s_waitcnt lgkmcnt(9)
    v_mfma_f32_32x32x16_bf16 v[64:79], v[144:147], v[136:139], v[64:79]
    s_cmp_eq_u32 s99, 6
    s_cselect_b32 s68, s97, 0x40000000
    buffer_load_dword v254, v215, s[20:23], s68 offen
    v_mfma_f32_32x32x16_bf16 v[80:95], v[148:151], v[136:139], v[80:95]
    s_cmp_eq_u32 s99, 6
    s_cselect_b32 s68, s98, 0x40000000
    buffer_load_dword v254, v216, s[24:27], s68 offen
    s_waitcnt lgkmcnt(8)
    v_mfma_f32_32x32x16_bf16 v[96:111], v[144:147], v[140:143], v[96:111]
    v_mfma_f32_32x32x16_bf16 v[112:127], v[148:151], v[140:143], v[112:127]
    s_waitcnt lgkmcnt(5)
    v_mfma_f32_32x32x16_bf16 v[0:15], v[172:175], v[156:159], v[0:15]
    ds_read_b64_tr_b16 v[144:145], v192 offset:4096
    ds_read_b64_tr_b16 v[146:147], v192 offset:4608
    s_waitcnt lgkmcnt(5)
    v_mfma_f32_32x32x16_bf16 v[16:31], v[176:179], v[156:159], v[16:31]
    ds_read_b128 v[128:131], v186 offset:0
    ds_read_b64_tr_b16 v[148:149], v193 offset:4096
    s_waitcnt lgkmcnt(6)
    v_mfma_f32_32x32x16_bf16 v[32:47], v[172:175], v[160:163], v[32:47]
    ds_read_b64_tr_b16 v[150:151], v193 offset:4608
    ds_read_b128 v[132:135], v186 offset:4096
    v_mfma_f32_32x32x16_bf16 v[48:63], v[176:179], v[160:163], v[48:63]
    ds_read_b128 v[136:139], v186 offset:8192
    ds_read_b128 v[140:143], v186 offset:12288
    s_waitcnt lgkmcnt(9)
    v_mfma_f32_32x32x16_bf16 v[64:79], v[172:175], v[164:167], v[64:79]
    v_mfma_f32_32x32x16_bf16 v[80:95], v[176:179], v[164:167], v[80:95]
    s_waitcnt lgkmcnt(8)
    v_mfma_f32_32x32x16_bf16 v[96:111], v[172:175], v[168:171], v[96:111]
    v_mfma_f32_32x32x16_bf16 v[112:127], v[176:179], v[168:171], v[112:127]
    s_waitcnt lgkmcnt(5)
    v_mfma_f32_32x32x16_bf16 v[0:15], v[144:147], v[128:131], v[0:15]
    ds_read_b64_tr_b16 v[172:173], v192 offset:6144
    ds_read_b64_tr_b16 v[174:175], v192 offset:6656
    s_waitcnt lgkmcnt(5)
    v_mfma_f32_32x32x16_bf16 v[16:31], v[148:151], v[128:131], v[16:31]
    ds_read_b128 v[156:159], v187 offset:0
    ds_read_b64_tr_b16 v[176:177], v193 offset:6144
    s_waitcnt lgkmcnt(6)
    v_mfma_f32_32x32x16_bf16 v[32:47], v[144:147], v[132:135], v[32:47]
    ds_read_b64_tr_b16 v[178:179], v193 offset:6656
    ds_read_b128 v[160:163], v187 offset:4096
    v_mfma_f32_32x32x16_bf16 v[48:63], v[148:151], v[132:135], v[48:63]
    ds_read_b128 v[164:167], v187 offset:8192
    ds_read_b128 v[168:171], v187 offset:12288
    s_waitcnt lgkmcnt(9)
    v_mfma_f32_32x32x16_bf16 v[64:79], v[144:147], v[136:139], v[64:79]
    v_mfma_f32_32x32x16_bf16 v[80:95], v[148:151], v[136:139], v[80:95]
    s_waitcnt lgkmcnt(8)
    v_mfma_f32_32x32x16_bf16 v[96:111], v[144:147], v[140:143], v[96:111]
    v_mfma_f32_32x32x16_bf16 v[112:127], v[148:151], v[140:143], v[112:127]
    s_waitcnt lgkmcnt(0)
    s_waitcnt vmcnt(6)
    s_barrier
    v_mfma_f32_32x32x16_bf16 v[0:15], v[172:175], v[156:159], v[0:15]
    ds_read_b64_tr_b16 v[144:145], v194 offset:0
    ds_read_b64_tr_b16 v[146:147], v194 offset:512
    s_add_u32 m0, s44, 0
    s_add_u32 s48, s3, 0
    buffer_load_dwordx4 v196, s[12:15], s48 offen lds
    v_mfma_f32_32x32x16_bf16 v[16:31], v[176:179], v[156:159], v[16:31]
    ds_read_b128 v[128:131], v188 offset:0
    ds_read_b64_tr_b16 v[148:149], v195 offset:0
    s_add_u32 m0, s44, 1024
    s_add_u32 s48, s3, 8192
    buffer_load_dwordx4 v197, s[12:15], s48 offen lds
    v_mfma_f32_32x32x16_bf16 v[32:47], v[172:175], v[160:163], v[32:47]
    ds_read_b64_tr_b16 v[150:151], v195 offset:512
    ds_read_b128 v[132:135], v188 offset:4096
    s_add_u32 m0, s44, 2048
    s_add_u32 s48, s3, 16384
    buffer_load_dwordx4 v196, s[12:15], s48 offen lds
    v_mfma_f32_32x32x16_bf16 v[48:63], v[176:179], v[160:163], v[48:63]
    ds_read_b128 v[136:139], v188 offset:8192
    ds_read_b128 v[140:143], v188 offset:12288
    s_add_u32 m0, s44, 3072
    s_add_u32 s48, s3, 24576
    buffer_load_dwordx4 v197, s[12:15], s48 offen lds
    v_mfma_f32_32x32x16_bf16 v[64:79], v[172:175], v[164:167], v[64:79]
    s_add_u32 m0, s45, 32768
    s_add_u32 s48, s42, 0
    buffer_load_dwordx4 v198, s[20:23], s48 offen lds
    v_mfma_f32_32x32x16_bf16 v[80:95], v[176:179], v[164:167], v[80:95]
    s_add_u32 m0, s45, 33792
    s_add_u32 s48, s42, 65536
    buffer_load_dwordx4 v198, s[20:23], s48 offen lds
    v_mfma_f32_32x32x16_bf16 v[96:111], v[172:175], v[168:171], v[96:111]
    s_add_u32 m0, s46, 49152
    s_add_u32 s48, s43, 0
    buffer_load_dwordx4 v199, s[24:27], s48 offen lds
    v_mfma_f32_32x32x16_bf16 v[112:127], v[176:179], v[168:171], v[112:127]
    s_waitcnt lgkmcnt(5)
    v_mfma_f32_32x32x16_bf16 v[0:15], v[144:147], v[128:131], v[0:15]
    ds_read_b64_tr_b16 v[172:173], v194 offset:2048
    ds_read_b64_tr_b16 v[174:175], v194 offset:2560
    s_cmp_eq_u32 s36, 7
    s_cselect_b32 s68, s95, 0x40000000
    buffer_load_dword v254, v250, s[12:15], s68 offen
    s_waitcnt lgkmcnt(5)
    v_mfma_f32_32x32x16_bf16 v[16:31], v[148:151], v[128:131], v[16:31]
    ds_read_b128 v[156:159], v189 offset:0
    ds_read_b64_tr_b16 v[176:177], v195 offset:2048
    s_cmp_eq_u32 s99, 7
    s_cselect_b32 s68, s97, 0x40000000
    buffer_load_dword v254, v215, s[20:23], s68 offen
    s_waitcnt lgkmcnt(6)
    v_mfma_f32_32x32x16_bf16 v[32:47], v[144:147], v[132:135], v[32:47]
    ds_read_b64_tr_b16 v[178:179], v195 offset:2560
    ds_read_b128 v[160:163], v189 offset:4096
    s_cmp_eq_u32 s99, 7
    s_cselect_b32 s68, s98, 0x40000000
    buffer_load_dword v254, v216, s[24:27], s68 offen
    v_mfma_f32_32x32x16_bf16 v[48:63], v[148:151], v[132:135], v[48:63]
    ds_read_b128 v[164:167], v189 offset:8192
    ds_read_b128 v[168:171], v189 offset:12288
    s_waitcnt lgkmcnt(9)
    v_mfma_f32_32x32x16_bf16 v[64:79], v[144:147], v[136:139], v[64:79]
    v_mfma_f32_32x32x16_bf16 v[80:95], v[148:151], v[136:139], v[80:95]
    s_waitcnt lgkmcnt(8)
    v_mfma_f32_32x32x16_bf16 v[96:111], v[144:147], v[140:143], v[96:111]
    v_mfma_f32_32x32x16_bf16 v[112:127], v[148:151], v[140:143], v[112:127]
    s_waitcnt lgkmcnt(5)
    v_mfma_f32_32x32x16_bf16 v[0:15], v[172:175], v[156:159], v[0:15]
    ds_read_b64_tr_b16 v[144:145], v194 offset:4096
    ds_read_b64_tr_b16 v[146:147], v194 offset:4608
    s_waitcnt lgkmcnt(5)
    v_mfma_f32_32x32x16_bf16 v[16:31], v[176:179], v[156:159], v[16:31]
    ds_read_b128 v[128:131], v190 offset:0
    ds_read_b64_tr_b16 v[148:149], v195 offset:4096
    s_waitcnt lgkmcnt(6)
    v_mfma_f32_32x32x16_bf16 v[32:47], v[172:175], v[160:163], v[32:47]
    ds_read_b64_tr_b16 v[150:151], v195 offset:4608
    ds_read_b128 v[132:135], v190 offset:4096
    v_mfma_f32_32x32x16_bf16 v[48:63], v[176:179], v[160:163], v[48:63]
    ds_read_b128 v[136:139], v190 offset:8192
    ds_read_b128 v[140:143], v190 offset:12288
    s_waitcnt lgkmcnt(9)
    v_mfma_f32_32x32x16_bf16 v[64:79], v[172:175], v[164:167], v[64:79]
    v_mfma_f32_32x32x16_bf16 v[80:95], v[176:179], v[164:167], v[80:95]
    s_waitcnt lgkmcnt(8)
    v_mfma_f32_32x32x16_bf16 v[96:111], v[172:175], v[168:171], v[96:111]
    v_mfma_f32_32x32x16_bf16 v[112:127], v[176:179], v[168:171], v[112:127]
    s_waitcnt lgkmcnt(5)
    v_mfma_f32_32x32x16_bf16 v[0:15], v[144:147], v[128:131], v[0:15]
    ds_read_b64_tr_b16 v[172:173], v194 offset:6144
    ds_read_b64_tr_b16 v[174:175], v194 offset:6656
    s_waitcnt lgkmcnt(5)
    v_mfma_f32_32x32x16_bf16 v[16:31], v[148:151], v[128:131], v[16:31]
    ds_read_b128 v[156:159], v191 offset:0
    ds_read_b64_tr_b16 v[176:177], v195 offset:6144
    s_waitcnt lgkmcnt(6)
    v_mfma_f32_32x32x16_bf16 v[32:47], v[144:147], v[132:135], v[32:47]
    ds_read_b64_tr_b16 v[178:179], v195 offset:6656
    ds_read_b128 v[160:163], v191 offset:4096
    v_mfma_f32_32x32x16_bf16 v[48:63], v[148:151], v[132:135], v[48:63]
    ds_read_b128 v[164:167], v191 offset:8192
    ds_read_b128 v[168:171], v191 offset:12288
    s_waitcnt lgkmcnt(9)
    v_mfma_f32_32x32x16_bf16 v[64:79], v[144:147], v[136:139], v[64:79]
    v_mfma_f32_32x32x16_bf16 v[80:95], v[148:151], v[136:139], v[80:95]
    s_waitcnt lgkmcnt(8)
    v_mfma_f32_32x32x16_bf16 v[96:111], v[144:147], v[140:143], v[96:111]
    v_mfma_f32_32x32x16_bf16 v[112:127], v[148:151], v[140:143], v[112:127]
    s_waitcnt lgkmcnt(0)
    s_waitcnt vmcnt(3)
    s_barrier
    v_mfma_f32_32x32x16_bf16 v[0:15], v[172:175], v[156:159], v[0:15]
    s_add_u32 m0, s44, 65536
    s_add_u32 s48, s3, 128
    buffer_load_dwordx4 v196, s[12:15], s48 offen lds
    v_mfma_f32_32x32x16_bf16 v[16:31], v[176:179], v[156:159], v[16:31]
    s_add_u32 m0, s44, 66560
    s_add_u32 s48, s3, 8320
    buffer_load_dwordx4 v197, s[12:15], s48 offen lds
    v_mfma_f32_32x32x16_bf16 v[32:47], v[172:175], v[160:163], v[32:47]
    s_add_u32 m0, s44, 67584
    s_add_u32 s48, s3, 16512
    buffer_load_dwordx4 v196, s[12:15], s48 offen lds
    v_mfma_f32_32x32x16_bf16 v[48:63], v[176:179], v[160:163], v[48:63]
    s_add_u32 m0, s44, 68608
    s_add_u32 s48, s3, 24704
    buffer_load_dwordx4 v197, s[12:15], s48 offen lds
    v_mfma_f32_32x32x16_bf16 v[64:79], v[172:175], v[164:167], v[64:79]
    s_add_u32 m0, s45, 98304
    s_add_u32 s48, s42, 524288
    buffer_load_dwordx4 v198, s[20:23], s48 offen lds
    v_mfma_f32_32x32x16_bf16 v[80:95], v[176:179], v[164:167], v[80:95]
    s_add_u32 m0, s45, 99328
    s_add_u32 s48, s42, 589824
    buffer_load_dwordx4 v198, s[20:23], s48 offen lds
    v_mfma_f32_32x32x16_bf16 v[96:111], v[172:175], v[168:171], v[96:111]
    s_add_u32 m0, s46, 114688
    s_add_u32 s48, s43, 196608
    buffer_load_dwordx4 v199, s[24:27], s48 offen lds
    v_mfma_f32_32x32x16_bf16 v[112:127], v[176:179], v[168:171], v[112:127]
    s_branch f_p2
f_vwave:
    s_waitcnt lgkmcnt(5)
    v_mfma_f32_32x32x16_bf16 v[0:15], v[128:131], v[144:147], 0
    ds_read_b64_tr_b16 v[172:173], v192 offset:2048
    ds_read_b64_tr_b16 v[174:175], v192 offset:2560
    s_cmp_eq_u32 s36, 2
    s_cselect_b32 s68, s95, 0x40000000
    buffer_load_dword v254, v250, s[8:11], s68 offen
    s_waitcnt lgkmcnt(5)
    v_mfma_f32_32x32x16_bf16 v[16:31], v[128:131], v[148:151], 0
    ds_read_b128 v[156:159], v185 offset:0
    ds_read_b64_tr_b16 v[176:177], v193 offset:2048
    s_cmp_eq_u32 s99, 2
    s_cselect_b32 s68, s96, 0x40000000
    buffer_load_dword v254, v251, s[16:19], s68 offen
    s_waitcnt lgkmcnt(6)
    v_mfma_f32_32x32x16_bf16 v[32:47], v[132:135], v[144:147], 0
    ds_read_b64_tr_b16 v[178:179], v193 offset:2560
    ds_read_b128 v[160:163], v185 offset:4096
    s_cmp_eq_u32 s36, 3
    s_cselect_b32 s68, s95, 0x40000000
    buffer_load_dword v254, v250, s[8:11], s68 offen
    v_mfma_f32_32x32x16_bf16 v[48:63], v[132:135], v[148:151], 0
    ds_read_b128 v[164:167], v185 offset:8192
    ds_read_b128 v[168:171], v185 offset:12288
    s_cmp_eq_u32 s99, 3
    s_cselect_b32 s68, s96, 0x40000000
    buffer_load_dword v254, v251, s[16:19], s68 offen
    s_waitcnt lgkmcnt(9)
    v_mfma_f32_32x32x16_bf16 v[64:79], v[136:139], v[144:147], 0
    v_mfma_f32_32x32x16_bf16 v[80:95], v[136:139], v[148:151], 0
    s_waitcnt lgkmcnt(8)
    v_mfma_f32_32x32x16_bf16 v[96:111], v[140:143], v[144:147], 0
    v_mfma_f32_32x32x16_bf16 v[112:127], v[140:143], v[148:151], 0
    s_waitcnt lgkmcnt(5)
    v_mfma_f32_32x32x16_bf16 v[0:15], v[156:159], v[172:175], v[0:15]
    ds_read_b64_tr_b16 v[144:145], v192 offset:4096
    ds_read_b64_tr_b16 v[146:147], v192 offset:4608
    s_waitcnt lgkmcnt(5)
    v_mfma_f32_32x32x16_bf16 v[16:31], v[156:159], v[176:179], v[16:31]
    ds_read_b128 v[128:131], v186 offset:0
    ds_read_b64_tr_b16 v[148:149], v193 offset:4096
    s_waitcnt lgkmcnt(6)
    v_mfma_f32_32x32x16_bf16 v[32:47], v[160:163], v[172:175], v[32:47]
    ds_read_b64_tr_b16 v[150:151], v193 offset:4608
    ds_read_b128 v[132:135], v186 offset:4096
    v_mfma_f32_32x32x16_bf16 v[48:63], v[160:163], v[176:179], v[48:63]
    ds_read_b128 v[136:139], v186 offset:8192
    ds_read_b128 v[140:143], v186 offset:12288
    s_waitcnt lgkmcnt(9)
    v_mfma_f32_32x32x16_bf16 v[64:79], v[164:167], v[172:175], v[64:79]
    v_mfma_f32_32x32x16_bf16 v[80:95], v[164:167], v[176:179], v[80:95]
    s_waitcnt lgkmcnt(8)
    v_mfma_f32_32x32x16_bf16 v[96:111], v[168:171], v[172:175], v[96:111]
    v_mfma_f32_32x32x16_bf16 v[112:127], v[168:171], v[176:179], v[112:127]
    s_waitcnt lgkmcnt(5)
    v_mfma_f32_32x32x16_bf16 v[0:15], v[128:131], v[144:147], v[0:15]
    ds_read_b64_tr_b16 v[172:173], v192 offset:6144
    ds_read_b64_tr_b16 v[174:175], v192 offset:6656
    s_waitcnt lgkmcnt(5)
    v_mfma_f32_32x32x16_bf16 v[16:31], v[128:131], v[148:151], v[16:31]
    ds_read_b128 v[156:159], v187 offset:0
    ds_read_b64_tr_b16 v[176:177], v193 offset:6144
    s_waitcnt lgkmcnt(6)
    v_mfma_f32_32x32x16_bf16 v[32:47], v[132:135], v[144:147], v[32:47]
    ds_read_b64_tr_b16 v[178:179], v193 offset:6656
    ds_read_b128 v[160:163], v187 offset:4096
    v_mfma_f32_32x32x16_bf16 v[48:63], v[132:135], v[148:151], v[48:63]
    ds_read_b128 v[164:167], v187 offset:8192
    ds_read_b128 v[168:171], v187 offset:12288
    s_waitcnt lgkmcnt(9)
    v_mfma_f32_32x32x16_bf16 v[64:79], v[136:139], v[144:147], v[64:79]
    v_mfma_f32_32x32x16_bf16 v[80:95], v[136:139], v[148:151], v[80:95]
    s_waitcnt lgkmcnt(8)
    v_mfma_f32_32x32x16_bf16 v[96:111], v[140:143], v[144:147], v[96:111]
    v_mfma_f32_32x32x16_bf16 v[112:127], v[140:143], v[148:151], v[112:127]
    s_waitcnt lgkmcnt(0)
    s_waitcnt vmcnt(4)
    s_barrier
    v_mfma_f32_32x32x16_bf16 v[0:15], v[156:159], v[172:175], v[0:15]
    ds_read_b64_tr_b16 v[144:145], v194 offset:0
    ds_read_b64_tr_b16 v[146:147], v194 offset:512
    s_add_u32 m0, s44, 0
    s_add_u32 s48, s40, 256
    buffer_load_dwordx4 v196, s[8:11], s48 offen lds
    v_mfma_f32_32x32x16_bf16 v[16:31], v[156:159], v[176:179], v[16:31]
    ds_read_b128 v[128:131], v188 offset:0
    ds_read_b64_tr_b16 v[148:149], v195 offset:0
    s_add_u32 m0, s44, 1024
    s_add_u32 s48, s40, 8448
    buffer_load_dwordx4 v197, s[8:11], s48 offen lds
    v_mfma_f32_32x32x16_bf16 v[32:47], v[160:163], v[172:175], v[32:47]
    ds_read_b64_tr_b16 v[150:151], v195 offset:512
    ds_read_b128 v[132:135], v188 offset:4096
    s_add_u32 m0, s44, 2048
    s_add_u32 s48, s40, 16640
    buffer_load_dwordx4 v196, s[8:11], s48 offen lds
    v_mfma_f32_32x32x16_bf16 v[48:63], v[160:163], v[176:179], v[48:63]
    ds_read_b128 v[136:139], v188 offset:8192
    ds_read_b128 v[140:143], v188 offset:12288
    s_add_u32 m0, s44, 3072
    s_add_u32 s48, s40, 24832
    buffer_load_dwordx4 v197, s[8:11], s48 offen lds
    v_mfma_f32_32x32x16_bf16 v[64:79], v[164:167], v[172:175], v[64:79]
    s_add_u32 m0, s44, 32768
    s_add_u32 s48, s41, 1048576
    buffer_load_dwordx4 v198, s[16:19], s48 offen lds
    v_mfma_f32_32x32x16_bf16 v[80:95], v[164:167], v[176:179], v[80:95]
    s_add_u32 m0, s44, 33792
    s_add_u32 s48, s41, 1114112
    buffer_load_dwordx4 v198, s[16:19], s48 offen lds
    v_mfma_f32_32x32x16_bf16 v[96:111], v[168:171], v[172:175], v[96:111]
    s_add_u32 m0, s44, 34816
    s_add_u32 s48, s41, 1179648
    buffer_load_dwordx4 v198, s[16:19], s48 offen lds
    v_mfma_f32_32x32x16_bf16 v[112:127], v[168:171], v[176:179], v[112:127]
    s_add_u32 m0, s44, 35840
    s_add_u32 s48, s41, 1245184
    buffer_load_dwordx4 v198, s[16:19], s48 offen lds
    s_waitcnt lgkmcnt(5)
    v_mfma_f32_32x32x16_bf16 v[0:15], v[128:131], v[144:147], v[0:15]
    ds_read_b64_tr_b16 v[172:173], v194 offset:2048
    ds_read_b64_tr_b16 v[174:175], v194 offset:2560
    s_cmp_eq_u32 s36, 4
    s_cselect_b32 s68, s95, 0x40000000
    buffer_load_dword v254, v250, s[8:11], s68 offen
    s_waitcnt lgkmcnt(5)
    v_mfma_f32_32x32x16_bf16 v[16:31], v[128:131], v[148:151], v[16:31]
    ds_read_b128 v[156:159], v189 offset:0
    ds_read_b64_tr_b16 v[176:177], v195 offset:2048
    s_cmp_eq_u32 s99, 4
    s_cselect_b32 s68, s96, 0x40000000
    buffer_load_dword v254, v251, s[16:19], s68 offen
    s_waitcnt lgkmcnt(6)
    v_mfma_f32_32x32x16_bf16 v[32:47], v[132:135], v[144:147], v[32:47]
    ds_read_b64_tr_b16 v[178:179], v195 offset:2560
    ds_read_b128 v[160:163], v189 offset:4096
    v_mfma_f32_32x32x16_bf16 v[48:63], v[132:135], v[148:151], v[48:63]
    ds_read_b128 v[164:167], v189 offset:8192
    ds_read_b128 v[168:171], v189 offset:12288
    s_waitcnt lgkmcnt(9)
    v_mfma_f32_32x32x16_bf16 v[64:79], v[136:139], v[144:147], v[64:79]
    v_mfma_f32_32x32x16_bf16 v[80:95], v[136:139], v[148:151], v[80:95]
    s_waitcnt lgkmcnt(8)
    v_mfma_f32_32x32x16_bf16 v[96:111], v[140:143], v[144:147], v[96:111]
    v_mfma_f32_32x32x16_bf16 v[112:127], v[140:143], v[148:151], v[112:127]
    s_waitcnt lgkmcnt(5)
    v_mfma_f32_32x32x16_bf16 v[0:15], v[156:159], v[172:175], v[0:15]
    ds_read_b64_tr_b16 v[144:145], v194 offset:4096
    ds_read_b64_tr_b16 v[146:147], v194 offset:4608
    s_waitcnt lgkmcnt(5)
    v_mfma_f32_32x32x16_bf16 v[16:31], v[156:159], v[176:179], v[16:31]
    ds_read_b128 v[128:131], v190 offset:0
    ds_read_b64_tr_b16 v[148:149], v195 offset:4096
    s_waitcnt lgkmcnt(6)
    v_mfma_f32_32x32x16_bf16 v[32:47], v[160:163], v[172:175], v[32:47]
    ds_read_b64_tr_b16 v[150:151], v195 offset:4608
    ds_read_b128 v[132:135], v190 offset:4096
    v_mfma_f32_32x32x16_bf16 v[48:63], v[160:163], v[176:179], v[48:63]
    ds_read_b128 v[136:139], v190 offset:8192
    ds_read_b128 v[140:143], v190 offset:12288
    s_waitcnt lgkmcnt(9)
    v_mfma_f32_32x32x16_bf16 v[64:79], v[164:167], v[172:175], v[64:79]
    v_mfma_f32_32x32x16_bf16 v[80:95], v[164:167], v[176:179], v[80:95]
    s_waitcnt lgkmcnt(8)
    v_mfma_f32_32x32x16_bf16 v[96:111], v[168:171], v[172:175], v[96:111]
    v_mfma_f32_32x32x16_bf16 v[112:127], v[168:171], v[176:179], v[112:127]
    s_waitcnt lgkmcnt(5)
    v_mfma_f32_32x32x16_bf16 v[0:15], v[128:131], v[144:147], v[0:15]
    ds_read_b64_tr_b16 v[172:173], v194 offset:6144
    ds_read_b64_tr_b16 v[174:175], v194 offset:6656
    s_waitcnt lgkmcnt(5)
    v_mfma_f32_32x32x16_bf16 v[16:31], v[128:131], v[148:151], v[16:31]
    ds_read_b128 v[156:159], v191 offset:0
    ds_read_b64_tr_b16 v[176:177], v195 offset:6144
    s_waitcnt lgkmcnt(6)
    v_mfma_f32_32x32x16_bf16 v[32:47], v[132:135], v[144:147], v[32:47]
    ds_read_b64_tr_b16 v[178:179], v195 offset:6656
    ds_read_b128 v[160:163], v191 offset:4096
    v_mfma_f32_32x32x16_bf16 v[48:63], v[132:135], v[148:151], v[48:63]
    ds_read_b128 v[164:167], v191 offset:8192
    ds_read_b128 v[168:171], v191 offset:12288
    s_waitcnt lgkmcnt(9)
    v_mfma_f32_32x32x16_bf16 v[64:79], v[136:139], v[144:147], v[64:79]
    v_mfma_f32_32x32x16_bf16 v[80:95], v[136:139], v[148:151], v[80:95]
    s_waitcnt lgkmcnt(8)
    v_mfma_f32_32x32x16_bf16 v[96:111], v[140:143], v[144:147], v[96:111]
    v_mfma_f32_32x32x16_bf16 v[112:127], v[140:143], v[148:151], v[112:127]
    s_waitcnt lgkmcnt(0)
    s_waitcnt vmcnt(2)
    s_barrier
    v_mfma_f32_32x32x16_bf16 v[0:15], v[156:159], v[172:175], v[0:15]
    ds_read_b64_tr_b16 v[144:145], v192 offset:0
    ds_read_b64_tr_b16 v[146:147], v192 offset:512
    s_add_u32 m0, s44, 65536
    s_add_u32 s48, s40, 384
    buffer_load_dwordx4 v196, s[8:11], s48 offen lds
    v_mfma_f32_32x32x16_bf16 v[16:31], v[156:159], v[176:179], v[16:31]
    ds_read_b128 v[128:131], v184 offset:0
    ds_read_b64_tr_b16 v[148:149], v193 offset:0
    s_add_u32 m0, s44, 66560
    s_add_u32 s48, s40, 8576
    buffer_load_dwordx4 v197, s[8:11], s48 offen lds
    v_mfma_f32_32x32x16_bf16 v[32:47], v[160:163], v[172:175], v[32:47]
    ds_read_b64_tr_b16 v[150:151], v193 offset:512
    ds_read_b128 v[132:135], v184 offset:4096
    s_add_u32 m0, s44, 67584
    s_add_u32 s48, s40, 16768
    buffer_load_dwordx4 v196, s[8:11], s48 offen lds
    v_mfma_f32_32x32x16_bf16 v[48:63], v[160:163], v[176:179], v[48:63]
    ds_read_b128 v[136:139], v184 offset:8192
    ds_read_b128 v[140:143], v184 offset:12288
    s_add_u32 m0, s44, 68608
    s_add_u32 s48, s40, 24960
    buffer_load_dwordx4 v197, s[8:11], s48 offen lds
    v_mfma_f32_32x32x16_bf16 v[64:79], v[164:167], v[172:175], v[64:79]
    s_add_u32 m0, s44, 98304
    s_add_u32 s48, s41, 1572864
    buffer_load_dwordx4 v198, s[16:19], s48 offen lds
    v_mfma_f32_32x32x16_bf16 v[80:95], v[164:167], v[176:179], v[80:95]
    s_add_u32 m0, s44, 99328
    s_add_u32 s48, s41, 1638400
    buffer_load_dwordx4 v198, s[16:19], s48 offen lds
    v_mfma_f32_32x32x16_bf16 v[96:111], v[168:171], v[172:175], v[96:111]
    s_add_u32 m0, s44, 100352
    s_add_u32 s48, s41, 1703936
    buffer_load_dwordx4 v198, s[16:19], s48 offen lds
    v_mfma_f32_32x32x16_bf16 v[112:127], v[168:171], v[176:179], v[112:127]
    s_add_u32 m0, s44, 101376
    s_add_u32 s48, s41, 1769472
    buffer_load_dwordx4 v198, s[16:19], s48 offen lds
    s_waitcnt lgkmcnt(5)
    v_mfma_f32_32x32x16_bf16 v[0:15], v[128:131], v[144:147], v[0:15]
    ds_read_b64_tr_b16 v[172:173], v192 offset:2048
    ds_read_b64_tr_b16 v[174:175], v192 offset:2560
    s_cmp_eq_u32 s36, 5
    s_cselect_b32 s68, s95, 0x40000000
    buffer_load_dword v254, v250, s[8:11], s68 offen
    s_waitcnt lgkmcnt(5)
    v_mfma_f32_32x32x16_bf16 v[16:31], v[128:131], v[148:151], v[16:31]
    ds_read_b128 v[156:159], v185 offset:0
    ds_read_b64_tr_b16 v[176:177], v193 offset:2048
    s_cmp_eq_u32 s99, 5
    s_cselect_b32 s68, s96, 0x40000000
    buffer_load_dword v254, v251, s[16:19], s68 offen
    s_waitcnt lgkmcnt(6)
    v_mfma_f32_32x32x16_bf16 v[32:47], v[132:135], v[144:147], v[32:47]
    ds_read_b64_tr_b16 v[178:179], v193 offset:2560
    ds_read_b128 v[160:163], v185 offset:4096
    v_mfma_f32_32x32x16_bf16 v[48:63], v[132:135], v[148:151], v[48:63]
    ds_read_b128 v[164:167], v185 offset:8192
    ds_read_b128 v[168:171], v185 offset:12288
    s_waitcnt lgkmcnt(9)
    v_mfma_f32_32x32x16_bf16 v[64:79], v[136:139], v[144:147], v[64:79]
    v_mfma_f32_32x32x16_bf16 v[80:95], v[136:139], v[148:151], v[80:95]
    s_waitcnt lgkmcnt(8)
    v_mfma_f32_32x32x16_bf16 v[96:111], v[140:143], v[144:147], v[96:111]
    v_mfma_f32_32x32x16_bf16 v[112:127], v[140:143], v[148:151], v[112:127]
    s_waitcnt lgkmcnt(5)
    v_mfma_f32_32x32x16_bf16 v[0:15], v[156:159], v[172:175], v[0:15]
    ds_read_b64_tr_b16 v[144:145], v192 offset:4096
    ds_read_b64_tr_b16 v[146:147], v192 offset:4608
    s_waitcnt lgkmcnt(5)
    v_mfma_f32_32x32x16_bf16 v[16:31], v[156:159], v[176:179], v[16:31]
    ds_read_b128 v[128:131], v186 offset:0
    ds_read_b64_tr_b16 v[148:149], v193 offset:4096
    s_waitcnt lgkmcnt(6)
    v_mfma_f32_32x32x16_bf16 v[32:47], v[160:163], v[172:175], v[32:47]
    ds_read_b64_tr_b16 v[150:151], v193 offset:4608
    ds_read_b128 v[132:135], v186 offset:4096
    v_mfma_f32_32x32x16_bf16 v[48:63], v[160:163], v[176:179], v[48:63]
    ds_read_b128 v[136:139], v186 offset:8192
    ds_read_b128 v[140:143], v186 offset:12288
    s_waitcnt lgkmcnt(9)
    v_mfma_f32_32x32x16_bf16 v[64:79], v[164:167], v[172:175], v[64:79]
    v_mfma_f32_32x32x16_bf16 v[80:95], v[164:167], v[176:179], v[80:95]
    s_waitcnt lgkmcnt(8)
    v_mfma_f32_32x32x16_bf16 v[96:111], v[168:171], v[172:175], v[96:111]
    v_mfma_f32_32x32x16_bf16 v[112:127], v[168:171], v[176:179], v[112:127]
    s_waitcnt lgkmcnt(5)
    v_mfma_f32_32x32x16_bf16 v[0:15], v[128:131], v[144:147], v[0:15]
    ds_read_b64_tr_b16 v[172:173], v192 offset:6144
    ds_read_b64_tr_b16 v[174:175], v192 offset:6656
    s_waitcnt lgkmcnt(5)
    v_mfma_f32_32x32x16_bf16 v[16:31], v[128:131], v[148:151], v[16:31]
    ds_read_b128 v[156:159], v187 offset:0
    ds_read_b64_tr_b16 v[176:177], v193 offset:6144
    s_waitcnt lgkmcnt(6)
    v_mfma_f32_32x32x16_bf16 v[32:47], v[132:135], v[144:147], v[32:47]
    ds_read_b64_tr_b16 v[178:179], v193 offset:6656
    ds_read_b128 v[160:163], v187 offset:4096
    v_mfma_f32_32x32x16_bf16 v[48:63], v[132:135], v[148:151], v[48:63]
    ds_read_b128 v[164:167], v187 offset:8192
    ds_read_b128 v[168:171], v187 offset:12288
    s_waitcnt lgkmcnt(9)
    v_mfma_f32_32x32x16_bf16 v[64:79], v[136:139], v[144:147], v[64:79]
    v_mfma_f32_32x32x16_bf16 v[80:95], v[136:139], v[148:151], v[80:95]
    s_waitcnt lgkmcnt(8)
    v_mfma_f32_32x32x16_bf16 v[96:111], v[140:143], v[144:147], v[96:111]
    v_mfma_f32_32x32x16_bf16 v[112:127], v[140:143], v[148:151], v[112:127]
    s_waitcnt lgkmcnt(0)
    s_waitcnt vmcnt(2)
    s_barrier
    v_mfma_f32_32x32x16_bf16 v[0:15], v[156:159], v[172:175], v[0:15]
    ds_read_b64_tr_b16 v[144:145], v194 offset:0
    ds_read_b64_tr_b16 v[146:147], v194 offset:512
    s_add_u32 m0, s44, 0
    s_add_u32 s48, s40, 512
    buffer_load_dwordx4 v196, s[8:11], s48 offen lds
    v_mfma_f32_32x32x16_bf16 v[16:31], v[156:159], v[176:179], v[16:31]
    ds_read_b128 v[128:131], v188 offset:0
    ds_read_b64_tr_b16 v[148:149], v195 offset:0
    s_add_u32 m0, s44, 1024
    s_add_u32 s48, s40, 8704
    buffer_load_dwordx4 v197, s[8:11], s48 offen lds
    v_mfma_f32_32x32x16_bf16 v[32:47], v[160:163], v[172:175], v[32:47]
    ds_read_b64_tr_b16 v[150:151], v195 offset:512
    ds_read_b128 v[132:135], v188 offset:4096
    s_add_u32 m0, s44, 2048
    s_add_u32 s48, s40, 16896
    buffer_load_dwordx4 v196, s[8:11], s48 offen lds
    v_mfma_f32_32x32x16_bf16 v[48:63], v[160:163], v[176:179], v[48:63]
    ds_read_b128 v[136:139], v188 offset:8192
    ds_read_b128 v[140:143], v188 offset:12288
    s_add_u32 m0, s44, 3072
    s_add_u32 s48, s40, 25088
    buffer_load_dwordx4 v197, s[8:11], s48 offen lds
    v_mfma_f32_32x32x16_bf16 v[64:79], v[164:167], v[172:175], v[64:79]
    s_add_u32 m0, s44, 32768
    s_add_u32 s48, s41, 2097152
    buffer_load_dwordx4 v198, s[16:19], s48 offen lds
    v_mfma_f32_32x32x16_bf16 v[80:95], v[164:167], v[176:179], v[80:95]
    s_add_u32 m0, s44, 33792
    s_add_u32 s48, s41, 2162688
    buffer_load_dwordx4 v198, s[16:19], s48 offen lds
    v_mfma_f32_32x32x16_bf16 v[96:111], v[168:171], v[172:175], v[96:111]
    s_add_u32 m0, s44, 34816
    s_add_u32 s48, s41, 2228224
    buffer_load_dwordx4 v198, s[16:19], s48 offen lds
    v_mfma_f32_32x32x16_bf16 v[112:127], v[168:171], v[176:179], v[112:127]
    s_add_u32 m0, s44, 35840
    s_add_u32 s48, s41, 2293760
    buffer_load_dwordx4 v198, s[16:19], s48 offen lds
    s_waitcnt lgkmcnt(5)
    v_mfma_f32_32x32x16_bf16 v[0:15], v[128:131], v[144:147], v[0:15]
    ds_read_b64_tr_b16 v[172:173], v194 offset:2048
    ds_read_b64_tr_b16 v[174:175], v194 offset:2560
    s_cmp_eq_u32 s36, 6
    s_cselect_b32 s68, s95, 0x40000000
    buffer_load_dword v254, v250, s[8:11], s68 offen
    s_waitcnt lgkmcnt(5)
    v_mfma_f32_32x32x16_bf16 v[16:31], v[128:131], v[148:151], v[16:31]
    ds_read_b128 v[156:159], v189 offset:0
    ds_read_b64_tr_b16 v[176:177], v195 offset:2048
    s_cmp_eq_u32 s99, 6
    s_cselect_b32 s68, s96, 0x40000000
    buffer_load_dword v254, v251, s[16:19], s68 offen
    s_waitcnt lgkmcnt(6)
    v_mfma_f32_32x32x16_bf16 v[32:47], v[132:135], v[144:147], v[32:47]
    ds_read_b64_tr_b16 v[178:179], v195 offset:2560
    ds_read_b128 v[160:163], v189 offset:4096
    s_cmp_eq_u32 s36, 0
    s_cselect_b32 s68, s95, 0x40000000
    buffer_load_dword v254, v250, s[12:15], s68 offen
    v_mfma_f32_32x32x16_bf16 v[48:63], v[132:135], v[148:151], v[48:63]
    ds_read_b128 v[164:167], v189 offset:8192
    ds_read_b128 v[168:171], v189 offset:12288
    s_cmp_eq_u32 s99, 0
    s_cselect_b32 s68, s97, 0x40000000
    buffer_load_dword v254, v215, s[20:23], s68 offen
    s_waitcnt lgkmcnt(9)
    v_mfma_f32_32x32x16_bf16 v[64:79], v[136:139], v[144:147], v[64:79]
    s_cmp_eq_u32 s99, 0
    s_cselect_b32 s68, s98, 0x40000000
    buffer_load_dword v254, v216, s[24:27], s68 offen
    v_mfma_f32_32x32x16_bf16 v[80:95], v[136:139], v[148:151], v[80:95]
    s_waitcnt lgkmcnt(8)
    v_mfma_f32_32x32x16_bf16 v[96:111], v[140:143], v[144:147], v[96:111]
    v_mfma_f32_32x32x16_bf16 v[112:127], v[140:143], v[148:151], v[112:127]
    s_waitcnt lgkmcnt(5)
    v_mfma_f32_32x32x16_bf16 v[0:15], v[156:159], v[172:175], v[0:15]
    ds_read_b64_tr_b16 v[144:145], v194 offset:4096
    ds_read_b64_tr_b16 v[146:147], v194 offset:4608
    s_waitcnt lgkmcnt(5)
    v_mfma_f32_32x32x16_bf16 v[16:31], v[156:159], v[176:179], v[16:31]
    ds_read_b128 v[128:131], v190 offset:0
    ds_read_b64_tr_b16 v[148:149], v195 offset:4096
    s_waitcnt lgkmcnt(6)
    v_mfma_f32_32x32x16_bf16 v[32:47], v[160:163], v[172:175], v[32:47]
    ds_read_b64_tr_b16 v[150:151], v195 offset:4608
    ds_read_b128 v[132:135], v190 offset:4096
    v_mfma_f32_32x32x16_bf16 v[48:63], v[160:163], v[176:179], v[48:63]
    ds_read_b128 v[136:139], v190 offset:8192
    ds_read_b128 v[140:143], v190 offset:12288
    s_waitcnt lgkmcnt(9)
    v_mfma_f32_32x32x16_bf16 v[64:79], v[164:167], v[172:175], v[64:79]
    v_mfma_f32_32x32x16_bf16 v[80:95], v[164:167], v[176:179], v[80:95]
    s_waitcnt lgkmcnt(8)
    v_mfma_f32_32x32x16_bf16 v[96:111], v[168:171], v[172:175], v[96:111]
    v_mfma_f32_32x32x16_bf16 v[112:127], v[168:171], v[176:179], v[112:127]
    s_waitcnt lgkmcnt(5)
    v_mfma_f32_32x32x16_bf16 v[0:15], v[128:131], v[144:147], v[0:15]
    ds_read_b64_tr_b16 v[172:173], v194 offset:6144
    ds_read_b64_tr_b16 v[174:175], v194 offset:6656
    s_waitcnt lgkmcnt(5)
    v_mfma_f32_32x32x16_bf16 v[16:31], v[128:131], v[148:151], v[16:31]
    ds_read_b128 v[156:159], v191 offset:0
    ds_read_b64_tr_b16 v[176:177], v195 offset:6144
    s_waitcnt lgkmcnt(6)
    v_mfma_f32_32x32x16_bf16 v[32:47], v[132:135], v[144:147], v[32:47]
    ds_read_b64_tr_b16 v[178:179], v195 offset:6656
    ds_read_b128 v[160:163], v191 offset:4096
    v_mfma_f32_32x32x16_bf16 v[48:63], v[132:135], v[148:151], v[48:63]
    ds_read_b128 v[164:167], v191 offset:8192
    ds_read_b128 v[168:171], v191 offset:12288
    s_waitcnt lgkmcnt(9)
    v_mfma_f32_32x32x16_bf16 v[64:79], v[136:139], v[144:147], v[64:79]
    v_mfma_f32_32x32x16_bf16 v[80:95], v[136:139], v[148:151], v[80:95]
    s_waitcnt lgkmcnt(8)
    v_mfma_f32_32x32x16_bf16 v[96:111], v[140:143], v[144:147], v[96:111]
    v_mfma_f32_32x32x16_bf16 v[112:127], v[140:143], v[148:151], v[112:127]
    s_waitcnt lgkmcnt(0)
    s_waitcnt vmcnt(5)
    s_barrier
    v_mfma_f32_32x32x16_bf16 v[0:15], v[156:159], v[172:175], v[0:15]
    ds_read_b64_tr_b16 v[144:145], v192 offset:0
    ds_read_b64_tr_b16 v[146:147], v192 offset:512
    s_add_u32 m0, s44, 65536
    s_add_u32 s48, s40, 640
    buffer_load_dwordx4 v196, s[8:11], s48 offen lds
    v_mfma_f32_32x32x16_bf16 v[16:31], v[156:159], v[176:179], v[16:31]
    ds_read_b128 v[128:131], v184 offset:0
    ds_read_b64_tr_b16 v[148:149], v193 offset:0
    s_add_u32 m0, s44, 66560
    s_add_u32 s48, s40, 8832
    buffer_load_dwordx4 v197, s[8:11], s48 offen lds
    v_mfma_f32_32x32x16_bf16 v[32:47], v[160:163], v[172:175], v[32:47]
    ds_read_b64_tr_b16 v[150:151], v193 offset:512
    ds_read_b128 v[132:135], v184 offset:4096
    s_add_u32 m0, s44, 67584
    s_add_u32 s48, s40, 17024
    buffer_load_dwordx4 v196, s[8:11], s48 offen lds
    v_mfma_f32_32x32x16_bf16 v[48:63], v[160:163], v[176:179], v[48:63]
    ds_read_b128 v[136:139], v184 offset:8192
    ds_read_b128 v[140:143], v184 offset:12288
    s_add_u32 m0, s44, 68608
    s_add_u32 s48, s40, 25216
    buffer_load_dwordx4 v197, s[8:11], s48 offen lds
    v_mfma_f32_32x32x16_bf16 v[64:79], v[164:167], v[172:175], v[64:79]
    s_add_u32 m0, s44, 98304
    s_add_u32 s48, s41, 2621440
    buffer_load_dwordx4 v198, s[16:19], s48 offen lds
    v_mfma_f32_32x32x16_bf16 v[80:95], v[164:167], v[176:179], v[80:95]
    s_add_u32 m0, s44, 99328
    s_add_u32 s48, s41, 2686976
    buffer_load_dwordx4 v198, s[16:19], s48 offen lds
    v_mfma_f32_32x32x16_bf16 v[96:111], v[168:171], v[172:175], v[96:111]
    s_add_u32 m0, s44, 100352
    s_add_u32 s48, s41, 2752512
    buffer_load_dwordx4 v198, s[16:19], s48 offen lds
    v_mfma_f32_32x32x16_bf16 v[112:127], v[168:171], v[176:179], v[112:127]
    s_add_u32 m0, s44, 101376
    s_add_u32 s48, s41, 2818048
    buffer_load_dwordx4 v198, s[16:19], s48 offen lds
    s_waitcnt lgkmcnt(5)
    v_mfma_f32_32x32x16_bf16 v[0:15], v[128:131], v[144:147], v[0:15]
    ds_read_b64_tr_b16 v[172:173], v192 offset:2048
    ds_read_b64_tr_b16 v[174:175], v192 offset:2560
    s_cmp_eq_u32 s36, 7
    s_cselect_b32 s68, s95, 0x40000000
    buffer_load_dword v254, v250, s[8:11], s68 offen
    s_waitcnt lgkmcnt(5)
    v_mfma_f32_32x32x16_bf16 v[16:31], v[128:131], v[148:151], v[16:31]
    ds_read_b128 v[156:159], v185 offset:0
    ds_read_b64_tr_b16 v[176:177], v193 offset:2048
    s_cmp_eq_u32 s99, 7
    s_cselect_b32 s68, s96, 0x40000000
    buffer_load_dword v254, v251, s[16:19], s68 offen
    s_waitcnt lgkmcnt(6)
    v_mfma_f32_32x32x16_bf16 v[32:47], v[132:135], v[144:147], v[32:47]
    ds_read_b64_tr_b16 v[178:179], v193 offset:2560
    ds_read_b128 v[160:163], v185 offset:4096
    s_cmp_eq_u32 s36, 1
    s_cselect_b32 s68, s95, 0x40000000
    buffer_load_dword v254, v250, s[12:15], s68 offen
    v_mfma_f32_32x32x16_bf16 v[48:63], v[132:135], v[148:151], v[48:63]
    ds_read_b128 v[164:167], v185 offset:8192
    ds_read_b128 v[168:171], v185 offset:12288
    s_cmp_eq_u32 s99, 1
    s_cselect_b32 s68, s97, 0x40000000
    buffer_load_dword v254, v215, s[20:23], s68 offen
    s_waitcnt lgkmcnt(9)
    v_mfma_f32_32x32x16_bf16 v[64:79], v[136:139], v[144:147], v[64:79]
    s_cmp_eq_u32 s99, 1
    s_cselect_b32 s68, s98, 0x40000000
    buffer_load_dword v254, v216, s[24:27], s68 offen
    v_mfma_f32_32x32x16_bf16 v[80:95], v[136:139], v[148:151], v[80:95]
    s_cmp_eq_u32 s36, 2
    s_cselect_b32 s68, s95, 0x40000000
    buffer_load_dword v254, v250, s[12:15], s68 offen
    s_waitcnt lgkmcnt(8)
    v_mfma_f32_32x32x16_bf16 v[96:111], v[140:143], v[144:147], v[96:111]
    s_cmp_eq_u32 s99, 2
    s_cselect_b32 s68, s97, 0x40000000
    buffer_load_dword v254, v215, s[20:23], s68 offen
    v_mfma_f32_32x32x16_bf16 v[112:127], v[140:143], v[148:151], v[112:127]
    s_cmp_eq_u32 s99, 2
    s_cselect_b32 s68, s98, 0x40000000
    buffer_load_dword v254, v216, s[24:27], s68 offen
    s_waitcnt lgkmcnt(5)
    v_mfma_f32_32x32x16_bf16 v[0:15], v[156:159], v[172:175], v[0:15]
    ds_read_b64_tr_b16 v[144:145], v192 offset:4096
    ds_read_b64_tr_b16 v[146:147], v192 offset:4608
    s_waitcnt lgkmcnt(5)
    v_mfma_f32_32x32x16_bf16 v[16:31], v[156:159], v[176:179], v[16:31]
    ds_read_b128 v[128:131], v186 offset:0
    ds_read_b64_tr_b16 v[148:149], v193 offset:4096
    s_waitcnt lgkmcnt(6)
    v_mfma_f32_32x32x16_bf16 v[32:47], v[160:163], v[172:175], v[32:47]
    ds_read_b64_tr_b16 v[150:151], v193 offset:4608
    ds_read_b128 v[132:135], v186 offset:4096
    v_mfma_f32_32x32x16_bf16 v[48:63], v[160:163], v[176:179], v[48:63]
    ds_read_b128 v[136:139], v186 offset:8192
    ds_read_b128 v[140:143], v186 offset:12288
    s_waitcnt lgkmcnt(9)
    v_mfma_f32_32x32x16_bf16 v[64:79], v[164:167], v[172:175], v[64:79]
    v_mfma_f32_32x32x16_bf16 v[80:95], v[164:167], v[176:179], v[80:95]
    s_waitcnt lgkmcnt(8)
    v_mfma_f32_32x32x16_bf16 v[96:111], v[168:171], v[172:175], v[96:111]
    v_mfma_f32_32x32x16_bf16 v[112:127], v[168:171], v[176:179], v[112:127]
    s_waitcnt lgkmcnt(5)
    v_mfma_f32_32x32x16_bf16 v[0:15], v[128:131], v[144:147], v[0:15]
    ds_read_b64_tr_b16 v[172:173], v192 offset:6144
    ds_read_b64_tr_b16 v[174:175], v192 offset:6656
    s_waitcnt lgkmcnt(5)
    v_mfma_f32_32x32x16_bf16 v[16:31], v[128:131], v[148:151], v[16:31]
    ds_read_b128 v[156:159], v187 offset:0
    ds_read_b64_tr_b16 v[176:177], v193 offset:6144
    s_waitcnt lgkmcnt(6)
    v_mfma_f32_32x32x16_bf16 v[32:47], v[132:135], v[144:147], v[32:47]
    ds_read_b64_tr_b16 v[178:179], v193 offset:6656
    ds_read_b128 v[160:163], v187 offset:4096
    v_mfma_f32_32x32x16_bf16 v[48:63], v[132:135], v[148:151], v[48:63]
    ds_read_b128 v[164:167], v187 offset:8192
    ds_read_b128 v[168:171], v187 offset:12288
    s_waitcnt lgkmcnt(9)
    v_mfma_f32_32x32x16_bf16 v[64:79], v[136:139], v[144:147], v[64:79]
    v_mfma_f32_32x32x16_bf16 v[80:95], v[136:139], v[148:151], v[80:95]
    s_waitcnt lgkmcnt(8)
    v_mfma_f32_32x32x16_bf16 v[96:111], v[140:143], v[144:147], v[96:111]
    v_mfma_f32_32x32x16_bf16 v[112:127], v[140:143], v[148:151], v[112:127]
    s_waitcnt lgkmcnt(0)
    s_waitcnt vmcnt(8)
    s_barrier
    v_mfma_f32_32x32x16_bf16 v[0:15], v[156:159], v[172:175], v[0:15]
    ds_read_b64_tr_b16 v[144:145], v194 offset:0
    ds_read_b64_tr_b16 v[146:147], v194 offset:512
    s_add_u32 m0, s44, 0
    s_add_u32 s48, s40, 768
    buffer_load_dwordx4 v196, s[8:11], s48 offen lds
    v_mfma_f32_32x32x16_bf16 v[16:31], v[156:159], v[176:179], v[16:31]
    ds_read_b128 v[128:131], v188 offset:0
    ds_read_b64_tr_b16 v[148:149], v195 offset:0
    s_add_u32 m0, s44, 1024
    s_add_u32 s48, s40, 8960
    buffer_load_dwordx4 v197, s[8:11], s48 offen lds
    v_mfma_f32_32x32x16_bf16 v[32:47], v[160:163], v[172:175], v[32:47]
    ds_read_b64_tr_b16 v[150:151], v195 offset:512
    ds_read_b128 v[132:135], v188 offset:4096
    s_add_u32 m0, s44, 2048
    s_add_u32 s48, s40, 17152
    buffer_load_dwordx4 v196, s[8:11], s48 offen lds
    v_mfma_f32_32x32x16_bf16 v[48:63], v[160:163], v[176:179], v[48:63]
    ds_read_b128 v[136:139], v188 offset:8192
    ds_read_b128 v[140:143], v188 offset:12288
    s_add_u32 m0, s44, 3072
    s_add_u32 s48, s40, 25344
    buffer_load_dwordx4 v197, s[8:11], s48 offen lds
    v_mfma_f32_32x32x16_bf16 v[64:79], v[164:167], v[172:175], v[64:79]
    s_add_u32 m0, s44, 32768
    s_add_u32 s48, s41, 3145728
    buffer_load_dwordx4 v198, s[16:19], s48 offen lds
    v_mfma_f32_32x32x16_bf16 v[80:95], v[164:167], v[176:179], v[80:95]
    s_add_u32 m0, s44, 33792
    s_add_u32 s48, s41, 3211264
    buffer_load_dwordx4 v198, s[16:19], s48 offen lds
    v_mfma_f32_32x32x16_bf16 v[96:111], v[168:171], v[172:175], v[96:111]
    s_add_u32 m0, s44, 34816
    s_add_u32 s48, s41, 3276800
    buffer_load_dwordx4 v198, s[16:19], s48 offen lds
    v_mfma_f32_32x32x16_bf16 v[112:127], v[168:171], v[176:179], v[112:127]
    s_add_u32 m0, s44, 35840
    s_add_u32 s48, s41, 3342336
    buffer_load_dwordx4 v198, s[16:19], s48 offen lds
    s_waitcnt lgkmcnt(5)
    v_mfma_f32_32x32x16_bf16 v[0:15], v[128:131], v[144:147], v[0:15]
    ds_read_b64_tr_b16 v[172:173], v194 offset:2048
    ds_read_b64_tr_b16 v[174:175], v194 offset:2560
    s_cmp_eq_u32 s36, 3
    s_cselect_b32 s68, s95, 0x40000000
    buffer_load_dword v254, v250, s[12:15], s68 offen
    s_waitcnt lgkmcnt(5)
    v_mfma_f32_32x32x16_bf16 v[16:31], v[128:131], v[148:151], v[16:31]
    ds_read_b128 v[156:159], v189 offset:0
    ds_read_b64_tr_b16 v[176:177], v195 offset:2048
    s_cmp_eq_u32 s99, 3
    s_cselect_b32 s68, s97, 0x40000000
    buffer_load_dword v254, v215, s[20:23], s68 offen
    s_waitcnt lgkmcnt(6)
    v_mfma_f32_32x32x16_bf16 v[32:47], v[132:135], v[144:147], v[32:47]
    ds_read_b64_tr_b16 v[178:179], v195 offset:2560
    ds_read_b128 v[160:163], v189 offset:4096
    s_cmp_eq_u32 s99, 3
    s_cselect_b32 s68, s98, 0x40000000
    buffer_load_dword v254, v216, s[24:27], s68 offen
    v_mfma_f32_32x32x16_bf16 v[48:63], v[132:135], v[148:151], v[48:63]
    ds_read_b128 v[164:167], v189 offset:8192
    ds_read_b128 v[168:171], v189 offset:12288
    s_cmp_eq_u32 s36, 4
    s_cselect_b32 s68, s95, 0x40000000
    buffer_load_dword v254, v250, s[12:15], s68 offen
    s_waitcnt lgkmcnt(9)
    v_mfma_f32_32x32x16_bf16 v[64:79], v[136:139], v[144:147], v[64:79]
    s_cmp_eq_u32 s99, 4
    s_cselect_b32 s68, s97, 0x40000000
    buffer_load_dword v254, v215, s[20:23], s68 offen
    v_mfma_f32_32x32x16_bf16 v[80:95], v[136:139], v[148:151], v[80:95]
    s_cmp_eq_u32 s99, 4
    s_cselect_b32 s68, s98, 0x40000000
    buffer_load_dword v254, v216, s[24:27], s68 offen
    s_waitcnt lgkmcnt(8)
    v_mfma_f32_32x32x16_bf16 v[96:111], v[140:143], v[144:147], v[96:111]
    v_mfma_f32_32x32x16_bf16 v[112:127], v[140:143], v[148:151], v[112:127]
    s_waitcnt lgkmcnt(5)
    v_mfma_f32_32x32x16_bf16 v[0:15], v[156:159], v[172:175], v[0:15]
    ds_read_b64_tr_b16 v[144:145], v194 offset:4096
    ds_read_b64_tr_b16 v[146:147], v194 offset:4608
    s_waitcnt lgkmcnt(5)
    v_mfma_f32_32x32x16_bf16 v[16:31], v[156:159], v[176:179], v[16:31]
    ds_read_b128 v[128:131], v190 offset:0
    ds_read_b64_tr_b16 v[148:149], v195 offset:4096
    s_waitcnt lgkmcnt(6)
    v_mfma_f32_32x32x16_bf16 v[32:47], v[160:163], v[172:175], v[32:47]
    ds_read_b64_tr_b16 v[150:151], v195 offset:4608
    ds_read_b128 v[132:135], v190 offset:4096
    v_mfma_f32_32x32x16_bf16 v[48:63], v[160:163], v[176:179], v[48:63]
    ds_read_b128 v[136:139], v190 offset:8192
    ds_read_b128 v[140:143], v190 offset:12288
    s_waitcnt lgkmcnt(9)
    v_mfma_f32_32x32x16_bf16 v[64:79], v[164:167], v[172:175], v[64:79]
    v_mfma_f32_32x32x16_bf16 v[80:95], v[164:167], v[176:179], v[80:95]
    s_waitcnt lgkmcnt(8)
    v_mfma_f32_32x32x16_bf16 v[96:111], v[168:171], v[172:175], v[96:111]
    v_mfma_f32_32x32x16_bf16 v[112:127], v[168:171], v[176:179], v[112:127]
    s_waitcnt lgkmcnt(5)
    v_mfma_f32_32x32x16_bf16 v[0:15], v[128:131], v[144:147], v[0:15]
    ds_read_b64_tr_b16 v[172:173], v194 offset:6144
    ds_read_b64_tr_b16 v[174:175], v194 offset:6656
    s_waitcnt lgkmcnt(5)
    v_mfma_f32_32x32x16_bf16 v[16:31], v[128:131], v[148:151], v[16:31]
    ds_read_b128 v[156:159], v191 offset:0
    ds_read_b64_tr_b16 v[176:177], v195 offset:6144
    s_waitcnt lgkmcnt(6)
    v_mfma_f32_32x32x16_bf16 v[32:47], v[132:135], v[144:147], v[32:47]
    ds_read_b64_tr_b16 v[178:179], v195 offset:6656
    ds_read_b128 v[160:163], v191 offset:4096
    v_mfma_f32_32x32x16_bf16 v[48:63], v[132:135], v[148:151], v[48:63]
    ds_read_b128 v[164:167], v191 offset:8192
    ds_read_b128 v[168:171], v191 offset:12288
    s_waitcnt lgkmcnt(9)
    v_mfma_f32_32x32x16_bf16 v[64:79], v[136:139], v[144:147], v[64:79]
    v_mfma_f32_32x32x16_bf16 v[80:95], v[136:139], v[148:151], v[80:95]
    s_waitcnt lgkmcnt(8)
    v_mfma_f32_32x32x16_bf16 v[96:111], v[140:143], v[144:147], v[96:111]
    v_mfma_f32_32x32x16_bf16 v[112:127], v[140:143], v[148:151], v[112:127]
    s_waitcnt lgkmcnt(0)
    s_waitcnt vmcnt(6)
    s_barrier
    v_mfma_f32_32x32x16_bf16 v[0:15], v[156:159], v[172:175], v[0:15]
    ds_read_b64_tr_b16 v[144:145], v192 offset:0
    ds_read_b64_tr_b16 v[146:147], v192 offset:512
    s_add_u32 m0, s44, 65536
    s_add_u32 s48, s40, 896
    buffer_load_dwordx4 v196, s[8:11], s48 offen lds
    v_mfma_f32_32x32x16_bf16 v[16:31], v[156:159], v[176:179], v[16:31]
    ds_read_b128 v[128:131], v184 offset:0
    ds_read_b64_tr_b16 v[148:149], v193 offset:0
    s_add_u32 m0, s44, 66560
    s_add_u32 s48, s40, 9088
    buffer_load_dwordx4 v197, s[8:11], s48 offen lds
    v_mfma_f32_32x32x16_bf16 v[32:47], v[160:163], v[172:175], v[32:47]
    ds_read_b64_tr_b16 v[150:151], v193 offset:512
    ds_read_b128 v[132:135], v184 offset:4096
    s_add_u32 m0, s44, 67584
    s_add_u32 s48, s40, 17280
    buffer_load_dwordx4 v196, s[8:11], s48 offen lds
    v_mfma_f32_32x32x16_bf16 v[48:63], v[160:163], v[176:179], v[48:63]
    ds_read_b128 v[136:139], v184 offset:8192
    ds_read_b128 v[140:143], v184 offset:12288
    s_add_u32 m0, s44, 68608
    s_add_u32 s48, s40, 25472
    buffer_load_dwordx4 v197, s[8:11], s48 offen lds
    v_mfma_f32_32x32x16_bf16 v[64:79], v[164:167], v[172:175], v[64:79]
    s_add_u32 m0, s44, 98304
    s_add_u32 s48, s41, 3670016
    buffer_load_dwordx4 v198, s[16:19], s48 offen lds
    v_mfma_f32_32x32x16_bf16 v[80:95], v[164:167], v[176:179], v[80:95]
    s_add_u32 m0, s44, 99328
    s_add_u32 s48, s41, 3735552
    buffer_load_dwordx4 v198, s[16:19], s48 offen lds
    v_mfma_f32_32x32x16_bf16 v[96:111], v[168:171], v[172:175], v[96:111]
    s_add_u32 m0, s44, 100352
    s_add_u32 s48, s41, 3801088
    buffer_load_dwordx4 v198, s[16:19], s48 offen lds
    v_mfma_f32_32x32x16_bf16 v[112:127], v[168:171], v[176:179], v[112:127]
    s_add_u32 m0, s44, 101376
    s_add_u32 s48, s41, 3866624
    buffer_load_dwordx4 v198, s[16:19], s48 offen lds
    s_waitcnt lgkmcnt(5)
    v_mfma_f32_32x32x16_bf16 v[0:15], v[128:131], v[144:147], v[0:15]
    ds_read_b64_tr_b16 v[172:173], v192 offset:2048
    ds_read_b64_tr_b16 v[174:175], v192 offset:2560
    s_cmp_eq_u32 s36, 5
    s_cselect_b32 s68, s95, 0x40000000
    buffer_load_dword v254, v250, s[12:15], s68 offen
    s_waitcnt lgkmcnt(5)
    v_mfma_f32_32x32x16_bf16 v[16:31], v[128:131], v[148:151], v[16:31]
    ds_read_b128 v[156:159], v185 offset:0
    ds_read_b64_tr_b16 v[176:177], v193 offset:2048
    s_cmp_eq_u32 s99, 5
    s_cselect_b32 s68, s97, 0x40000000
    buffer_load_dword v254, v215, s[20:23], s68 offen
    s_waitcnt lgkmcnt(6)
    v_mfma_f32_32x32x16_bf16 v[32:47], v[132:135], v[144:147], v[32:47]
    ds_read_b64_tr_b16 v[178:179], v193 offset:2560
    ds_read_b128 v[160:163], v185 offset:4096
    s_cmp_eq_u32 s99, 5
    s_cselect_b32 s68, s98, 0x40000000
    buffer_load_dword v254, v216, s[24:27], s68 offen
    v_mfma_f32_32x32x16_bf16 v[48:63], v[132:135], v[148:151], v[48:63]
    ds_read_b128 v[164:167], v185 offset:8192
    ds_read_b128 v[168:171], v185 offset:12288
    s_cmp_eq_u32 s36, 6
    s_cselect_b32 s68, s95, 0x40000000
    buffer_load_dword v254, v250, s[12:15], s68 offen
    s_waitcnt lgkmcnt(9)
    v_mfma_f32_32x32x16_bf16 v[64:79], v[136:139], v[144:147], v[64:79]
    s_cmp_eq_u32 s99, 6
    s_cselect_b32 s68, s97, 0x40000000
    buffer_load_dword v254, v215, s[20:23], s68 offen
    v_mfma_f32_32x32x16_bf16 v[80:95], v[136:139], v[148:151], v[80:95]
    s_cmp_eq_u32 s99, 6
    s_cselect_b32 s68, s98, 0x40000000
    buffer_load_dword v254, v216, s[24:27], s68 offen
    s_waitcnt lgkmcnt(8)
    v_mfma_f32_32x32x16_bf16 v[96:111], v[140:143], v[144:147], v[96:111]
    v_mfma_f32_32x32x16_bf16 v[112:127], v[140:143], v[148:151], v[112:127]
    s_waitcnt lgkmcnt(5)
    v_mfma_f32_32x32x16_bf16 v[0:15], v[156:159], v[172:175], v[0:15]
    ds_read_b64_tr_b16 v[144:145], v192 offset:4096
    ds_read_b64_tr_b16 v[146:147], v192 offset:4608
    s_waitcnt lgkmcnt(5)
    v_mfma_f32_32x32x16_bf16 v[16:31], v[156:159], v[176:179], v[16:31]
    ds_read_b128 v[128:131], v186 offset:0
    ds_read_b64_tr_b16 v[148:149], v193 offset:4096
    s_waitcnt lgkmcnt(6)
    v_mfma_f32_32x32x16_bf16 v[32:47], v[160:163], v[172:175], v[32:47]
    ds_read_b64_tr_b16 v[150:151], v193 offset:4608
    ds_read_b128 v[132:135], v186 offset:4096
    v_mfma_f32_32x32x16_bf16 v[48:63], v[160:163], v[176:179], v[48:63]
    ds_read_b128 v[136:139], v186 offset:8192
    ds_read_b128 v[140:143], v186 offset:12288
    s_waitcnt lgkmcnt(9)
    v_mfma_f32_32x32x16_bf16 v[64:79], v[164:167], v[172:175], v[64:79]
    v_mfma_f32_32x32x16_bf16 v[80:95], v[164:167], v[176:179], v[80:95]
    s_waitcnt lgkmcnt(8)
    v_mfma_f32_32x32x16_bf16 v[96:111], v[168:171], v[172:175], v[96:111]
    v_mfma_f32_32x32x16_bf16 v[112:127], v[168:171], v[176:179], v[112:127]
    s_waitcnt lgkmcnt(5)
    v_mfma_f32_32x32x16_bf16 v[0:15], v[128:131], v[144:147], v[0:15]
    ds_read_b64_tr_b16 v[172:173], v192 offset:6144
    ds_read_b64_tr_b16 v[174:175], v192 offset:6656
    s_waitcnt lgkmcnt(5)
    v_mfma_f32_32x32x16_bf16 v[16:31], v[128:131], v[148:151], v[16:31]
    ds_read_b128 v[156:159], v187 offset:0
    ds_read_b64_tr_b16 v[176:177], v193 offset:6144
    s_waitcnt lgkmcnt(6)
    v_mfma_f32_32x32x16_bf16 v[32:47], v[132:135], v[144:147], v[32:47]
    ds_read_b64_tr_b16 v[178:179], v193 offset:6656
    ds_read_b128 v[160:163], v187 offset:4096
    v_mfma_f32_32x32x16_bf16 v[48:63], v[132:135], v[148:151], v[48:63]
    ds_read_b128 v[164:167], v187 offset:8192
    ds_read_b128 v[168:171], v187 offset:12288
    s_waitcnt lgkmcnt(9)
    v_mfma_f32_32x32x16_bf16 v[64:79], v[136:139], v[144:147], v[64:79]
    v_mfma_f32_32x32x16_bf16 v[80:95], v[136:139], v[148:151], v[80:95]
    s_waitcnt lgkmcnt(8)
    v_mfma_f32_32x32x16_bf16 v[96:111], v[140:143], v[144:147], v[96:111]
    v_mfma_f32_32x32x16_bf16 v[112:127], v[140:143], v[148:151], v[112:127]
    s_waitcnt lgkmcnt(0)
    s_waitcnt vmcnt(6)
    s_barrier
    v_mfma_f32_32x32x16_bf16 v[0:15], v[156:159], v[172:175], v[0:15]
    ds_read_b64_tr_b16 v[144:145], v194 offset:0
    ds_read_b64_tr_b16 v[146:147], v194 offset:512
    s_add_u32 m0, s44, 0
    s_add_u32 s48, s3, 0
    buffer_load_dwordx4 v196, s[12:15], s48 offen lds
    v_mfma_f32_32x32x16_bf16 v[16:31], v[156:159], v[176:179], v[16:31]
    ds_read_b128 v[128:131], v188 offset:0
    ds_read_b64_tr_b16 v[148:149], v195 offset:0
    s_add_u32 m0, s44, 1024
    s_add_u32 s48, s3, 8192
    buffer_load_dwordx4 v197, s[12:15], s48 offen lds
    v_mfma_f32_32x32x16_bf16 v[32:47], v[160:163], v[172:175], v[32:47]
    ds_read_b64_tr_b16 v[150:151], v195 offset:512
    ds_read_b128 v[132:135], v188 offset:4096
    s_add_u32 m0, s44, 2048
    s_add_u32 s48, s3, 16384
    buffer_load_dwordx4 v196, s[12:15], s48 offen lds
    v_mfma_f32_32x32x16_bf16 v[48:63], v[160:163], v[176:179], v[48:63]
    ds_read_b128 v[136:139], v188 offset:8192
    ds_read_b128 v[140:143], v188 offset:12288
    s_add_u32 m0, s44, 3072
    s_add_u32 s48, s3, 24576
    buffer_load_dwordx4 v197, s[12:15], s48 offen lds
    v_mfma_f32_32x32x16_bf16 v[64:79], v[164:167], v[172:175], v[64:79]
    s_add_u32 m0, s45, 32768
    s_add_u32 s48, s42, 0
    buffer_load_dwordx4 v198, s[20:23], s48 offen lds
    v_mfma_f32_32x32x16_bf16 v[80:95], v[164:167], v[176:179], v[80:95]
    s_add_u32 m0, s45, 33792
    s_add_u32 s48, s42, 65536
    buffer_load_dwordx4 v198, s[20:23], s48 offen lds
    v_mfma_f32_32x32x16_bf16 v[96:111], v[168:171], v[172:175], v[96:111]
    s_add_u32 m0, s46, 49152
    s_add_u32 s48, s43, 0
    buffer_load_dwordx4 v199, s[24:27], s48 offen lds
    v_mfma_f32_32x32x16_bf16 v[112:127], v[168:171], v[176:179], v[112:127]
    s_waitcnt lgkmcnt(5)
    v_mfma_f32_32x32x16_bf16 v[0:15], v[128:131], v[144:147], v[0:15]
    ds_read_b64_tr_b16 v[172:173], v194 offset:2048
    ds_read_b64_tr_b16 v[174:175], v194 offset:2560
    s_cmp_eq_u32 s36, 7
    s_cselect_b32 s68, s95, 0x40000000
    buffer_load_dword v254, v250, s[12:15], s68 offen
    s_waitcnt lgkmcnt(5)
    v_mfma_f32_32x32x16_bf16 v[16:31], v[128:131], v[148:151], v[16:31]
    ds_read_b128 v[156:159], v189 offset:0
    ds_read_b64_tr_b16 v[176:177], v195 offset:2048
    s_cmp_eq_u32 s99, 7
    s_cselect_b32 s68, s97, 0x40000000
    buffer_load_dword v254, v215, s[20:23], s68 offen
    s_waitcnt lgkmcnt(6)
    v_mfma_f32_32x32x16_bf16 v[32:47], v[132:135], v[144:147], v[32:47]
    ds_read_b64_tr_b16 v[178:179], v195 offset:2560
    ds_read_b128 v[160:163], v189 offset:4096
    s_cmp_eq_u32 s99, 7
    s_cselect_b32 s68, s98, 0x40000000
    buffer_load_dword v254, v216, s[24:27], s68 offen
    v_mfma_f32_32x32x16_bf16 v[48:63], v[132:135], v[148:151], v[48:63]
    ds_read_b128 v[164:167], v189 offset:8192
    ds_read_b128 v[168:171], v189 offset:12288
    s_waitcnt lgkmcnt(9)
    v_mfma_f32_32x32x16_bf16 v[64:79], v[136:139], v[144:147], v[64:79]
    v_mfma_f32_32x32x16_bf16 v[80:95], v[136:139], v[148:151], v[80:95]
    s_waitcnt lgkmcnt(8)
    v_mfma_f32_32x32x16_bf16 v[96:111], v[140:143], v[144:147], v[96:111]
    v_mfma_f32_32x32x16_bf16 v[112:127], v[140:143], v[148:151], v[112:127]
    s_waitcnt lgkmcnt(5)
    v_mfma_f32_32x32x16_bf16 v[0:15], v[156:159], v[172:175], v[0:15]
    ds_read_b64_tr_b16 v[144:145], v194 offset:4096
    ds_read_b64_tr_b16 v[146:147], v194 offset:4608
    s_waitcnt lgkmcnt(5)
    v_mfma_f32_32x32x16_bf16 v[16:31], v[156:159], v[176:179], v[16:31]
    ds_read_b128 v[128:131], v190 offset:0
    ds_read_b64_tr_b16 v[148:149], v195 offset:4096
    s_waitcnt lgkmcnt(6)
    v_mfma_f32_32x32x16_bf16 v[32:47], v[160:163], v[172:175], v[32:47]
    ds_read_b64_tr_b16 v[150:151], v195 offset:4608
    ds_read_b128 v[132:135], v190 offset:4096
    v_mfma_f32_32x32x16_bf16 v[48:63], v[160:163], v[176:179], v[48:63]
    ds_read_b128 v[136:139], v190 offset:8192
    ds_read_b128 v[140:143], v190 offset:12288
    s_waitcnt lgkmcnt(9)
    v_mfma_f32_32x32x16_bf16 v[64:79], v[164:167], v[172:175], v[64:79]
    v_mfma_f32_32x32x16_bf16 v[80:95], v[164:167], v[176:179], v[80:95]
    s_waitcnt lgkmcnt(8)
    v_mfma_f32_32x32x16_bf16 v[96:111], v[168:171], v[172:175], v[96:111]
    v_mfma_f32_32x32x16_bf16 v[112:127], v[168:171], v[176:179], v[112:127]
    s_waitcnt lgkmcnt(5)
    v_mfma_f32_32x32x16_bf16 v[0:15], v[128:131], v[144:147], v[0:15]
    ds_read_b64_tr_b16 v[172:173], v194 offset:6144
    ds_read_b64_tr_b16 v[174:175], v194 offset:6656
    s_waitcnt lgkmcnt(5)
    v_mfma_f32_32x32x16_bf16 v[16:31], v[128:131], v[148:151], v[16:31]
    ds_read_b128 v[156:159], v191 offset:0
    ds_read_b64_tr_b16 v[176:177], v195 offset:6144
    s_waitcnt lgkmcnt(6)
    v_mfma_f32_32x32x16_bf16 v[32:47], v[132:135], v[144:147], v[32:47]
    ds_read_b64_tr_b16 v[178:179], v195 offset:6656
    ds_read_b128 v[160:163], v191 offset:4096
    v_mfma_f32_32x32x16_bf16 v[48:63], v[132:135], v[148:151], v[48:63]
    ds_read_b128 v[164:167], v191 offset:8192
    ds_read_b128 v[168:171], v191 offset:12288
    s_waitcnt lgkmcnt(9)
    v_mfma_f32_32x32x16_bf16 v[64:79], v[136:139], v[144:147], v[64:79]
    v_mfma_f32_32x32x16_bf16 v[80:95], v[136:139], v[148:151], v[80:95]
    s_waitcnt lgkmcnt(8)
    v_mfma_f32_32x32x16_bf16 v[96:111], v[140:143], v[144:147], v[96:111]
    v_mfma_f32_32x32x16_bf16 v[112:127], v[140:143], v[148:151], v[112:127]
    s_waitcnt lgkmcnt(0)
    s_waitcnt vmcnt(3)
    s_barrier
    v_mfma_f32_32x32x16_bf16 v[0:15], v[156:159], v[172:175], v[0:15]
    s_add_u32 m0, s44, 65536
    s_add_u32 s48, s3, 128
    buffer_load_dwordx4 v196, s[12:15], s48 offen lds
    v_mfma_f32_32x32x16_bf16 v[16:31], v[156:159], v[176:179], v[16:31]
    s_add_u32 m0, s44, 66560
    s_add_u32 s48, s3, 8320
    buffer_load_dwordx4 v197, s[12:15], s48 offen lds
    v_mfma_f32_32x32x16_bf16 v[32:47], v[160:163], v[172:175], v[32:47]
    s_add_u32 m0, s44, 67584
    s_add_u32 s48, s3, 16512
    buffer_load_dwordx4 v196, s[12:15], s48 offen lds
    v_mfma_f32_32x32x16_bf16 v[48:63], v[160:163], v[176:179], v[48:63]
    s_add_u32 m0, s44, 68608
    s_add_u32 s48, s3, 24704
    buffer_load_dwordx4 v197, s[12:15], s48 offen lds
    v_mfma_f32_32x32x16_bf16 v[64:79], v[164:167], v[172:175], v[64:79]
    s_add_u32 m0, s45, 98304
    s_add_u32 s48, s42, 524288
    buffer_load_dwordx4 v198, s[20:23], s48 offen lds
    v_mfma_f32_32x32x16_bf16 v[80:95], v[164:167], v[176:179], v[80:95]
    s_add_u32 m0, s45, 99328
    s_add_u32 s48, s42, 589824
    buffer_load_dwordx4 v198, s[20:23], s48 offen lds
    v_mfma_f32_32x32x16_bf16 v[96:111], v[168:171], v[172:175], v[96:111]
    s_add_u32 m0, s46, 114688
    s_add_u32 s48, s43, 196608
    buffer_load_dwordx4 v199, s[24:27], s48 offen lds
    v_mfma_f32_32x32x16_bf16 v[112:127], v[168:171], v[176:179], v[112:127]
f_p2:
    s_sub_u32 s48, s44, s52
    s_sub_u32 s49, 32768, s53
    v_add_u32 v184, s48, v184
    v_add_u32 v185, s48, v185
    v_add_u32 v186, s48, v186
    v_add_u32 v187, s48, v187
    v_add_u32 v188, s48, v188
    v_add_u32 v189, s48, v189
    v_add_u32 v190, s48, v190
    v_add_u32 v191, s48, v191
    v_add_u32 v192, s49, v192
    v_add_u32 v193, s49, v193
    v_add_u32 v194, s49, v194
    v_add_u32 v195, s49, v195
    ds_read_b128 v[128:131], v184
    ds_read_b64_tr_b16 v[132:133], v192 offset:0
    ds_read_b64_tr_b16 v[134:135], v192 offset:512
    ds_read_b64_tr_b16 v[136:137], v193 offset:0
    ds_read_b64_tr_b16 v[138:139], v193 offset:512
    ds_read_b128 v[204:207], v202 offset:0
    ds_read_b64_tr_b16 v[140:141], v192 offset:8192
    ds_read_b64_tr_b16 v[142:143], v192 offset:8704
    ds_read_b64_tr_b16 v[144:145], v193 offset:8192
    ds_read_b64_tr_b16 v[146:147], v193 offset:8704
    ds_read_b64_tr_b16 v[148:149], v192 offset:16384
    ds_read_b64_tr_b16 v[150:151], v192 offset:16896
    ds_read_b64_tr_b16 v[152:153], v193 offset:16384
    ds_read_b64_tr_b16 v[154:155], v193 offset:16896
    s_nop 3
    v_cvt_pk_bf16_f32 v218, v96, v97
    v_cvt_pk_bf16_f32 v219, v98, v99
    v_cvt_pk_bf16_f32 v220, v100, v101
    v_cvt_pk_bf16_f32 v221, v102, v103
    v_cvt_pk_bf16_f32 v222, v104, v105
    v_cvt_pk_bf16_f32 v223, v106, v107
    v_cvt_pk_bf16_f32 v224, v108, v109
    v_cvt_pk_bf16_f32 v225, v110, v111
    v_cvt_pk_bf16_f32 v226, v112, v113
    v_cvt_pk_bf16_f32 v227, v114, v115
    v_cvt_pk_bf16_f32 v228, v116, v117
    v_cvt_pk_bf16_f32 v229, v118, v119
    v_cvt_pk_bf16_f32 v230, v120, v121
    v_cvt_pk_bf16_f32 v231, v122, v123
    v_cvt_pk_bf16_f32 v232, v124, v125
    v_cvt_pk_bf16_f32 v233, v126, v127
    v_cvt_pk_bf16_f32 v234, v0, v1
    v_cvt_pk_bf16_f32 v235, v2, v3
    v_cvt_pk_bf16_f32 v236, v4, v5
    v_cvt_pk_bf16_f32 v237, v6, v7
    v_cvt_pk_bf16_f32 v238, v8, v9
    v_cvt_pk_bf16_f32 v239, v10, v11
    v_cvt_pk_bf16_f32 v240, v12, v13
    v_cvt_pk_bf16_f32 v241, v14, v15
    v_cvt_pk_bf16_f32 v242, v16, v17
    v_cvt_pk_bf16_f32 v243, v18, v19
    v_cvt_pk_bf16_f32 v244, v20, v21
    v_cvt_pk_bf16_f32 v245, v22, v23
    v_cvt_pk_bf16_f32 v246, v24, v25
    v_cvt_pk_bf16_f32 v247, v26, v27
    v_cvt_pk_bf16_f32 v248, v28, v29
    v_cvt_pk_bf16_f32 v249, v30, v31
    v_cvt_pk_bf16_f32 v96, v32, v33
    v_cvt_pk_bf16_f32 v97, v34, v35
    v_cvt_pk_bf16_f32 v98, v36, v37
    v_cvt_pk_bf16_f32 v99, v38, v39
    v_cvt_pk_bf16_f32 v100, v40, v41
    v_cvt_pk_bf16_f32 v101, v42, v43
    v_cvt_pk_bf16_f32 v102, v44, v45
    v_cvt_pk_bf16_f32 v103, v46, v47
    v_cvt_pk_bf16_f32 v104, v48, v49
    v_cvt_pk_bf16_f32 v105, v50, v51
    v_cvt_pk_bf16_f32 v106, v52, v53
    v_cvt_pk_bf16_f32 v107, v54, v55
    v_cvt_pk_bf16_f32 v108, v56, v57
    v_cvt_pk_bf16_f32 v109, v58, v59
    v_cvt_pk_bf16_f32 v110, v60, v61
    v_cvt_pk_bf16_f32 v111, v62, v63
    v_cvt_pk_bf16_f32 v112, v64, v65
    v_cvt_pk_bf16_f32 v113, v66, v67
    v_cvt_pk_bf16_f32 v114, v68, v69
    v_cvt_pk_bf16_f32 v115, v70, v71
    v_cvt_pk_bf16_f32 v116, v72, v73
    v_cvt_pk_bf16_f32 v117, v74, v75
    v_cvt_pk_bf16_f32 v118, v76, v77
    v_cvt_pk_bf16_f32 v119, v78, v79
    v_cvt_pk_bf16_f32 v120, v80, v81
    v_cvt_pk_bf16_f32 v121, v82, v83
    v_cvt_pk_bf16_f32 v122, v84, v85
    v_cvt_pk_bf16_f32 v123, v86, v87
    v_cvt_pk_bf16_f32 v124, v88, v89
    v_cvt_pk_bf16_f32 v125, v90, v91
    v_cvt_pk_bf16_f32 v126, v92, v93
    v_cvt_pk_bf16_f32 v127, v94, v95
    s_waitcnt lgkmcnt(11)
    v_mfma_f32_32x32x16_bf16 v[0:15], v[132:135], v[128:131], 0
    ds_read_b128 v[156:159], v185
    ds_read_b64_tr_b16 v[160:161], v192 offset:2048
    ds_read_b64_tr_b16 v[162:163], v192 offset:2560
    s_add_u32 s49, s72, 8192
    buffer_store_dwordx4 v[96:99], v201, s[28:31], s49 offen sc1
    s_waitcnt lgkmcnt(12)
    v_mfma_f32_32x32x16_bf16 v[16:31], v[136:139], v[128:131], 0
    ds_read_b64_tr_b16 v[164:165], v193 offset:2048
    ds_read_b64_tr_b16 v[166:167], v193 offset:2560
    ds_read_b128 v[208:211], v202 offset:32
    s_add_u32 s49, s73, 8192
    buffer_store_dwordx4 v[100:103], v201, s[28:31], s49 offen sc1
    s_waitcnt lgkmcnt(12)
    v_mfma_f32_32x32x16_bf16 v[32:47], v[140:143], v[128:131], 0
    ds_read_b64_tr_b16 v[168:169], v192 offset:10240
    ds_read_b64_tr_b16 v[170:171], v192 offset:10752
    ds_read_b64_tr_b16 v[172:173], v193 offset:10240
    s_waitcnt lgkmcnt(13)
    v_mfma_f32_32x32x16_bf16 v[48:63], v[144:147], v[128:131], 0
    ds_read_b64_tr_b16 v[174:175], v193 offset:10752
    ds_read_b64_tr_b16 v[176:177], v192 offset:18432
    ds_read_b64_tr_b16 v[178:179], v192 offset:18944
    v_mfma_f32_16x16x32_bf16 v[250:253], v[204:207], v[128:131], 0
    s_waitcnt lgkmcnt(14)
    v_mfma_f32_32x32x16_bf16 v[64:79], v[148:151], v[128:131], 0
    ds_read_b64_tr_b16 v[180:181], v193 offset:18432
    ds_read_b64_tr_b16 v[182:183], v193 offset:18944
    s_waitcnt lgkmcnt(14)
    v_mfma_f32_32x32x16_bf16 v[80:95], v[128:131], v[152:155], 0
    s_waitcnt lgkmcnt(11)
    v_mfma_f32_32x32x16_bf16 v[0:15], v[160:163], v[156:159], v[0:15]
    ds_read_b128 v[128:131], v186
    ds_read_b64_tr_b16 v[132:133], v192 offset:4096
    ds_read_b64_tr_b16 v[134:135], v192 offset:4608
    s_add_u32 s49, s74, 8192
    buffer_store_dwordx4 v[104:107], v201, s[28:31], s49 offen sc1
    s_waitcnt lgkmcnt(12)
    v_mfma_f32_32x32x16_bf16 v[16:31], v[164:167], v[156:159], v[16:31]
    ds_read_b64_tr_b16 v[136:137], v193 offset:4096
    ds_read_b64_tr_b16 v[138:139], v193 offset:4608
    ds_read_b128 v[204:207], v202 offset:64
    s_waitcnt lgkmcnt(12)
    v_mfma_f32_32x32x16_bf16 v[32:47], v[168:171], v[156:159], v[32:47]
    ds_read_b64_tr_b16 v[140:141], v192 offset:12288
    ds_read_b64_tr_b16 v[142:143], v192 offset:12800
    ds_read_b64_tr_b16 v[144:145], v193 offset:12288
    s_waitcnt lgkmcnt(13)
    v_mfma_f32_32x32x16_bf16 v[48:63], v[172:175], v[156:159], v[48:63]
    ds_read_b64_tr_b16 v[146:147], v193 offset:12800
    ds_read_b64_tr_b16 v[148:149], v192 offset:20480
    ds_read_b64_tr_b16 v[150:151], v192 offset:20992
    v_mfma_f32_16x16x32_bf16 v[250:253], v[208:211], v[156:159], v[250:253]
    s_waitcnt lgkmcnt(14)
    v_mfma_f32_32x32x16_bf16 v[64:79], v[176:179], v[156:159], v[64:79]
    ds_read_b64_tr_b16 v[152:153], v193 offset:20480
    ds_read_b64_tr_b16 v[154:155], v193 offset:20992
    s_waitcnt lgkmcnt(14)
    v_mfma_f32_32x32x16_bf16 v[80:95], v[156:159], v[180:183], v[80:95]
    s_waitcnt lgkmcnt(11)
    v_mfma_f32_32x32x16_bf16 v[0:15], v[132:135], v[128:131], v[0:15]
    ds_read_b128 v[156:159], v187
    ds_read_b64_tr_b16 v[160:161], v192 offset:6144
    ds_read_b64_tr_b16 v[162:163], v192 offset:6656
    s_waitcnt lgkmcnt(12)
    v_mfma_f32_32x32x16_bf16 v[16:31], v[136:139], v[128:131], v[16:31]
    ds_read_b64_tr_b16 v[164:165], v193 offset:6144
    ds_read_b64_tr_b16 v[166:167], v193 offset:6656
    ds_read_b128 v[208:211], v202 offset:96
    s_waitcnt lgkmcnt(12)
    v_mfma_f32_32x32x16_bf16 v[32:47], v[140:143], v[128:131], v[32:47]
    ds_read_b64_tr_b16 v[168:169], v192 offset:14336
    ds_read_b64_tr_b16 v[170:171], v192 offset:14848
    ds_read_b64_tr_b16 v[172:173], v193 offset:14336
    s_waitcnt lgkmcnt(13)
    v_mfma_f32_32x32x16_bf16 v[48:63], v[144:147], v[128:131], v[48:63]
    ds_read_b64_tr_b16 v[174:175], v193 offset:14848
    ds_read_b64_tr_b16 v[176:177], v192 offset:22528
    ds_read_b64_tr_b16 v[178:179], v192 offset:23040
    v_mfma_f32_16x16x32_bf16 v[250:253], v[204:207], v[128:131], v[250:253]
    s_waitcnt lgkmcnt(14)
    v_mfma_f32_32x32x16_bf16 v[64:79], v[148:151], v[128:131], v[64:79]
    ds_read_b64_tr_b16 v[180:181], v193 offset:22528
    ds_read_b64_tr_b16 v[182:183], v193 offset:23040
    s_waitcnt lgkmcnt(14)
    v_mfma_f32_32x32x16_bf16 v[80:95], v[128:131], v[152:155], v[80:95]
    s_waitcnt lgkmcnt(0)
    s_waitcnt vmcnt(3)
    s_barrier
    v_mfma_f32_32x32x16_bf16 v[0:15], v[160:163], v[156:159], v[0:15]
    ds_read_b128 v[128:131], v188
    ds_read_b64_tr_b16 v[132:133], v194 offset:0
    ds_read_b64_tr_b16 v[134:135], v194 offset:512
    s_add_u32 m0, s44, 0
    s_add_u32 s48, s3, 256
    buffer_load_dwordx4 v196, s[12:15], s48 offen lds
    s_add_u32 m0, s44, 1024
    s_add_u32 s48, s3, 8448
    buffer_load_dwordx4 v197, s[12:15], s48 offen lds
    v_mfma_f32_32x32x16_bf16 v[16:31], v[164:167], v[156:159], v[16:31]
    ds_read_b64_tr_b16 v[136:137], v195 offset:0
    ds_read_b64_tr_b16 v[138:139], v195 offset:512
    ds_read_b128 v[204:207], v202 offset:128
    s_add_u32 m0, s44, 2048
    s_add_u32 s48, s3, 16640
    buffer_load_dwordx4 v196, s[12:15], s48 offen lds
    s_add_u32 m0, s44, 3072
    s_add_u32 s48, s3, 24832
    buffer_load_dwordx4 v197, s[12:15], s48 offen lds
    v_mfma_f32_32x32x16_bf16 v[32:47], v[168:171], v[156:159], v[32:47]
    ds_read_b64_tr_b16 v[140:141], v194 offset:8192
    ds_read_b64_tr_b16 v[142:143], v194 offset:8704
    ds_read_b64_tr_b16 v[144:145], v195 offset:8192
    s_add_u32 m0, s45, 32768
    s_add_u32 s48, s42, 1048576
    buffer_load_dwordx4 v198, s[20:23], s48 offen lds
    s_add_u32 m0, s45, 33792
    s_add_u32 s48, s42, 1114112
    buffer_load_dwordx4 v198, s[20:23], s48 offen lds
    v_mfma_f32_32x32x16_bf16 v[48:63], v[172:175], v[156:159], v[48:63]
    ds_read_b64_tr_b16 v[146:147], v195 offset:8704
    ds_read_b64_tr_b16 v[148:149], v194 offset:16384
    ds_read_b64_tr_b16 v[150:151], v194 offset:16896
    s_add_u32 m0, s46, 49152
    s_add_u32 s48, s43, 393216
    buffer_load_dwordx4 v199, s[24:27], s48 offen lds
    v_mfma_f32_16x16x32_bf16 v[250:253], v[208:211], v[156:159], v[250:253]
    v_mfma_f32_32x32x16_bf16 v[64:79], v[176:179], v[156:159], v[64:79]
    ds_read_b64_tr_b16 v[152:153], v195 offset:16384
    ds_read_b64_tr_b16 v[154:155], v195 offset:16896
    v_mfma_f32_32x32x16_bf16 v[80:95], v[156:159], v[180:183], v[80:95]
    s_waitcnt lgkmcnt(11)
    v_mfma_f32_32x32x16_bf16 v[0:15], v[132:135], v[128:131], v[0:15]
    ds_read_b128 v[156:159], v189
    ds_read_b64_tr_b16 v[160:161], v194 offset:2048
    ds_read_b64_tr_b16 v[162:163], v194 offset:2560
    s_add_u32 s49, s75, 8192
    buffer_store_dwordx4 v[108:111], v201, s[28:31], s49 offen sc1
    s_waitcnt lgkmcnt(12)
    v_mfma_f32_32x32x16_bf16 v[16:31], v[136:139], v[128:131], v[16:31]
    ds_read_b64_tr_b16 v[164:165], v195 offset:2048
    ds_read_b64_tr_b16 v[166:167], v195 offset:2560
    ds_read_b128 v[208:211], v202 offset:160
    s_add_u32 s49, s72, 32768
    buffer_store_dwordx4 v[112:115], v201, s[28:31], s49 offen sc1
    s_waitcnt lgkmcnt(12)
    v_mfma_f32_32x32x16_bf16 v[32:47], v[140:143], v[128:131], v[32:47]
    ds_read_b64_tr_b16 v[168:169], v194 offset:10240
    ds_read_b64_tr_b16 v[170:171], v194 offset:10752
    ds_read_b64_tr_b16 v[172:173], v195 offset:10240
    s_waitcnt lgkmcnt(13)
    v_mfma_f32_32x32x16_bf16 v[48:63], v[144:147], v[128:131], v[48:63]
    ds_read_b64_tr_b16 v[174:175], v195 offset:10752
    ds_read_b64_tr_b16 v[176:177], v194 offset:18432
    ds_read_b64_tr_b16 v[178:179], v194 offset:18944
    v_mfma_f32_16x16x32_bf16 v[250:253], v[204:207], v[128:131], v[250:253]
    s_waitcnt lgkmcnt(14)
    v_mfma_f32_32x32x16_bf16 v[64:79], v[148:151], v[128:131], v[64:79]
    ds_read_b64_tr_b16 v[180:181], v195 offset:18432
    ds_read_b64_tr_b16 v[182:183], v195 offset:18944
    s_waitcnt lgkmcnt(14)
    v_mfma_f32_32x32x16_bf16 v[80:95], v[128:131], v[152:155], v[80:95]
    s_waitcnt lgkmcnt(11)
    v_mfma_f32_32x32x16_bf16 v[0:15], v[160:163], v[156:159], v[0:15]
    ds_read_b128 v[128:131], v190
    ds_read_b64_tr_b16 v[132:133], v194 offset:4096
    ds_read_b64_tr_b16 v[134:135], v194 offset:4608
    s_add_u32 s49, s73, 32768
    buffer_store_dwordx4 v[116:119], v201, s[28:31], s49 offen sc1
    s_waitcnt lgkmcnt(12)
    v_mfma_f32_32x32x16_bf16 v[16:31], v[164:167], v[156:159], v[16:31]
    ds_read_b64_tr_b16 v[136:137], v195 offset:4096
    ds_read_b64_tr_b16 v[138:139], v195 offset:4608
    ds_read_b128 v[204:207], v202 offset:192
    s_waitcnt lgkmcnt(12)
    v_mfma_f32_32x32x16_bf16 v[32:47], v[168:171], v[156:159], v[32:47]
    ds_read_b64_tr_b16 v[140:141], v194 offset:12288
    ds_read_b64_tr_b16 v[142:143], v194 offset:12800
    ds_read_b64_tr_b16 v[144:145], v195 offset:12288
    s_waitcnt lgkmcnt(13)
    v_mfma_f32_32x32x16_bf16 v[48:63], v[172:175], v[156:159], v[48:63]
    ds_read_b64_tr_b16 v[146:147], v195 offset:12800
    ds_read_b64_tr_b16 v[148:149], v194 offset:20480
    ds_read_b64_tr_b16 v[150:151], v194 offset:20992
    v_mfma_f32_16x16x32_bf16 v[250:253], v[208:211], v[156:159], v[250:253]
    s_waitcnt lgkmcnt(14)
    v_mfma_f32_32x32x16_bf16 v[64:79], v[176:179], v[156:159], v[64:79]
    ds_read_b64_tr_b16 v[152:153], v195 offset:20480
    ds_read_b64_tr_b16 v[154:155], v195 offset:20992
    s_waitcnt lgkmcnt(14)
    v_mfma_f32_32x32x16_bf16 v[80:95], v[156:159], v[180:183], v[80:95]
    s_waitcnt lgkmcnt(11)
    v_mfma_f32_32x32x16_bf16 v[0:15], v[132:135], v[128:131], v[0:15]
    ds_read_b128 v[156:159], v191
    ds_read_b64_tr_b16 v[160:161], v194 offset:6144
    ds_read_b64_tr_b16 v[162:163], v194 offset:6656
    s_waitcnt lgkmcnt(12)
    v_mfma_f32_32x32x16_bf16 v[16:31], v[136:139], v[128:131], v[16:31]
    ds_read_b64_tr_b16 v[164:165], v195 offset:6144
    ds_read_b64_tr_b16 v[166:167], v195 offset:6656
    ds_read_b128 v[208:211], v202 offset:224
    s_waitcnt lgkmcnt(12)
    v_mfma_f32_32x32x16_bf16 v[32:47], v[140:143], v[128:131], v[32:47]
    ds_read_b64_tr_b16 v[168:169], v194 offset:14336
    ds_read_b64_tr_b16 v[170:171], v194 offset:14848
    ds_read_b64_tr_b16 v[172:173], v195 offset:14336
    s_waitcnt lgkmcnt(13)
    v_mfma_f32_32x32x16_bf16 v[48:63], v[144:147], v[128:131], v[48:63]
    ds_read_b64_tr_b16 v[174:175], v195 offset:14848
    ds_read_b64_tr_b16 v[176:177], v194 offset:22528
    ds_read_b64_tr_b16 v[178:179], v194 offset:23040
    v_mfma_f32_16x16x32_bf16 v[250:253], v[204:207], v[128:131], v[250:253]
    s_waitcnt lgkmcnt(14)
    v_mfma_f32_32x32x16_bf16 v[64:79], v[148:151], v[128:131], v[64:79]
    ds_read_b64_tr_b16 v[180:181], v195 offset:22528
    ds_read_b64_tr_b16 v[182:183], v195 offset:23040
    s_waitcnt lgkmcnt(14)
    v_mfma_f32_32x32x16_bf16 v[80:95], v[128:131], v[152:155], v[80:95]
    s_waitcnt lgkmcnt(0)
    s_waitcnt vmcnt(3)
    s_barrier
    v_mfma_f32_32x32x16_bf16 v[0:15], v[160:163], v[156:159], v[0:15]
    ds_read_b128 v[128:131], v184
    ds_read_b64_tr_b16 v[132:133], v192 offset:0
    ds_read_b64_tr_b16 v[134:135], v192 offset:512
    s_add_u32 m0, s44, 65536
    s_add_u32 s48, s3, 384
    buffer_load_dwordx4 v196, s[12:15], s48 offen lds
    s_add_u32 m0, s44, 66560
    s_add_u32 s48, s3, 8576
    buffer_load_dwordx4 v197, s[12:15], s48 offen lds
    v_mfma_f32_32x32x16_bf16 v[16:31], v[164:167], v[156:159], v[16:31]
    ds_read_b64_tr_b16 v[136:137], v193 offset:0
    ds_read_b64_tr_b16 v[138:139], v193 offset:512
    ds_read_b128 v[204:207], v202 offset:256
    s_add_u32 m0, s44, 67584
    s_add_u32 s48, s3, 16768
    buffer_load_dwordx4 v196, s[12:15], s48 offen lds
    s_add_u32 m0, s44, 68608
    s_add_u32 s48, s3, 24960
    buffer_load_dwordx4 v197, s[12:15], s48 offen lds
    v_mfma_f32_32x32x16_bf16 v[32:47], v[168:171], v[156:159], v[32:47]
    ds_read_b64_tr_b16 v[140:141], v192 offset:8192
    ds_read_b64_tr_b16 v[142:143], v192 offset:8704
    ds_read_b64_tr_b16 v[144:145], v193 offset:8192
    s_add_u32 m0, s45, 98304
    s_add_u32 s48, s42, 1572864
    buffer_load_dwordx4 v198, s[20:23], s48 offen lds
    s_add_u32 m0, s45, 99328
    s_add_u32 s48, s42, 1638400
    buffer_load_dwordx4 v198, s[20:23], s48 offen lds
    v_mfma_f32_32x32x16_bf16 v[48:63], v[172:175], v[156:159], v[48:63]
    ds_read_b64_tr_b16 v[146:147], v193 offset:8704
    ds_read_b64_tr_b16 v[148:149], v192 offset:16384
    ds_read_b64_tr_b16 v[150:151], v192 offset:16896
    s_add_u32 m0, s46, 114688
    s_add_u32 s48, s43, 589824
    buffer_load_dwordx4 v199, s[24:27], s48 offen lds
    v_mfma_f32_16x16x32_bf16 v[250:253], v[208:211], v[156:159], v[250:253]
    v_mfma_f32_32x32x16_bf16 v[64:79], v[176:179], v[156:159], v[64:79]
    ds_read_b64_tr_b16 v[152:153], v193 offset:16384
    ds_read_b64_tr_b16 v[154:155], v193 offset:16896
    v_mfma_f32_32x32x16_bf16 v[80:95], v[156:159], v[180:183], v[80:95]
    s_waitcnt lgkmcnt(11)
    v_mfma_f32_32x32x16_bf16 v[0:15], v[132:135], v[128:131], v[0:15]
    ds_read_b128 v[156:159], v185
    ds_read_b64_tr_b16 v[160:161], v192 offset:2048
    ds_read_b64_tr_b16 v[162:163], v192 offset:2560
    s_add_u32 s49, s74, 32768
    buffer_store_dwordx4 v[120:123], v201, s[28:31], s49 offen sc1
    s_waitcnt lgkmcnt(12)
    v_mfma_f32_32x32x16_bf16 v[16:31], v[136:139], v[128:131], v[16:31]
    ds_read_b64_tr_b16 v[164:165], v193 offset:2048
    ds_read_b64_tr_b16 v[166:167], v193 offset:2560
    ds_read_b128 v[208:211], v202 offset:288
    s_add_u32 s49, s75, 32768
    buffer_store_dwordx4 v[124:127], v201, s[28:31], s49 offen sc1
    s_waitcnt lgkmcnt(12)
    v_mfma_f32_32x32x16_bf16 v[32:47], v[140:143], v[128:131], v[32:47]
    ds_read_b64_tr_b16 v[168:169], v192 offset:10240
    ds_read_b64_tr_b16 v[170:171], v192 offset:10752
    ds_read_b64_tr_b16 v[172:173], v193 offset:10240
    s_waitcnt lgkmcnt(13)
    v_mfma_f32_32x32x16_bf16 v[48:63], v[144:147], v[128:131], v[48:63]
    ds_read_b64_tr_b16 v[174:175], v193 offset:10752
    ds_read_b64_tr_b16 v[176:177], v192 offset:18432
    ds_read_b64_tr_b16 v[178:179], v192 offset:18944
    v_mfma_f32_16x16x32_bf16 v[250:253], v[204:207], v[128:131], v[250:253]
    s_waitcnt lgkmcnt(14)
    v_mfma_f32_32x32x16_bf16 v[64:79], v[148:151], v[128:131], v[64:79]
    ds_read_b64_tr_b16 v[180:181], v193 offset:18432
    ds_read_b64_tr_b16 v[182:183], v193 offset:18944
    s_waitcnt lgkmcnt(14)
    v_mfma_f32_32x32x16_bf16 v[80:95], v[128:131], v[152:155], v[80:95]
    s_waitcnt lgkmcnt(11)
    v_mfma_f32_32x32x16_bf16 v[0:15], v[160:163], v[156:159], v[0:15]
    ds_read_b128 v[128:131], v186
    ds_read_b64_tr_b16 v[132:133], v192 offset:4096
    ds_read_b64_tr_b16 v[134:135], v192 offset:4608
    s_add_u32 s49, s72, 40960
    buffer_store_dwordx4 v[218:221], v201, s[28:31], s49 offen sc1
    s_waitcnt lgkmcnt(12)
    v_mfma_f32_32x32x16_bf16 v[16:31], v[164:167], v[156:159], v[16:31]
    ds_read_b64_tr_b16 v[136:137], v193 offset:4096
    ds_read_b64_tr_b16 v[138:139], v193 offset:4608
    ds_read_b128 v[204:207], v202 offset:320
    s_waitcnt lgkmcnt(12)
    v_mfma_f32_32x32x16_bf16 v[32:47], v[168:171], v[156:159], v[32:47]
    ds_read_b64_tr_b16 v[140:141], v192 offset:12288
    ds_read_b64_tr_b16 v[142:143], v192 offset:12800
    ds_read_b64_tr_b16 v[144:145], v193 offset:12288
    s_waitcnt lgkmcnt(13)
    v_mfma_f32_32x32x16_bf16 v[48:63], v[172:175], v[156:159], v[48:63]
    ds_read_b64_tr_b16 v[146:147], v193 offset:12800
    ds_read_b64_tr_b16 v[148:149], v192 offset:20480
    ds_read_b64_tr_b16 v[150:151], v192 offset:20992
    v_mfma_f32_16x16x32_bf16 v[250:253], v[208:211], v[156:159], v[250:253]
    s_waitcnt lgkmcnt(14)
    v_mfma_f32_32x32x16_bf16 v[64:79], v[176:179], v[156:159], v[64:79]
    ds_read_b64_tr_b16 v[152:153], v193 offset:20480
    ds_read_b64_tr_b16 v[154:155], v193 offset:20992
    s_waitcnt lgkmcnt(14)
    v_mfma_f32_32x32x16_bf16 v[80:95], v[156:159], v[180:183], v[80:95]
    s_waitcnt lgkmcnt(11)
    v_mfma_f32_32x32x16_bf16 v[0:15], v[132:135], v[128:131], v[0:15]
    ds_read_b128 v[156:159], v187
    ds_read_b64_tr_b16 v[160:161], v192 offset:6144
    ds_read_b64_tr_b16 v[162:163], v192 offset:6656
    s_waitcnt lgkmcnt(12)
    v_mfma_f32_32x32x16_bf16 v[16:31], v[136:139], v[128:131], v[16:31]
    ds_read_b64_tr_b16 v[164:165], v193 offset:6144
    ds_read_b64_tr_b16 v[166:167], v193 offset:6656
    ds_read_b128 v[208:211], v202 offset:352
    s_waitcnt lgkmcnt(12)
    v_mfma_f32_32x32x16_bf16 v[32:47], v[140:143], v[128:131], v[32:47]
    ds_read_b64_tr_b16 v[168:169], v192 offset:14336
    ds_read_b64_tr_b16 v[170:171], v192 offset:14848
    ds_read_b64_tr_b16 v[172:173], v193 offset:14336
    s_waitcnt lgkmcnt(13)
    v_mfma_f32_32x32x16_bf16 v[48:63], v[144:147], v[128:131], v[48:63]
    ds_read_b64_tr_b16 v[174:175], v193 offset:14848
    ds_read_b64_tr_b16 v[176:177], v192 offset:22528
    ds_read_b64_tr_b16 v[178:179], v192 offset:23040
    v_mfma_f32_16x16x32_bf16 v[250:253], v[204:207], v[128:131], v[250:253]
    s_waitcnt lgkmcnt(14)
    v_mfma_f32_32x32x16_bf16 v[64:79], v[148:151], v[128:131], v[64:79]
    ds_read_b64_tr_b16 v[180:181], v193 offset:22528
    ds_read_b64_tr_b16 v[182:183], v193 offset:23040
    s_waitcnt lgkmcnt(14)
    v_mfma_f32_32x32x16_bf16 v[80:95], v[128:131], v[152:155], v[80:95]
    s_waitcnt lgkmcnt(0)
    s_waitcnt vmcnt(3)
    s_barrier
    v_mfma_f32_32x32x16_bf16 v[0:15], v[160:163], v[156:159], v[0:15]
    ds_read_b128 v[128:131], v188
    ds_read_b64_tr_b16 v[132:133], v194 offset:0
    ds_read_b64_tr_b16 v[134:135], v194 offset:512
    s_add_u32 m0, s44, 0
    s_add_u32 s48, s3, 512
    buffer_load_dwordx4 v196, s[12:15], s48 offen lds
    s_add_u32 m0, s44, 1024
    s_add_u32 s48, s3, 8704
    buffer_load_dwordx4 v197, s[12:15], s48 offen lds
    v_mfma_f32_32x32x16_bf16 v[16:31], v[164:167], v[156:159], v[16:31]
    ds_read_b64_tr_b16 v[136:137], v195 offset:0
    ds_read_b64_tr_b16 v[138:139], v195 offset:512
    ds_read_b128 v[204:207], v202 offset:384
    s_add_u32 m0, s44, 2048
    s_add_u32 s48, s3, 16896
    buffer_load_dwordx4 v196, s[12:15], s48 offen lds
    s_add_u32 m0, s44, 3072
    s_add_u32 s48, s3, 25088
    buffer_load_dwordx4 v197, s[12:15], s48 offen lds
    v_mfma_f32_32x32x16_bf16 v[32:47], v[168:171], v[156:159], v[32:47]
    ds_read_b64_tr_b16 v[140:141], v194 offset:8192
    ds_read_b64_tr_b16 v[142:143], v194 offset:8704
    ds_read_b64_tr_b16 v[144:145], v195 offset:8192
    s_add_u32 m0, s45, 32768
    s_add_u32 s48, s42, 2097152
    buffer_load_dwordx4 v198, s[20:23], s48 offen lds
    s_add_u32 m0, s45, 33792
    s_add_u32 s48, s42, 2162688
    buffer_load_dwordx4 v198, s[20:23], s48 offen lds
    v_mfma_f32_32x32x16_bf16 v[48:63], v[172:175], v[156:159], v[48:63]
    ds_read_b64_tr_b16 v[146:147], v195 offset:8704
    ds_read_b64_tr_b16 v[148:149], v194 offset:16384
    ds_read_b64_tr_b16 v[150:151], v194 offset:16896
    s_add_u32 m0, s46, 49152
    s_add_u32 s48, s43, 786432
    buffer_load_dwordx4 v199, s[24:27], s48 offen lds
    v_mfma_f32_16x16x32_bf16 v[250:253], v[208:211], v[156:159], v[250:253]
    v_mfma_f32_32x32x16_bf16 v[64:79], v[176:179], v[156:159], v[64:79]
    ds_read_b64_tr_b16 v[152:153], v195 offset:16384
    ds_read_b64_tr_b16 v[154:155], v195 offset:16896
    v_mfma_f32_32x32x16_bf16 v[80:95], v[156:159], v[180:183], v[80:95]
    s_waitcnt lgkmcnt(11)
    v_mfma_f32_32x32x16_bf16 v[0:15], v[132:135], v[128:131], v[0:15]
    ds_read_b128 v[156:159], v189
    ds_read_b64_tr_b16 v[160:161], v194 offset:2048
    ds_read_b64_tr_b16 v[162:163], v194 offset:2560
    s_add_u32 s49, s73, 40960
    buffer_store_dwordx4 v[222:225], v201, s[28:31], s49 offen sc1
    s_waitcnt lgkmcnt(12)
    v_mfma_f32_32x32x16_bf16 v[16:31], v[136:139], v[128:131], v[16:31]
    ds_read_b64_tr_b16 v[164:165], v195 offset:2048
    ds_read_b64_tr_b16 v[166:167], v195 offset:2560
    ds_read_b128 v[208:211], v202 offset:416
    s_add_u32 s49, s74, 40960
    buffer_store_dwordx4 v[226:229], v201, s[28:31], s49 offen sc1
    s_waitcnt lgkmcnt(12)
    v_mfma_f32_32x32x16_bf16 v[32:47], v[140:143], v[128:131], v[32:47]
    ds_read_b64_tr_b16 v[168:169], v194 offset:10240
    ds_read_b64_tr_b16 v[170:171], v194 offset:10752
    ds_read_b64_tr_b16 v[172:173], v195 offset:10240
    s_waitcnt lgkmcnt(13)
    v_mfma_f32_32x32x16_bf16 v[48:63], v[144:147], v[128:131], v[48:63]
    ds_read_b64_tr_b16 v[174:175], v195 offset:10752
    ds_read_b64_tr_b16 v[176:177], v194 offset:18432
    ds_read_b64_tr_b16 v[178:179], v194 offset:18944
    v_mfma_f32_16x16x32_bf16 v[250:253], v[204:207], v[128:131], v[250:253]
    s_waitcnt lgkmcnt(14)
    v_mfma_f32_32x32x16_bf16 v[64:79], v[148:151], v[128:131], v[64:79]
    ds_read_b64_tr_b16 v[180:181], v195 offset:18432
    ds_read_b64_tr_b16 v[182:183], v195 offset:18944
    s_waitcnt lgkmcnt(14)
    v_mfma_f32_32x32x16_bf16 v[80:95], v[128:131], v[152:155], v[80:95]
    s_waitcnt lgkmcnt(11)
    v_mfma_f32_32x32x16_bf16 v[0:15], v[160:163], v[156:159], v[0:15]
    ds_read_b128 v[128:131], v190
    ds_read_b64_tr_b16 v[132:133], v194 offset:4096
    ds_read_b64_tr_b16 v[134:135], v194 offset:4608
    s_add_u32 s49, s75, 40960
    buffer_store_dwordx4 v[230:233], v201, s[28:31], s49 offen sc1
    s_waitcnt lgkmcnt(12)
    v_mfma_f32_32x32x16_bf16 v[16:31], v[164:167], v[156:159], v[16:31]
    ds_read_b64_tr_b16 v[136:137], v195 offset:4096
    ds_read_b64_tr_b16 v[138:139], v195 offset:4608
    ds_read_b128 v[204:207], v202 offset:448
    s_waitcnt lgkmcnt(12)
    v_mfma_f32_32x32x16_bf16 v[32:47], v[168:171], v[156:159], v[32:47]
    ds_read_b64_tr_b16 v[140:141], v194 offset:12288
    ds_read_b64_tr_b16 v[142:143], v194 offset:12800
    ds_read_b64_tr_b16 v[144:145], v195 offset:12288
    s_waitcnt lgkmcnt(13)
    v_mfma_f32_32x32x16_bf16 v[48:63], v[172:175], v[156:159], v[48:63]
    ds_read_b64_tr_b16 v[146:147], v195 offset:12800
    ds_read_b64_tr_b16 v[148:149], v194 offset:20480
    ds_read_b64_tr_b16 v[150:151], v194 offset:20992
    v_mfma_f32_16x16x32_bf16 v[250:253], v[208:211], v[156:159], v[250:253]
    s_waitcnt lgkmcnt(14)
    v_mfma_f32_32x32x16_bf16 v[64:79], v[176:179], v[156:159], v[64:79]
    ds_read_b64_tr_b16 v[152:153], v195 offset:20480
    ds_read_b64_tr_b16 v[154:155], v195 offset:20992
    s_waitcnt lgkmcnt(14)
    v_mfma_f32_32x32x16_bf16 v[80:95], v[156:159], v[180:183], v[80:95]
    s_waitcnt lgkmcnt(11)
    v_mfma_f32_32x32x16_bf16 v[0:15], v[132:135], v[128:131], v[0:15]
    ds_read_b128 v[156:159], v191
    ds_read_b64_tr_b16 v[160:161], v194 offset:6144
    ds_read_b64_tr_b16 v[162:163], v194 offset:6656
    v_lshlrev_b32 v216, 2, v213
    v_sub_u32 v216, v214, v216
    s_waitcnt lgkmcnt(12)
    v_mfma_f32_32x32x16_bf16 v[16:31], v[136:139], v[128:131], v[16:31]
    ds_read_b64_tr_b16 v[164:165], v195 offset:6144
    ds_read_b64_tr_b16 v[166:167], v195 offset:6656
    ds_read_b128 v[208:211], v202 offset:480
    v_mov_b32 v217, 0x3f80
    v_mov_b32 v215, 0x3f800000
    s_waitcnt lgkmcnt(12)
    v_mfma_f32_32x32x16_bf16 v[32:47], v[140:143], v[128:131], v[32:47]
    ds_read_b64_tr_b16 v[168:169], v194 offset:14336
    ds_read_b64_tr_b16 v[170:171], v194 offset:14848
    ds_read_b64_tr_b16 v[172:173], v195 offset:14336
    v_cmp_eq_u32 s[64:65], 0, v216
    v_cmp_eq_u32 s[66:67], 1, v216
    s_waitcnt lgkmcnt(13)
    v_mfma_f32_32x32x16_bf16 v[48:63], v[144:147], v[128:131], v[48:63]
    ds_read_b64_tr_b16 v[174:175], v195 offset:14848
    ds_read_b64_tr_b16 v[176:177], v194 offset:22528
    ds_read_b64_tr_b16 v[178:179], v194 offset:23040
    v_mov_b32 v104, 0
    s_nop 0
    v_mfma_f32_16x16x32_bf16 v[250:253], v[204:207], v[128:131], v[250:253]
    s_waitcnt lgkmcnt(14)
    v_mfma_f32_32x32x16_bf16 v[64:79], v[148:151], v[128:131], v[64:79]
    ds_read_b64_tr_b16 v[180:181], v195 offset:22528
    ds_read_b64_tr_b16 v[182:183], v195 offset:23040
    v_cndmask_b32 v104, v104, v217, s[64:65]
    s_waitcnt lgkmcnt(14)
    v_mfma_f32_32x32x16_bf16 v[80:95], v[128:131], v[152:155], v[80:95]
    s_waitcnt lgkmcnt(0)
    s_waitcnt vmcnt(3)
    s_barrier
    v_mfma_f32_32x32x16_bf16 v[0:15], v[160:163], v[156:159], v[0:15]
    ds_read_b128 v[128:131], v184
    ds_read_b64_tr_b16 v[132:133], v192 offset:0
    ds_read_b64_tr_b16 v[134:135], v192 offset:512
    s_add_u32 m0, s44, 65536
    s_add_u32 s48, s3, 640
    buffer_load_dwordx4 v196, s[12:15], s48 offen lds
    s_add_u32 m0, s44, 66560
    s_add_u32 s48, s3, 8832
    buffer_load_dwordx4 v197, s[12:15], s48 offen lds
    v_mfma_f32_32x32x16_bf16 v[16:31], v[164:167], v[156:159], v[16:31]
    ds_read_b64_tr_b16 v[136:137], v193 offset:0
    ds_read_b64_tr_b16 v[138:139], v193 offset:512
    ds_read_b128 v[204:207], v202 offset:512
    s_add_u32 m0, s44, 67584
    s_add_u32 s48, s3, 17024
    buffer_load_dwordx4 v196, s[12:15], s48 offen lds
    s_add_u32 m0, s44, 68608
    s_add_u32 s48, s3, 25216
    buffer_load_dwordx4 v197, s[12:15], s48 offen lds
    v_mfma_f32_32x32x16_bf16 v[32:47], v[168:171], v[156:159], v[32:47]
    ds_read_b64_tr_b16 v[140:141], v192 offset:8192
    ds_read_b64_tr_b16 v[142:143], v192 offset:8704
    ds_read_b64_tr_b16 v[144:145], v193 offset:8192
    s_add_u32 m0, s45, 98304
    s_add_u32 s48, s42, 2621440
    buffer_load_dwordx4 v198, s[20:23], s48 offen lds
    s_add_u32 m0, s45, 99328
    s_add_u32 s48, s42, 2686976
    buffer_load_dwordx4 v198, s[20:23], s48 offen lds
    v_mfma_f32_32x32x16_bf16 v[48:63], v[172:175], v[156:159], v[48:63]
    ds_read_b64_tr_b16 v[146:147], v193 offset:8704
    ds_read_b64_tr_b16 v[148:149], v192 offset:16384
    ds_read_b64_tr_b16 v[150:151], v192 offset:16896
    s_add_u32 m0, s46, 114688
    s_add_u32 s48, s43, 983040
    buffer_load_dwordx4 v199, s[24:27], s48 offen lds
    v_mfma_f32_16x16x32_bf16 v[250:253], v[208:211], v[156:159], v[250:253]
    v_mfma_f32_32x32x16_bf16 v[64:79], v[176:179], v[156:159], v[64:79]
    ds_read_b64_tr_b16 v[152:153], v193 offset:16384
    ds_read_b64_tr_b16 v[154:155], v193 offset:16896
    v_mfma_f32_32x32x16_bf16 v[80:95], v[156:159], v[180:183], v[80:95]
    s_waitcnt lgkmcnt(11)
    v_mfma_f32_32x32x16_bf16 v[0:15], v[132:135], v[128:131], v[0:15]
    ds_read_b128 v[156:159], v185
    ds_read_b64_tr_b16 v[160:161], v192 offset:2048
    ds_read_b64_tr_b16 v[162:163], v192 offset:2560
    s_add_u32 s49, s72, 0
    buffer_store_dwordx4 v[234:237], v201, s[28:31], s49 offen sc1
    s_waitcnt lgkmcnt(12)
    v_mfma_f32_32x32x16_bf16 v[16:31], v[136:139], v[128:131], v[16:31]
    ds_read_b64_tr_b16 v[164:165], v193 offset:2048
    ds_read_b64_tr_b16 v[166:167], v193 offset:2560
    ds_read_b128 v[208:211], v202 offset:544
    s_waitcnt lgkmcnt(12)
    v_mfma_f32_32x32x16_bf16 v[32:47], v[140:143], v[128:131], v[32:47]
    ds_read_b64_tr_b16 v[168:169], v192 offset:10240
    ds_read_b64_tr_b16 v[170:171], v192 offset:10752
    ds_read_b64_tr_b16 v[172:173], v193 offset:10240
    s_waitcnt lgkmcnt(13)
    v_mfma_f32_32x32x16_bf16 v[48:63], v[144:147], v[128:131], v[48:63]
    ds_read_b64_tr_b16 v[174:175], v193 offset:10752
    ds_read_b64_tr_b16 v[176:177], v192 offset:18432
    ds_read_b64_tr_b16 v[178:179], v192 offset:18944
    v_mfma_f32_16x16x32_bf16 v[250:253], v[204:207], v[128:131], v[250:253]
    s_waitcnt lgkmcnt(14)
    v_mfma_f32_32x32x16_bf16 v[64:79], v[148:151], v[128:131], v[64:79]
    ds_read_b64_tr_b16 v[180:181], v193 offset:18432
    ds_read_b64_tr_b16 v[182:183], v193 offset:18944
    s_waitcnt lgkmcnt(14)
    v_mfma_f32_32x32x16_bf16 v[80:95], v[128:131], v[152:155], v[80:95]
    s_waitcnt lgkmcnt(11)
    v_mfma_f32_32x32x16_bf16 v[0:15], v[160:163], v[156:159], v[0:15]
    ds_read_b128 v[128:131], v186
    ds_read_b64_tr_b16 v[132:133], v192 offset:4096
    ds_read_b64_tr_b16 v[134:135], v192 offset:4608
    s_add_u32 s49, s73, 0
    buffer_store_dwordx4 v[238:241], v201, s[28:31], s49 offen sc1
    s_waitcnt lgkmcnt(12)
    v_mfma_f32_32x32x16_bf16 v[16:31], v[164:167], v[156:159], v[16:31]
    ds_read_b64_tr_b16 v[136:137], v193 offset:4096
    ds_read_b64_tr_b16 v[138:139], v193 offset:4608
    ds_read_b128 v[204:207], v202 offset:576
    s_waitcnt lgkmcnt(12)
    v_mfma_f32_32x32x16_bf16 v[32:47], v[168:171], v[156:159], v[32:47]
    ds_read_b64_tr_b16 v[140:141], v192 offset:12288
    ds_read_b64_tr_b16 v[142:143], v192 offset:12800
    ds_read_b64_tr_b16 v[144:145], v193 offset:12288
    s_waitcnt lgkmcnt(13)
    v_mfma_f32_32x32x16_bf16 v[48:63], v[172:175], v[156:159], v[48:63]
    ds_read_b64_tr_b16 v[146:147], v193 offset:12800
    ds_read_b64_tr_b16 v[148:149], v192 offset:20480
    ds_read_b64_tr_b16 v[150:151], v192 offset:20992
    v_mfma_f32_16x16x32_bf16 v[250:253], v[208:211], v[156:159], v[250:253]
    s_waitcnt lgkmcnt(14)
    v_mfma_f32_32x32x16_bf16 v[64:79], v[176:179], v[156:159], v[64:79]
    ds_read_b64_tr_b16 v[152:153], v193 offset:20480
    ds_read_b64_tr_b16 v[154:155], v193 offset:20992
    s_waitcnt lgkmcnt(14)
    v_mfma_f32_32x32x16_bf16 v[80:95], v[156:159], v[180:183], v[80:95]
    s_waitcnt lgkmcnt(11)
    v_mfma_f32_32x32x16_bf16 v[0:15], v[132:135], v[128:131], v[0:15]
    ds_read_b128 v[156:159], v187
    ds_read_b64_tr_b16 v[160:161], v192 offset:6144
    ds_read_b64_tr_b16 v[162:163], v192 offset:6656
    v_cndmask_b32 v104, v104, v215, s[66:67]
    v_cmp_eq_u32 s[64:65], 2, v216
    s_waitcnt lgkmcnt(12)
    v_mfma_f32_32x32x16_bf16 v[16:31], v[136:139], v[128:131], v[16:31]
    ds_read_b64_tr_b16 v[164:165], v193 offset:6144
    ds_read_b64_tr_b16 v[166:167], v193 offset:6656
    ds_read_b128 v[208:211], v202 offset:608
    v_cmp_eq_u32 s[66:67], 3, v216
    v_mov_b32 v105, 0
    s_waitcnt lgkmcnt(12)
    v_mfma_f32_32x32x16_bf16 v[32:47], v[140:143], v[128:131], v[32:47]
    ds_read_b64_tr_b16 v[168:169], v192 offset:14336
    ds_read_b64_tr_b16 v[170:171], v192 offset:14848
    ds_read_b64_tr_b16 v[172:173], v193 offset:14336
    s_nop 0
    v_cndmask_b32 v105, v105, v217, s[64:65]
    s_waitcnt lgkmcnt(13)
    v_mfma_f32_32x32x16_bf16 v[48:63], v[144:147], v[128:131], v[48:63]
    ds_read_b64_tr_b16 v[174:175], v193 offset:14848
    ds_read_b64_tr_b16 v[176:177], v192 offset:22528
    ds_read_b64_tr_b16 v[178:179], v192 offset:23040
    v_cndmask_b32 v105, v105, v215, s[66:67]
    v_cmp_eq_u32 s[64:65], 8, v216
    v_mfma_f32_16x16x32_bf16 v[250:253], v[204:207], v[128:131], v[250:253]
    s_waitcnt lgkmcnt(14)
    v_mfma_f32_32x32x16_bf16 v[64:79], v[148:151], v[128:131], v[64:79]
    ds_read_b64_tr_b16 v[180:181], v193 offset:22528
    ds_read_b64_tr_b16 v[182:183], v193 offset:23040
    v_cmp_eq_u32 s[66:67], 9, v216
    s_waitcnt lgkmcnt(14)
    v_mfma_f32_32x32x16_bf16 v[80:95], v[128:131], v[152:155], v[80:95]
    s_waitcnt lgkmcnt(0)
    s_waitcnt vmcnt(2)
    s_barrier
    v_mfma_f32_32x32x16_bf16 v[0:15], v[160:163], v[156:159], v[0:15]
    ds_read_b128 v[128:131], v188
    ds_read_b64_tr_b16 v[132:133], v194 offset:0
    ds_read_b64_tr_b16 v[134:135], v194 offset:512
    s_add_u32 m0, s44, 0
    s_add_u32 s48, s3, 768
    buffer_load_dwordx4 v196, s[12:15], s48 offen lds
    s_add_u32 m0, s44, 1024
    s_add_u32 s48, s3, 8960
    buffer_load_dwordx4 v197, s[12:15], s48 offen lds
    v_mfma_f32_32x32x16_bf16 v[16:31], v[164:167], v[156:159], v[16:31]
    ds_read_b64_tr_b16 v[136:137], v195 offset:0
    ds_read_b64_tr_b16 v[138:139], v195 offset:512
    ds_read_b128 v[204:207], v202 offset:640
    s_add_u32 m0, s44, 2048
    s_add_u32 s48, s3, 17152
    buffer_load_dwordx4 v196, s[12:15], s48 offen lds
    s_add_u32 m0, s44, 3072
    s_add_u32 s48, s3, 25344
    buffer_load_dwordx4 v197, s[12:15], s48 offen lds
    v_mfma_f32_32x32x16_bf16 v[32:47], v[168:171], v[156:159], v[32:47]
    ds_read_b64_tr_b16 v[140:141], v194 offset:8192
    ds_read_b64_tr_b16 v[142:143], v194 offset:8704
    ds_read_b64_tr_b16 v[144:145], v195 offset:8192
    s_add_u32 m0, s45, 32768
    s_add_u32 s48, s42, 3145728
    buffer_load_dwordx4 v198, s[20:23], s48 offen lds
    s_add_u32 m0, s45, 33792
    s_add_u32 s48, s42, 3211264
    buffer_load_dwordx4 v198, s[20:23], s48 offen lds
    v_mfma_f32_32x32x16_bf16 v[48:63], v[172:175], v[156:159], v[48:63]
    ds_read_b64_tr_b16 v[146:147], v195 offset:8704
    ds_read_b64_tr_b16 v[148:149], v194 offset:16384
    ds_read_b64_tr_b16 v[150:151], v194 offset:16896
    s_add_u32 m0, s46, 49152
    s_add_u32 s48, s43, 1179648
    buffer_load_dwordx4 v199, s[24:27], s48 offen lds
    v_mfma_f32_16x16x32_bf16 v[250:253], v[208:211], v[156:159], v[250:253]
    v_mfma_f32_32x32x16_bf16 v[64:79], v[176:179], v[156:159], v[64:79]
    ds_read_b64_tr_b16 v[152:153], v195 offset:16384
    ds_read_b64_tr_b16 v[154:155], v195 offset:16896
    v_mfma_f32_32x32x16_bf16 v[80:95], v[156:159], v[180:183], v[80:95]
    s_waitcnt lgkmcnt(11)
    v_mfma_f32_32x32x16_bf16 v[0:15], v[132:135], v[128:131], v[0:15]
    ds_read_b128 v[156:159], v189
    ds_read_b64_tr_b16 v[160:161], v194 offset:2048
    ds_read_b64_tr_b16 v[162:163], v194 offset:2560
    s_add_u32 s49, s74, 0
    buffer_store_dwordx4 v[242:245], v201, s[28:31], s49 offen sc1
    s_waitcnt lgkmcnt(12)
    v_mfma_f32_32x32x16_bf16 v[16:31], v[136:139], v[128:131], v[16:31]
    ds_read_b64_tr_b16 v[164:165], v195 offset:2048
    ds_read_b64_tr_b16 v[166:167], v195 offset:2560
    ds_read_b128 v[208:211], v202 offset:672
    s_waitcnt lgkmcnt(12)
    v_mfma_f32_32x32x16_bf16 v[32:47], v[140:143], v[128:131], v[32:47]
    ds_read_b64_tr_b16 v[168:169], v194 offset:10240
    ds_read_b64_tr_b16 v[170:171], v194 offset:10752
    ds_read_b64_tr_b16 v[172:173], v195 offset:10240
    s_waitcnt lgkmcnt(13)
    v_mfma_f32_32x32x16_bf16 v[48:63], v[144:147], v[128:131], v[48:63]
    ds_read_b64_tr_b16 v[174:175], v195 offset:10752
    ds_read_b64_tr_b16 v[176:177], v194 offset:18432
    ds_read_b64_tr_b16 v[178:179], v194 offset:18944
    v_mfma_f32_16x16x32_bf16 v[250:253], v[204:207], v[128:131], v[250:253]
    s_waitcnt lgkmcnt(14)
    v_mfma_f32_32x32x16_bf16 v[64:79], v[148:151], v[128:131], v[64:79]
    ds_read_b64_tr_b16 v[180:181], v195 offset:18432
    ds_read_b64_tr_b16 v[182:183], v195 offset:18944
    s_waitcnt lgkmcnt(14)
    v_mfma_f32_32x32x16_bf16 v[80:95], v[128:131], v[152:155], v[80:95]
    s_waitcnt lgkmcnt(11)
    v_mfma_f32_32x32x16_bf16 v[0:15], v[160:163], v[156:159], v[0:15]
    ds_read_b128 v[128:131], v190
    ds_read_b64_tr_b16 v[132:133], v194 offset:4096
    ds_read_b64_tr_b16 v[134:135], v194 offset:4608
    s_add_u32 s49, s75, 0
    buffer_store_dwordx4 v[246:249], v201, s[28:31], s49 offen sc1
    s_waitcnt lgkmcnt(12)
    v_mfma_f32_32x32x16_bf16 v[16:31], v[164:167], v[156:159], v[16:31]
    ds_read_b64_tr_b16 v[136:137], v195 offset:4096
    ds_read_b64_tr_b16 v[138:139], v195 offset:4608
    ds_read_b128 v[204:207], v202 offset:704
    s_waitcnt lgkmcnt(12)
    v_mfma_f32_32x32x16_bf16 v[32:47], v[168:171], v[156:159], v[32:47]
    ds_read_b64_tr_b16 v[140:141], v194 offset:12288
    ds_read_b64_tr_b16 v[142:143], v194 offset:12800
    ds_read_b64_tr_b16 v[144:145], v195 offset:12288
    s_waitcnt lgkmcnt(13)
    v_mfma_f32_32x32x16_bf16 v[48:63], v[172:175], v[156:159], v[48:63]
    ds_read_b64_tr_b16 v[146:147], v195 offset:12800
    ds_read_b64_tr_b16 v[148:149], v194 offset:20480
    ds_read_b64_tr_b16 v[150:151], v194 offset:20992
    v_mfma_f32_16x16x32_bf16 v[250:253], v[208:211], v[156:159], v[250:253]
    s_waitcnt lgkmcnt(14)
    v_mfma_f32_32x32x16_bf16 v[64:79], v[176:179], v[156:159], v[64:79]
    ds_read_b64_tr_b16 v[152:153], v195 offset:20480
    ds_read_b64_tr_b16 v[154:155], v195 offset:20992
    s_waitcnt lgkmcnt(14)
    v_mfma_f32_32x32x16_bf16 v[80:95], v[156:159], v[180:183], v[80:95]
    s_waitcnt lgkmcnt(11)
    v_mfma_f32_32x32x16_bf16 v[0:15], v[132:135], v[128:131], v[0:15]
    ds_read_b128 v[156:159], v191
    ds_read_b64_tr_b16 v[160:161], v194 offset:6144
    ds_read_b64_tr_b16 v[162:163], v194 offset:6656
    v_mov_b32 v106, 0
    s_nop 0
    s_waitcnt lgkmcnt(12)
    v_mfma_f32_32x32x16_bf16 v[16:31], v[136:139], v[128:131], v[16:31]
    ds_read_b64_tr_b16 v[164:165], v195 offset:6144
    ds_read_b64_tr_b16 v[166:167], v195 offset:6656
    ds_read_b128 v[208:211], v202 offset:736
    v_cndmask_b32 v106, v106, v217, s[64:65]
    v_cndmask_b32 v106, v106, v215, s[66:67]
    s_waitcnt lgkmcnt(12)
    v_mfma_f32_32x32x16_bf16 v[32:47], v[140:143], v[128:131], v[32:47]
    ds_read_b64_tr_b16 v[168:169], v194 offset:14336
    ds_read_b64_tr_b16 v[170:171], v194 offset:14848
    ds_read_b64_tr_b16 v[172:173], v195 offset:14336
    v_cmp_eq_u32 s[64:65], 10, v216
    v_cmp_eq_u32 s[66:67], 11, v216
    s_waitcnt lgkmcnt(13)
    v_mfma_f32_32x32x16_bf16 v[48:63], v[144:147], v[128:131], v[48:63]
    ds_read_b64_tr_b16 v[174:175], v195 offset:14848
    ds_read_b64_tr_b16 v[176:177], v194 offset:22528
    ds_read_b64_tr_b16 v[178:179], v194 offset:23040
    v_mov_b32 v107, 0
    s_nop 0
    v_mfma_f32_16x16x32_bf16 v[250:253], v[204:207], v[128:131], v[250:253]
    s_waitcnt lgkmcnt(14)
    v_mfma_f32_32x32x16_bf16 v[64:79], v[148:151], v[128:131], v[64:79]
    ds_read_b64_tr_b16 v[180:181], v195 offset:22528
    ds_read_b64_tr_b16 v[182:183], v195 offset:23040
    v_cndmask_b32 v107, v107, v217, s[64:65]
    s_waitcnt lgkmcnt(14)
    v_mfma_f32_32x32x16_bf16 v[80:95], v[128:131], v[152:155], v[80:95]
    s_waitcnt lgkmcnt(0)
    s_waitcnt vmcnt(2)
    s_barrier
    v_mfma_f32_32x32x16_bf16 v[0:15], v[160:163], v[156:159], v[0:15]
    ds_read_b128 v[128:131], v184
    ds_read_b64_tr_b16 v[132:133], v192 offset:0
    ds_read_b64_tr_b16 v[134:135], v192 offset:512
    s_add_u32 m0, s44, 65536
    s_add_u32 s48, s3, 896
    buffer_load_dwordx4 v196, s[12:15], s48 offen lds
    s_add_u32 m0, s44, 66560
    s_add_u32 s48, s3, 9088
    buffer_load_dwordx4 v197, s[12:15], s48 offen lds
    v_mfma_f32_32x32x16_bf16 v[16:31], v[164:167], v[156:159], v[16:31]
    ds_read_b64_tr_b16 v[136:137], v193 offset:0
    ds_read_b64_tr_b16 v[138:139], v193 offset:512
    ds_read_b128 v[204:207], v202 offset:768
    s_add_u32 m0, s44, 67584
    s_add_u32 s48, s3, 17280
    buffer_load_dwordx4 v196, s[12:15], s48 offen lds
    s_add_u32 m0, s44, 68608
    s_add_u32 s48, s3, 25472
    buffer_load_dwordx4 v197, s[12:15], s48 offen lds
    v_mfma_f32_32x32x16_bf16 v[32:47], v[168:171], v[156:159], v[32:47]
    ds_read_b64_tr_b16 v[140:141], v192 offset:8192
    ds_read_b64_tr_b16 v[142:143], v192 offset:8704
    ds_read_b64_tr_b16 v[144:145], v193 offset:8192
    s_add_u32 m0, s45, 98304
    s_add_u32 s48, s42, 3670016
    buffer_load_dwordx4 v198, s[20:23], s48 offen lds
    s_add_u32 m0, s45, 99328
    s_add_u32 s48, s42, 3735552
    buffer_load_dwordx4 v198, s[20:23], s48 offen lds
    v_mfma_f32_32x32x16_bf16 v[48:63], v[172:175], v[156:159], v[48:63]
    ds_read_b64_tr_b16 v[146:147], v193 offset:8704
    ds_read_b64_tr_b16 v[148:149], v192 offset:16384
    ds_read_b64_tr_b16 v[150:151], v192 offset:16896
    s_add_u32 m0, s46, 114688
    s_add_u32 s48, s43, 1376256
    buffer_load_dwordx4 v199, s[24:27], s48 offen lds
    v_mfma_f32_16x16x32_bf16 v[250:253], v[208:211], v[156:159], v[250:253]
    v_mfma_f32_32x32x16_bf16 v[64:79], v[176:179], v[156:159], v[64:79]
    ds_read_b64_tr_b16 v[152:153], v193 offset:16384
    ds_read_b64_tr_b16 v[154:155], v193 offset:16896
    v_mfma_f32_32x32x16_bf16 v[80:95], v[156:159], v[180:183], v[80:95]
    s_waitcnt lgkmcnt(11)
    v_mfma_f32_32x32x16_bf16 v[0:15], v[132:135], v[128:131], v[0:15]
    ds_read_b128 v[156:159], v185
    ds_read_b64_tr_b16 v[160:161], v192 offset:2048
    ds_read_b64_tr_b16 v[162:163], v192 offset:2560
    s_waitcnt lgkmcnt(12)
    v_mfma_f32_32x32x16_bf16 v[16:31], v[136:139], v[128:131], v[16:31]
    ds_read_b64_tr_b16 v[164:165], v193 offset:2048
    ds_read_b64_tr_b16 v[166:167], v193 offset:2560
    ds_read_b128 v[208:211], v202 offset:800
    s_waitcnt lgkmcnt(12)
    v_mfma_f32_32x32x16_bf16 v[32:47], v[140:143], v[128:131], v[32:47]
    ds_read_b64_tr_b16 v[168:169], v192 offset:10240
    ds_read_b64_tr_b16 v[170:171], v192 offset:10752
    ds_read_b64_tr_b16 v[172:173], v193 offset:10240
    s_waitcnt lgkmcnt(13)
    v_mfma_f32_32x32x16_bf16 v[48:63], v[144:147], v[128:131], v[48:63]
    ds_read_b64_tr_b16 v[174:175], v193 offset:10752
    ds_read_b64_tr_b16 v[176:177], v192 offset:18432
    ds_read_b64_tr_b16 v[178:179], v192 offset:18944
    v_mfma_f32_16x16x32_bf16 v[250:253], v[204:207], v[128:131], v[250:253]
    s_waitcnt lgkmcnt(14)
    v_mfma_f32_32x32x16_bf16 v[64:79], v[148:151], v[128:131], v[64:79]
    ds_read_b64_tr_b16 v[180:181], v193 offset:18432
    ds_read_b64_tr_b16 v[182:183], v193 offset:18944
    s_waitcnt lgkmcnt(14)
    v_mfma_f32_32x32x16_bf16 v[80:95], v[128:131], v[152:155], v[80:95]
    s_waitcnt lgkmcnt(11)
    v_mfma_f32_32x32x16_bf16 v[0:15], v[160:163], v[156:159], v[0:15]
    ds_read_b128 v[128:131], v186
    ds_read_b64_tr_b16 v[132:133], v192 offset:4096
    ds_read_b64_tr_b16 v[134:135], v192 offset:4608
    s_waitcnt lgkmcnt(12)
    v_mfma_f32_32x32x16_bf16 v[16:31], v[164:167], v[156:159], v[16:31]
    ds_read_b64_tr_b16 v[136:137], v193 offset:4096
    ds_read_b64_tr_b16 v[138:139], v193 offset:4608
    ds_read_b128 v[204:207], v202 offset:832
    s_waitcnt lgkmcnt(12)
    v_mfma_f32_32x32x16_bf16 v[32:47], v[168:171], v[156:159], v[32:47]
    ds_read_b64_tr_b16 v[140:141], v192 offset:12288
    ds_read_b64_tr_b16 v[142:143], v192 offset:12800
    ds_read_b64_tr_b16 v[144:145], v193 offset:12288
    s_waitcnt lgkmcnt(13)
    v_mfma_f32_32x32x16_bf16 v[48:63], v[172:175], v[156:159], v[48:63]
    ds_read_b64_tr_b16 v[146:147], v193 offset:12800
    ds_read_b64_tr_b16 v[148:149], v192 offset:20480
    ds_read_b64_tr_b16 v[150:151], v192 offset:20992
    v_mfma_f32_16x16x32_bf16 v[250:253], v[208:211], v[156:159], v[250:253]
    s_waitcnt lgkmcnt(14)
    v_mfma_f32_32x32x16_bf16 v[64:79], v[176:179], v[156:159], v[64:79]
    ds_read_b64_tr_b16 v[152:153], v193 offset:20480
    ds_read_b64_tr_b16 v[154:155], v193 offset:20992
    s_waitcnt lgkmcnt(14)
    v_mfma_f32_32x32x16_bf16 v[80:95], v[156:159], v[180:183], v[80:95]
    s_waitcnt lgkmcnt(11)
    v_mfma_f32_32x32x16_bf16 v[0:15], v[132:135], v[128:131], v[0:15]
    ds_read_b128 v[156:159], v187
    ds_read_b64_tr_b16 v[160:161], v192 offset:6144
    ds_read_b64_tr_b16 v[162:163], v192 offset:6656
    v_cndmask_b32 v107, v107, v215, s[66:67]
    v_cmp_eq_u32 s[64:65], 16, v216
    s_waitcnt lgkmcnt(12)
    v_mfma_f32_32x32x16_bf16 v[16:31], v[136:139], v[128:131], v[16:31]
    ds_read_b64_tr_b16 v[164:165], v193 offset:6144
    ds_read_b64_tr_b16 v[166:167], v193 offset:6656
    ds_read_b128 v[208:211], v202 offset:864
    v_cmp_eq_u32 s[66:67], 17, v216
    v_mov_b32 v108, 0
    s_waitcnt lgkmcnt(12)
    v_mfma_f32_32x32x16_bf16 v[32:47], v[140:143], v[128:131], v[32:47]
    ds_read_b64_tr_b16 v[168:169], v192 offset:14336
    ds_read_b64_tr_b16 v[170:171], v192 offset:14848
    ds_read_b64_tr_b16 v[172:173], v193 offset:14336
    s_nop 0
    v_cndmask_b32 v108, v108, v217, s[64:65]
    s_waitcnt lgkmcnt(13)
    v_mfma_f32_32x32x16_bf16 v[48:63], v[144:147], v[128:131], v[48:63]
    ds_read_b64_tr_b16 v[174:175], v193 offset:14848
    ds_read_b64_tr_b16 v[176:177], v192 offset:22528
    ds_read_b64_tr_b16 v[178:179], v192 offset:23040
    v_cndmask_b32 v108, v108, v215, s[66:67]
    v_cmp_eq_u32 s[64:65], 18, v216
    v_mfma_f32_16x16x32_bf16 v[250:253], v[204:207], v[128:131], v[250:253]
    s_waitcnt lgkmcnt(14)
    v_mfma_f32_32x32x16_bf16 v[64:79], v[148:151], v[128:131], v[64:79]
    ds_read_b64_tr_b16 v[180:181], v193 offset:22528
    ds_read_b64_tr_b16 v[182:183], v193 offset:23040
    v_cmp_eq_u32 s[66:67], 19, v216
    s_waitcnt lgkmcnt(14)
    v_mfma_f32_32x32x16_bf16 v[80:95], v[128:131], v[152:155], v[80:95]
    s_waitcnt lgkmcnt(0)
    s_waitcnt vmcnt(0)
    s_barrier
    v_mfma_f32_32x32x16_bf16 v[0:15], v[160:163], v[156:159], v[0:15]
    ds_read_b128 v[128:131], v188
    ds_read_b64_tr_b16 v[132:133], v194 offset:0
    ds_read_b64_tr_b16 v[134:135], v194 offset:512
    v_mfma_f32_32x32x16_bf16 v[16:31], v[164:167], v[156:159], v[16:31]
    ds_read_b64_tr_b16 v[136:137], v195 offset:0
    ds_read_b64_tr_b16 v[138:139], v195 offset:512
    ds_read_b128 v[204:207], v202 offset:896
    v_mfma_f32_32x32x16_bf16 v[32:47], v[168:171], v[156:159], v[32:47]
    ds_read_b64_tr_b16 v[140:141], v194 offset:8192
    ds_read_b64_tr_b16 v[142:143], v194 offset:8704
    ds_read_b64_tr_b16 v[144:145], v195 offset:8192
    v_mfma_f32_32x32x16_bf16 v[48:63], v[172:175], v[156:159], v[48:63]
    ds_read_b64_tr_b16 v[146:147], v195 offset:8704
    ds_read_b64_tr_b16 v[148:149], v194 offset:16384
    ds_read_b64_tr_b16 v[150:151], v194 offset:16896
    v_mfma_f32_16x16x32_bf16 v[250:253], v[208:211], v[156:159], v[250:253]
    v_mfma_f32_32x32x16_bf16 v[64:79], v[176:179], v[156:159], v[64:79]
    ds_read_b64_tr_b16 v[152:153], v195 offset:16384
    ds_read_b64_tr_b16 v[154:155], v195 offset:16896
    v_mfma_f32_32x32x16_bf16 v[80:95], v[156:159], v[180:183], v[80:95]
    s_waitcnt lgkmcnt(11)
    v_mfma_f32_32x32x16_bf16 v[0:15], v[132:135], v[128:131], v[0:15]
    ds_read_b128 v[156:159], v189
    ds_read_b64_tr_b16 v[160:161], v194 offset:2048
    ds_read_b64_tr_b16 v[162:163], v194 offset:2560
    s_lshl_b32 s68, s37, 3
    v_mov_b32 v255, s68
    s_cmp_eq_u32 s36, 1
    s_cbranch_scc0 f_noinv
    buffer_inv sc1
    f_noinv:
    s_cmp_eq_u32 s36, 0
    s_cbranch_scc0 f_noat
    v_mov_b32 v254, 1
    s_mov_b64 s[68:69], exec
    s_mov_b64 exec, 1
    buffer_atomic_add v254, v255, s[4:7], 0 offen sc1
    s_mov_b64 exec, s[68:69]
    f_noat:
    v_mov_b32 v109, 0
    s_waitcnt lgkmcnt(12)
    v_mfma_f32_32x32x16_bf16 v[16:31], v[136:139], v[128:131], v[16:31]
    ds_read_b64_tr_b16 v[164:165], v195 offset:2048
    ds_read_b64_tr_b16 v[166:167], v195 offset:2560
    ds_read_b128 v[208:211], v202 offset:928
    s_nop 0
    v_cndmask_b32 v109, v109, v217, s[64:65]
    s_waitcnt lgkmcnt(12)
    v_mfma_f32_32x32x16_bf16 v[32:47], v[140:143], v[128:131], v[32:47]
    ds_read_b64_tr_b16 v[168:169], v194 offset:10240
    ds_read_b64_tr_b16 v[170:171], v194 offset:10752
    ds_read_b64_tr_b16 v[172:173], v195 offset:10240
    v_cndmask_b32 v109, v109, v215, s[66:67]
    v_cmp_eq_u32 s[64:65], 24, v216
    s_waitcnt lgkmcnt(13)
    v_mfma_f32_32x32x16_bf16 v[48:63], v[144:147], v[128:131], v[48:63]
    ds_read_b64_tr_b16 v[174:175], v195 offset:10752
    ds_read_b64_tr_b16 v[176:177], v194 offset:18432
    ds_read_b64_tr_b16 v[178:179], v194 offset:18944
    v_cmp_eq_u32 s[66:67], 25, v216
    v_mov_b32 v110, 0
    v_mfma_f32_16x16x32_bf16 v[250:253], v[204:207], v[128:131], v[250:253]
    s_waitcnt lgkmcnt(14)
    v_mfma_f32_32x32x16_bf16 v[64:79], v[148:151], v[128:131], v[64:79]
    ds_read_b64_tr_b16 v[180:181], v195 offset:18432
    ds_read_b64_tr_b16 v[182:183], v195 offset:18944
    s_nop 0
    v_cndmask_b32 v110, v110, v217, s[64:65]
    s_waitcnt lgkmcnt(14)
    v_mfma_f32_32x32x16_bf16 v[80:95], v[128:131], v[152:155], v[80:95]
    s_waitcnt lgkmcnt(11)
    v_mfma_f32_32x32x16_bf16 v[0:15], v[160:163], v[156:159], v[0:15]
    ds_read_b128 v[128:131], v190
    ds_read_b64_tr_b16 v[132:133], v194 offset:4096
    ds_read_b64_tr_b16 v[134:135], v194 offset:4608
    v_cndmask_b32 v110, v110, v215, s[66:67]
    v_cmp_eq_u32 s[64:65], 26, v216
    s_waitcnt lgkmcnt(12)
    v_mfma_f32_32x32x16_bf16 v[16:31], v[164:167], v[156:159], v[16:31]
    ds_read_b64_tr_b16 v[136:137], v195 offset:4096
    ds_read_b64_tr_b16 v[138:139], v195 offset:4608
    ds_read_b128 v[204:207], v202 offset:960
    v_cmp_eq_u32 s[66:67], 27, v216
    v_mov_b32 v111, 0
    s_waitcnt lgkmcnt(12)
    v_mfma_f32_32x32x16_bf16 v[32:47], v[168:171], v[156:159], v[32:47]
    ds_read_b64_tr_b16 v[140:141], v194 offset:12288
    ds_read_b64_tr_b16 v[142:143], v194 offset:12800
    ds_read_b64_tr_b16 v[144:145], v195 offset:12288
    s_nop 0
    v_cndmask_b32 v111, v111, v217, s[64:65]
    s_waitcnt lgkmcnt(13)
    v_mfma_f32_32x32x16_bf16 v[48:63], v[172:175], v[156:159], v[48:63]
    ds_read_b64_tr_b16 v[146:147], v195 offset:12800
    ds_read_b64_tr_b16 v[148:149], v194 offset:20480
    ds_read_b64_tr_b16 v[150:151], v194 offset:20992
    v_cndmask_b32 v111, v111, v215, s[66:67]
    v_mfma_f32_16x16x32_bf16 v[250:253], v[208:211], v[156:159], v[250:253]
    s_waitcnt lgkmcnt(14)
    v_mfma_f32_32x32x16_bf16 v[64:79], v[176:179], v[156:159], v[64:79]
    ds_read_b64_tr_b16 v[152:153], v195 offset:20480
    ds_read_b64_tr_b16 v[154:155], v195 offset:20992
    s_waitcnt lgkmcnt(14)
    v_mfma_f32_32x32x16_bf16 v[80:95], v[156:159], v[180:183], v[80:95]
    s_waitcnt lgkmcnt(11)
    v_mfma_f32_32x32x16_bf16 v[0:15], v[132:135], v[128:131], v[0:15]
    ds_read_b128 v[156:159], v191
    ds_read_b64_tr_b16 v[160:161], v194 offset:6144
    ds_read_b64_tr_b16 v[162:163], v194 offset:6656
    s_waitcnt lgkmcnt(12)
    v_mfma_f32_32x32x16_bf16 v[16:31], v[136:139], v[128:131], v[16:31]
    ds_read_b64_tr_b16 v[164:165], v195 offset:6144
    ds_read_b64_tr_b16 v[166:167], v195 offset:6656
    ds_read_b128 v[208:211], v202 offset:992
    s_waitcnt lgkmcnt(12)
    v_mfma_f32_32x32x16_bf16 v[32:47], v[140:143], v[128:131], v[32:47]
    ds_read_b64_tr_b16 v[168:169], v194 offset:14336
    ds_read_b64_tr_b16 v[170:171], v194 offset:14848
    ds_read_b64_tr_b16 v[172:173], v195 offset:14336
    s_waitcnt lgkmcnt(13)
    v_mfma_f32_32x32x16_bf16 v[48:63], v[144:147], v[128:131], v[48:63]
    ds_read_b64_tr_b16 v[174:175], v195 offset:14848
    ds_read_b64_tr_b16 v[176:177], v194 offset:22528
    ds_read_b64_tr_b16 v[178:179], v194 offset:23040
    v_mfma_f32_16x16x32_bf16 v[250:253], v[204:207], v[128:131], v[250:253]
    s_waitcnt lgkmcnt(14)
    v_mfma_f32_32x32x16_bf16 v[64:79], v[148:151], v[128:131], v[64:79]
    ds_read_b64_tr_b16 v[180:181], v195 offset:22528
    ds_read_b64_tr_b16 v[182:183], v195 offset:23040
    s_waitcnt lgkmcnt(14)
    v_mfma_f32_32x32x16_bf16 v[80:95], v[128:131], v[152:155], v[80:95]
    s_waitcnt lgkmcnt(0)
    v_mfma_f32_32x32x16_bf16 v[0:15], v[160:163], v[156:159], v[0:15]
    v_mfma_f32_32x32x16_bf16 v[16:31], v[164:167], v[156:159], v[16:31]
    v_mfma_f32_32x32x16_bf16 v[32:47], v[168:171], v[156:159], v[32:47]
    v_mfma_f32_32x32x16_bf16 v[48:63], v[172:175], v[156:159], v[48:63]
    v_mfma_f32_16x16x32_bf16 v[250:253], v[208:211], v[156:159], v[250:253]
    v_mfma_f32_32x32x16_bf16 v[64:79], v[176:179], v[156:159], v[64:79]
    v_mfma_f32_32x32x16_bf16 v[80:95], v[156:159], v[180:183], v[80:95]
    v_bfe_u32 v215, v200, 2, 2
    v_lshl_add_u32 v215, v213, 2, v215
    v_lshlrev_b32 v215, 5, v215
    v_and_b32 v216, 3, v200
    v_lshl_add_u32 v215, v216, 3, v215
    v_add_u32 v215, 156672, v215
    ds_read_b64_tr_b16 v[218:219], v215
    ds_read_b64_tr_b16 v[220:221], v215 offset:256
    v_cmp_lt_u32 vcc, 15, v214
    v_mov_b32 v215, 0x80008000
    v_mov_b32 v216, 0
    v_cndmask_b32 v215, v216, v215, vcc
    s_waitcnt lgkmcnt(0)
    v_xor_b32 v218, v218, v215
    v_xor_b32 v219, v219, v215
    v_xor_b32 v220, v220, v215
    v_xor_b32 v221, v221, v215
    s_nop 3
    v_cvt_pk_bf16_f32 v112, v64, v65
    v_cvt_pk_bf16_f32 v116, v72, v73
    v_cvt_pk_bf16_f32 v113, v66, v67
    v_cvt_pk_bf16_f32 v117, v74, v75
    v_cvt_pk_bf16_f32 v114, v68, v69
    v_cvt_pk_bf16_f32 v118, v76, v77
    v_cvt_pk_bf16_f32 v115, v70, v71
    v_cvt_pk_bf16_f32 v119, v78, v79
    s_nop 1
    v_mfma_f32_32x32x16_bf16 v[226:241], v[218:221], v[112:115], 0
    v_mfma_f32_32x32x16_bf16 v[64:79], v[218:221], v[116:119], 0
    s_mov_b32 s70, 0x3e0293ee
    s_mov_b32 s71, 0x3e0293ee
    v_pk_mul_f32 v[0:1], v[0:1], s[70:71]
    v_pk_mul_f32 v[2:3], v[2:3], s[70:71]
    v_pk_mul_f32 v[4:5], v[4:5], s[70:71]
    v_pk_mul_f32 v[6:7], v[6:7], s[70:71]
    v_pk_mul_f32 v[8:9], v[8:9], s[70:71]
    v_pk_mul_f32 v[10:11], v[10:11], s[70:71]
    v_pk_mul_f32 v[12:13], v[12:13], s[70:71]
    v_pk_mul_f32 v[14:15], v[14:15], s[70:71]
    v_cvt_pk_bf16_f32 v128, v0, v1
    v_cvt_pk_bf16_f32 v129, v2, v3
    v_cvt_pk_bf16_f32 v130, v4, v5
    v_cvt_pk_bf16_f32 v131, v6, v7
    v_cvt_pk_bf16_f32 v132, v8, v9
    v_cvt_pk_bf16_f32 v133, v10, v11
    v_cvt_pk_bf16_f32 v134, v12, v13
    v_cvt_pk_bf16_f32 v135, v14, v15
    v_pk_mul_f32 v[16:17], v[16:17], s[70:71]
    v_pk_mul_f32 v[18:19], v[18:19], s[70:71]
    v_pk_mul_f32 v[20:21], v[20:21], s[70:71]
    v_pk_mul_f32 v[22:23], v[22:23], s[70:71]
    v_pk_mul_f32 v[24:25], v[24:25], s[70:71]
    v_pk_mul_f32 v[26:27], v[26:27], s[70:71]
    v_pk_mul_f32 v[28:29], v[28:29], s[70:71]
    v_pk_mul_f32 v[30:31], v[30:31], s[70:71]
    v_cvt_pk_bf16_f32 v136, v16, v17
    v_cvt_pk_bf16_f32 v137, v18, v19
    v_cvt_pk_bf16_f32 v138, v20, v21
    v_cvt_pk_bf16_f32 v139, v22, v23
    v_cvt_pk_bf16_f32 v140, v24, v25
    v_cvt_pk_bf16_f32 v141, v26, v27
    v_cvt_pk_bf16_f32 v142, v28, v29
    v_cvt_pk_bf16_f32 v143, v30, v31
    v_pk_mul_f32 v[32:33], v[32:33], s[70:71]
    v_pk_mul_f32 v[34:35], v[34:35], s[70:71]
    v_pk_mul_f32 v[36:37], v[36:37], s[70:71]
    v_pk_mul_f32 v[38:39], v[38:39], s[70:71]
    v_pk_mul_f32 v[40:41], v[40:41], s[70:71]
    v_pk_mul_f32 v[42:43], v[42:43], s[70:71]
    v_pk_mul_f32 v[44:45], v[44:45], s[70:71]
    v_pk_mul_f32 v[46:47], v[46:47], s[70:71]
    v_cvt_pk_bf16_f32 v144, v32, v33
    v_cvt_pk_bf16_f32 v145, v34, v35
    v_cvt_pk_bf16_f32 v146, v36, v37
    v_cvt_pk_bf16_f32 v147, v38, v39
    v_cvt_pk_bf16_f32 v148, v40, v41
    v_cvt_pk_bf16_f32 v149, v42, v43
    v_cvt_pk_bf16_f32 v150, v44, v45
    v_cvt_pk_bf16_f32 v151, v46, v47
    v_pk_mul_f32 v[48:49], v[48:49], s[70:71]
    v_pk_mul_f32 v[50:51], v[50:51], s[70:71]
    v_pk_mul_f32 v[52:53], v[52:53], s[70:71]
    v_pk_mul_f32 v[54:55], v[54:55], s[70:71]
    v_pk_mul_f32 v[56:57], v[56:57], s[70:71]
    v_pk_mul_f32 v[58:59], v[58:59], s[70:71]
    v_pk_mul_f32 v[60:61], v[60:61], s[70:71]
    v_pk_mul_f32 v[62:63], v[62:63], s[70:71]
    v_cvt_pk_bf16_f32 v152, v48, v49
    v_cvt_pk_bf16_f32 v153, v50, v51
    v_cvt_pk_bf16_f32 v154, v52, v53
    v_cvt_pk_bf16_f32 v155, v54, v55
    v_cvt_pk_bf16_f32 v156, v56, v57
    v_cvt_pk_bf16_f32 v157, v58, v59
    v_cvt_pk_bf16_f32 v158, v60, v61
    v_cvt_pk_bf16_f32 v159, v62, v63
    v_and_b32 v215, 27, v214
    v_cmp_eq_u32 vcc, 16, v215
    v_mov_b32 v216, 0x3f803f80
    v_cvt_pk_bf16_f32 v120, v80, v81
    v_cvt_pk_bf16_f32 v121, v82, v83
    v_cvt_pk_bf16_f32 v122, v84, v85
    v_cvt_pk_bf16_f32 v123, v86, v87
    v_cvt_pk_bf16_f32 v124, v88, v89
    v_cvt_pk_bf16_f32 v125, v90, v91
    v_cvt_pk_bf16_f32 v126, v92, v93
    v_cvt_pk_bf16_f32 v127, v94, v95
    v_cndmask_b32 v120, v120, v216, vcc
    v_cndmask_b32 v121, v121, v216, vcc
    v_cndmask_b32 v122, v122, v216, vcc
    v_cndmask_b32 v123, v123, v216, vcc
    v_cndmask_b32 v124, v124, v216, vcc
    v_cndmask_b32 v125, v125, v216, vcc
    v_cndmask_b32 v126, v126, v216, vcc
    v_cndmask_b32 v127, v127, v216, vcc
    s_mov_b32 s69, 0x3fb8aa3b
    v_max3_f32 v160, v226, v227, v228
    v_max3_f32 v162, v234, v235, v236
    v_max3_f32 v164, v64, v65, v66
    v_max3_f32 v166, v72, v73, v74
    v_max3_f32 v160, v160, v229, v230
    v_max3_f32 v162, v162, v237, v238
    v_max3_f32 v164, v164, v67, v68
    v_max3_f32 v166, v166, v75, v76
    v_max3_f32 v160, v160, v231, v232
    v_max3_f32 v162, v162, v239, v240
    v_max3_f32 v164, v164, v69, v70
    v_max3_f32 v166, v166, v77, v78
    v_max_f32 v160, v160, v233
    v_max_f32 v162, v162, v241
    v_max_f32 v164, v164, v71
    v_max_f32 v166, v166, v79
    v_mov_b32 v161, v160
    v_mov_b32 v163, v162
    v_mov_b32 v165, v164
    v_mov_b32 v167, v166
    v_and_b32 v168, 15, v200
    v_lshlrev_b32 v168, 2, v168
    ds_bpermute_b32 v212, v168, v250
    ds_bpermute_b32 v169, v168, v251
    v_permlane32_swap_b32 v160, v161
    v_permlane32_swap_b32 v162, v163
    v_permlane32_swap_b32 v164, v165
    v_permlane32_swap_b32 v166, v167
    v_cmp_lt_u32 vcc, 15, v214
    s_waitcnt lgkmcnt(0)
    v_max_f32 v160, v160, v161
    v_max_f32 v162, v162, v163
    v_max_f32 v164, v164, v165
    v_max_f32 v166, v166, v167
    v_cndmask_b32 v212, v212, v169, vcc
    v_mul_f32 v160, 0xbfb8aa3b, v160
    v_mul_f32 v162, 0xbfb8aa3b, v162
    v_mul_f32 v164, 0xbfb8aa3b, v164
    v_mul_f32 v166, 0xbfb8aa3b, v166
    v_mul_f32 v212, 0xbfb8aa3b, v212
    v_fma_f32 v226, v226, s69, v160
    v_fma_f32 v227, v227, s69, v160
    v_fma_f32 v228, v228, s69, v160
    v_fma_f32 v229, v229, s69, v160
    v_fma_f32 v230, v230, s69, v160
    v_fma_f32 v231, v231, s69, v160
    v_fma_f32 v232, v232, s69, v160
    v_fma_f32 v233, v233, s69, v160
    v_fma_f32 v234, v234, s69, v162
    v_fma_f32 v235, v235, s69, v162
    v_fma_f32 v236, v236, s69, v162
    v_fma_f32 v237, v237, s69, v162
    v_fma_f32 v238, v238, s69, v162
    v_fma_f32 v239, v239, s69, v162
    v_fma_f32 v240, v240, s69, v162
    v_fma_f32 v241, v241, s69, v162
    v_fma_f32 v64, v64, s69, v164
    v_fma_f32 v65, v65, s69, v164
    v_fma_f32 v66, v66, s69, v164
    v_fma_f32 v67, v67, s69, v164
    v_fma_f32 v68, v68, s69, v164
    v_fma_f32 v69, v69, s69, v164
    v_fma_f32 v70, v70, s69, v164
    v_fma_f32 v71, v71, s69, v164
    v_fma_f32 v72, v72, s69, v166
    v_fma_f32 v73, v73, s69, v166
    v_fma_f32 v74, v74, s69, v166
    v_fma_f32 v75, v75, s69, v166
    v_fma_f32 v76, v76, s69, v166
    v_fma_f32 v77, v77, s69, v166
    v_fma_f32 v78, v78, s69, v166
    v_fma_f32 v79, v79, s69, v166
    v_exp_f32 v212, v212
    v_exp_f32 v226, v226
    v_exp_f32 v227, v227
    v_exp_f32 v228, v228
    v_exp_f32 v229, v229
    v_exp_f32 v230, v230
    v_exp_f32 v231, v231
    v_exp_f32 v232, v232
    v_exp_f32 v233, v233
    v_exp_f32 v234, v234
    v_exp_f32 v235, v235
    v_exp_f32 v236, v236
    v_exp_f32 v237, v237
    v_exp_f32 v238, v238
    v_exp_f32 v239, v239
    v_exp_f32 v240, v240
    v_exp_f32 v241, v241
    v_exp_f32 v64, v64
    v_exp_f32 v65, v65
    v_exp_f32 v66, v66
    v_exp_f32 v67, v67
    v_exp_f32 v68, v68
    v_exp_f32 v69, v69
    v_exp_f32 v70, v70
    v_exp_f32 v71, v71
    v_exp_f32 v72, v72
    v_exp_f32 v73, v73
    v_exp_f32 v74, v74
    v_exp_f32 v75, v75
    v_exp_f32 v76, v76
    v_exp_f32 v77, v77
    v_exp_f32 v78, v78
    v_exp_f32 v79, v79
    v_add_f32 v212, 1.0, v212
    v_add_f32 v160, v226, v227
    v_add_f32 v162, v234, v235
    v_add_f32 v164, v64, v65
    v_add_f32 v166, v72, v73
    v_add_f32 v160, v160, v228
    v_add_f32 v162, v162, v236
    v_add_f32 v164, v164, v66
    v_add_f32 v166, v166, v74
    v_add_f32 v160, v160, v229
    v_add_f32 v162, v162, v237
    v_add_f32 v164, v164, v67
    v_add_f32 v166, v166, v75
    v_add_f32 v160, v160, v230
    v_add_f32 v162, v162, v238
    v_add_f32 v164, v164, v68
    v_add_f32 v166, v166, v76
    v_add_f32 v160, v160, v231
    v_add_f32 v162, v162, v239
    v_add_f32 v164, v164, v69
    v_add_f32 v166, v166, v77
    v_add_f32 v160, v160, v232
    v_add_f32 v162, v162, v240
    v_add_f32 v164, v164, v70
    v_add_f32 v166, v166, v78
    v_add_f32 v160, v160, v233
    v_add_f32 v162, v162, v241
    v_add_f32 v164, v164, v71
    v_add_f32 v166, v166, v79
    v_mov_b32 v161, v160
    v_mov_b32 v163, v162
    v_mov_b32 v165, v164
    v_mov_b32 v167, v166
    v_rcp_f32 v212, v212
    s_nop 0
    v_permlane32_swap_b32 v160, v161
    v_permlane32_swap_b32 v162, v163
    v_permlane32_swap_b32 v164, v165
    v_permlane32_swap_b32 v166, v167
    s_nop 0
    v_add_f32 v160, v160, v161
    v_add_f32 v162, v162, v163
    v_add_f32 v164, v164, v165
    v_add_f32 v166, v166, v167
    v_rcp_f32 v160, v160
    v_rcp_f32 v162, v162
    v_rcp_f32 v164, v164
    v_rcp_f32 v166, v166
    s_nop 0
    v_mul_f32 v226, v160, v226
    v_mul_f32 v227, v160, v227
    v_mul_f32 v228, v160, v228
    v_mul_f32 v229, v160, v229
    v_mul_f32 v230, v160, v230
    v_mul_f32 v231, v160, v231
    v_mul_f32 v232, v160, v232
    v_mul_f32 v233, v160, v233
    v_mul_f32 v234, v162, v234
    v_mul_f32 v235, v162, v235
    v_mul_f32 v236, v162, v236
    v_mul_f32 v237, v162, v237
    v_mul_f32 v238, v162, v238
    v_mul_f32 v239, v162, v239
    v_mul_f32 v240, v162, v240
    v_mul_f32 v241, v162, v241
    v_mul_f32 v64, v164, v64
    v_mul_f32 v65, v164, v65
    v_mul_f32 v66, v164, v66
    v_mul_f32 v67, v164, v67
    v_mul_f32 v68, v164, v68
    v_mul_f32 v69, v164, v69
    v_mul_f32 v70, v164, v70
    v_mul_f32 v71, v164, v71
    v_mul_f32 v72, v166, v72
    v_mul_f32 v73, v166, v73
    v_mul_f32 v74, v166, v74
    v_mul_f32 v75, v166, v75
    v_mul_f32 v76, v166, v76
    v_mul_f32 v77, v166, v77
    v_mul_f32 v78, v166, v78
    v_mul_f32 v79, v166, v79
    s_cmp_lg_u32 s36, 0
    s_cbranch_scc1 f_nopoll
    buffer_load_dword v224, v255, s[4:7], 0 offen sc1
f_nopoll:
    v_cvt_pk_bf16_f32 v64, v64, v65
    v_cvt_pk_bf16_f32 v65, v66, v67
    v_cvt_pk_bf16_f32 v66, v68, v69
    v_cvt_pk_bf16_f32 v67, v70, v71
    v_cvt_pk_bf16_f32 v72, v72, v73
    v_cvt_pk_bf16_f32 v73, v74, v75
    v_cvt_pk_bf16_f32 v74, v76, v77
    v_cvt_pk_bf16_f32 v75, v78, v79
    s_nop 0
    v_mfma_f32_32x32x16_bf16 v[0:15], v[64:67], v[104:107], 0
    v_mfma_f32_32x32x16_bf16 v[0:15], v[72:75], v[108:111], v[0:15]
    v_cvt_pk_bf16_f32 v242, v226, v227
    v_cvt_pk_bf16_f32 v243, v228, v229
    v_cvt_pk_bf16_f32 v244, v230, v231
    v_cvt_pk_bf16_f32 v245, v232, v233
    v_cvt_pk_bf16_f32 v246, v234, v235
    v_cvt_pk_bf16_f32 v247, v236, v237
    v_cvt_pk_bf16_f32 v248, v238, v239
    v_cvt_pk_bf16_f32 v249, v240, v241
    s_nop 7
    s_nop 3
    v_cvt_pk_bf16_f32 v0, v0, v1
    v_cvt_pk_bf16_f32 v1, v2, v3
    v_cvt_pk_bf16_f32 v2, v4, v5
    v_cvt_pk_bf16_f32 v3, v6, v7
    v_cvt_pk_bf16_f32 v8, v8, v9
    v_cvt_pk_bf16_f32 v9, v10, v11
    v_cvt_pk_bf16_f32 v10, v12, v13
    v_cvt_pk_bf16_f32 v11, v14, v15
    s_nop 1
    v_mfma_f32_32x32x16_bf16 v[16:31], v[0:3], v[120:123], 0
    v_mfma_f32_32x32x16_bf16 v[16:31], v[8:11], v[124:127], v[16:31]
    s_cmp_lt_u32 s36, 4
    s_cselect_b32 s66, 0, 2560
    s_add_u32 s66, s66, s44
    s_add_u32 s66, s66, 114688
    v_add_u32 v215, s66, v201
    v_and_b32 v160, 3, v203
    v_lshlrev_b32 v160, 10, v160
    v_lshrrev_b32 v161, 2, v203
    v_lshl_add_u32 v160, v161, 4, v160
    v_add_u32 v160, 114688, v160
    s_lshl_b32 s48, s37, 15
    s_lshl_b32 s49, s38, 12
    s_add_u32 s48, s48, s49
    s_add_u32 s48, s48, 81788928
    v_lshlrev_b32 v162, 4, v203
    s_nop 7
    s_nop 1
    ds_write_b128 v215, v[16:19] offset:0
    ds_write_b128 v215, v[20:23] offset:1024
    ds_write_b128 v215, v[24:27] offset:2048
    ds_write_b128 v215, v[28:31] offset:3072
    v_mov_b32 v215, 131072
    v_mov_b32 v216, 0
    ds_write_b32 v215, v216
    s_cmp_lg_u32 s36, 0
    s_cbranch_scc1 f_sync_done
    s_mov_b32 s66, 40000
f_spin:
    s_waitcnt vmcnt(0)
    v_readfirstlane_b32 s67, v224
    s_cmp_ge_u32 s67, 8
    s_cbranch_scc1 f_spin_out
    buffer_load_dword v224, v255, s[4:7], 0 offen sc1
    s_sub_u32 s66, s66, 1
    s_cmp_lg_u32 s66, 0
    s_cbranch_scc1 f_spin
    s_waitcnt vmcnt(0)
f_spin_out:
f_sync_done:
    s_waitcnt vmcnt(0) lgkmcnt(0)
    s_barrier
    s_cmp_ge_u32 s36, 4
    s_cbranch_scc1 f_nored
    ds_read_b128 v[32:35], v160 offset:0
    ds_read_b128 v[36:39], v160 offset:4096
    ds_read_b128 v[40:43], v160 offset:8192
    ds_read_b128 v[44:47], v160 offset:12288
    ds_read_b128 v[48:51], v160 offset:18944
    ds_read_b128 v[52:55], v160 offset:23040
    ds_read_b128 v[56:59], v160 offset:27136
    ds_read_b128 v[60:63], v160 offset:31232
    s_waitcnt lgkmcnt(0)
    v_pk_add_f32 v[32:33], v[32:33], v[48:49]
    v_pk_add_f32 v[34:35], v[34:35], v[50:51]
    v_pk_add_f32 v[36:37], v[36:37], v[52:53]
    v_pk_add_f32 v[38:39], v[38:39], v[54:55]
    v_pk_add_f32 v[40:41], v[40:41], v[56:57]
    v_pk_add_f32 v[42:43], v[42:43], v[58:59]
    v_pk_add_f32 v[44:45], v[44:45], v[60:61]
    v_pk_add_f32 v[46:47], v[46:47], v[62:63]
    v_pk_add_f32 v[32:33], v[32:33], v[40:41]
    v_pk_add_f32 v[34:35], v[34:35], v[42:43]
    v_pk_add_f32 v[36:37], v[36:37], v[44:45]
    v_pk_add_f32 v[38:39], v[38:39], v[46:47]
    v_pk_add_f32 v[32:33], v[32:33], v[36:37]
    v_pk_add_f32 v[34:35], v[34:35], v[38:39]
    buffer_store_dwordx4 v[32:35], v162, s[28:31], s48 offen sc1
    s_branch f_predone
f_nored:
    s_and_b32 s11, s36, 3
    s_lshl_b32 s16, s37, 20
    s_lshl_b32 s13, s11, 12
    s_add_u32 s16, s16, s13
    s_add_u32 m0, s13, 0
    s_add_u32 s19, s16, 0
    buffer_load_dwordx4 v201, s[28:31], s19 offen offset:0 lds
    buffer_load_dwordx4 v201, s[28:31], s19 offen offset:1024 lds
    buffer_load_dwordx4 v201, s[28:31], s19 offen offset:2048 lds
    buffer_load_dwordx4 v201, s[28:31], s19 offen offset:3072 lds
    s_add_u32 m0, s13, 32768
    s_add_u32 s19, s16, 32768
    buffer_load_dwordx4 v201, s[28:31], s19 offen offset:0 lds
    buffer_load_dwordx4 v201, s[28:31], s19 offen offset:1024 lds
    buffer_load_dwordx4 v201, s[28:31], s19 offen offset:2048 lds
    buffer_load_dwordx4 v201, s[28:31], s19 offen offset:3072 lds
    s_add_u32 m0, s13, 16384
    s_add_u32 s19, s16, 16384
    buffer_load_dwordx4 v201, s[28:31], s19 offen offset:0 lds
    buffer_load_dwordx4 v201, s[28:31], s19 offen offset:1024 lds
    buffer_load_dwordx4 v201, s[28:31], s19 offen offset:2048 lds
    buffer_load_dwordx4 v201, s[28:31], s19 offen offset:3072 lds
    s_add_u32 m0, s13, 49152
    s_add_u32 s19, s16, 49152
    buffer_load_dwordx4 v201, s[28:31], s19 offen offset:0 lds
    buffer_load_dwordx4 v201, s[28:31], s19 offen offset:1024 lds
    buffer_load_dwordx4 v201, s[28:31], s19 offen offset:2048 lds
    buffer_load_dwordx4 v201, s[28:31], s19 offen offset:3072 lds
    s_add_u32 m0, s13, 65536
    s_add_u32 s19, s16, 65536
    buffer_load_dwordx4 v201, s[28:31], s19 offen offset:0 lds
    buffer_load_dwordx4 v201, s[28:31], s19 offen offset:1024 lds
    buffer_load_dwordx4 v201, s[28:31], s19 offen offset:2048 lds
    buffer_load_dwordx4 v201, s[28:31], s19 offen offset:3072 lds
    s_add_u32 m0, s13, 81920
    s_add_u32 s19, s16, 81920
    buffer_load_dwordx4 v201, s[28:31], s19 offen offset:0 lds
    buffer_load_dwordx4 v201, s[28:31], s19 offen offset:1024 lds
    buffer_load_dwordx4 v201, s[28:31], s19 offen offset:2048 lds
    buffer_load_dwordx4 v201, s[28:31], s19 offen offset:3072 lds
    s_add_u32 m0, s13, 98304
    s_add_u32 s19, s16, 98304
    buffer_load_dwordx4 v201, s[28:31], s19 offen offset:0 lds
    buffer_load_dwordx4 v201, s[28:31], s19 offen offset:1024 lds
    buffer_load_dwordx4 v201, s[28:31], s19 offen offset:2048 lds
    buffer_load_dwordx4 v201, s[28:31], s19 offen offset:3072 lds
    s_add_u32 s12, s16, 131072
f_predone:
    v_mov_b32 v215, v212
    v_mov_b32 v216, v203
    v_mov_b32 v217, v200
    v_mov_b32 v214, v201
    s_lshr_b32 s10, s36, 2
    s_and_b32 s11, s36, 3
    s_sub_u32 s17, 15, s38
    s_lshl_b32 s8, s39, 1
    s_add_u32 s8, s8, 2
    s_lshl_b32 s9, s17, 1
    s_add_u32 s9, s9, 2
    s_lshl_b32 s16, s37, 20
    s_lshl_b32 s17, s11, 12
    s_add_u32 s16, s16, s17
    s_mov_b32 s15, 0
    s_add_u32 s41, s16, 1015808
    s_add_u32 s42, s41, 16384
    v_and_b32 v219, 31, v217
    v_lshrrev_b32 v221, 5, v217
    v_lshlrev_b32 v221, 2, v221
    v_sub_u32 v212, v219, v221
    s_lshl_b32 s17, s11, 5
    v_add_u32 v212, s17, v212
    v_subrev_u32 v213, 64, v212
    v_mov_b32 v160, 0
    v_mov_b32 v161, 0
    v_mov_b32 v162, 0
    v_mov_b32 v163, 0
    v_mov_b32 v164, 0
    v_mov_b32 v165, 0
    v_mov_b32 v166, 0
    v_mov_b32 v167, 0
    v_mov_b32 v168, 0
    v_mov_b32 v169, 0
    v_mov_b32 v170, 0
    v_mov_b32 v171, 0
    v_mov_b32 v172, 0
    v_mov_b32 v173, 0
    v_mov_b32 v174, 0
    v_mov_b32 v175, 0
    s_lshl_b32 s40, s10, 4
    s_cmp_ge_u32 s8, 26
    s_cselect_b32 s44, 1, 2
    s_branch fa_ra
fa_restart:
    s_cmp_eq_u32 s10, 0
    s_cbranch_scc1 fa_ra
    s_lshl_b32 s13, s11, 12
    s_add_u32 m0, s13, 0
    s_add_u32 s19, s16, 0
    buffer_load_dwordx4 v214, s[28:31], s19 offen offset:0 lds
    buffer_load_dwordx4 v214, s[28:31], s19 offen offset:1024 lds
    buffer_load_dwordx4 v214, s[28:31], s19 offen offset:2048 lds
    buffer_load_dwordx4 v214, s[28:31], s19 offen offset:3072 lds
    s_add_u32 m0, s13, 32768
    s_add_u32 s19, s16, 32768
    buffer_load_dwordx4 v214, s[28:31], s19 offen offset:0 lds
    buffer_load_dwordx4 v214, s[28:31], s19 offen offset:1024 lds
    buffer_load_dwordx4 v214, s[28:31], s19 offen offset:2048 lds
    buffer_load_dwordx4 v214, s[28:31], s19 offen offset:3072 lds
    s_add_u32 m0, s13, 16384
    s_add_u32 s19, s16, 16384
    buffer_load_dwordx4 v214, s[28:31], s19 offen offset:0 lds
    buffer_load_dwordx4 v214, s[28:31], s19 offen offset:1024 lds
    buffer_load_dwordx4 v214, s[28:31], s19 offen offset:2048 lds
    buffer_load_dwordx4 v214, s[28:31], s19 offen offset:3072 lds
    s_add_u32 m0, s13, 49152
    s_add_u32 s19, s16, 49152
    buffer_load_dwordx4 v214, s[28:31], s19 offen offset:0 lds
    buffer_load_dwordx4 v214, s[28:31], s19 offen offset:1024 lds
    buffer_load_dwordx4 v214, s[28:31], s19 offen offset:2048 lds
    buffer_load_dwordx4 v214, s[28:31], s19 offen offset:3072 lds
    s_add_u32 m0, s13, 65536
    s_add_u32 s19, s16, 65536
    buffer_load_dwordx4 v214, s[28:31], s19 offen offset:0 lds
    buffer_load_dwordx4 v214, s[28:31], s19 offen offset:1024 lds
    buffer_load_dwordx4 v214, s[28:31], s19 offen offset:2048 lds
    buffer_load_dwordx4 v214, s[28:31], s19 offen offset:3072 lds
    s_add_u32 m0, s13, 81920
    s_add_u32 s19, s16, 81920
    buffer_load_dwordx4 v214, s[28:31], s19 offen offset:0 lds
    buffer_load_dwordx4 v214, s[28:31], s19 offen offset:1024 lds
    buffer_load_dwordx4 v214, s[28:31], s19 offen offset:2048 lds
    buffer_load_dwordx4 v214, s[28:31], s19 offen offset:3072 lds
    s_add_u32 m0, s13, 98304
    s_add_u32 s19, s16, 98304
    buffer_load_dwordx4 v214, s[28:31], s19 offen offset:0 lds
    buffer_load_dwordx4 v214, s[28:31], s19 offen offset:1024 lds
    buffer_load_dwordx4 v214, s[28:31], s19 offen offset:2048 lds
    buffer_load_dwordx4 v214, s[28:31], s19 offen offset:3072 lds
    s_add_u32 s12, s16, 131072
fa_ra:
    s_waitcnt vmcnt(16)
    s_barrier
fa_start:
    v_mov_b32 v0, 0
    v_mov_b32 v1, 0
    v_mov_b32 v2, 0
    v_mov_b32 v3, 0
    v_mov_b32 v4, 0
    v_mov_b32 v5, 0
    v_mov_b32 v6, 0
    v_mov_b32 v7, 0
    v_mov_b32 v8, 0
    v_mov_b32 v9, 0
    v_mov_b32 v10, 0
    v_mov_b32 v11, 0
    v_mov_b32 v12, 0
    v_mov_b32 v13, 0
    v_mov_b32 v14, 0
    v_mov_b32 v15, 0
    v_mov_b32 v16, 0
    v_mov_b32 v17, 0
    v_mov_b32 v18, 0
    v_mov_b32 v19, 0
    v_mov_b32 v20, 0
    v_mov_b32 v21, 0
    v_mov_b32 v22, 0
    v_mov_b32 v23, 0
    v_mov_b32 v24, 0
    v_mov_b32 v25, 0
    v_mov_b32 v26, 0
    v_mov_b32 v27, 0
    v_mov_b32 v28, 0
    v_mov_b32 v29, 0
    v_mov_b32 v30, 0
    v_mov_b32 v31, 0
    v_mov_b32 v32, 0
    v_mov_b32 v33, 0
    v_mov_b32 v34, 0
    v_mov_b32 v35, 0
    v_mov_b32 v36, 0
    v_mov_b32 v37, 0
    v_mov_b32 v38, 0
    v_mov_b32 v39, 0
    v_mov_b32 v40, 0
    v_mov_b32 v41, 0
    v_mov_b32 v42, 0
    v_mov_b32 v43, 0
    v_mov_b32 v44, 0
    v_mov_b32 v45, 0
    v_mov_b32 v46, 0
    v_mov_b32 v47, 0
    v_mov_b32 v48, 0
    v_mov_b32 v49, 0
    v_mov_b32 v50, 0
    v_mov_b32 v51, 0
    v_mov_b32 v52, 0
    v_mov_b32 v53, 0
    v_mov_b32 v54, 0
    v_mov_b32 v55, 0
    v_mov_b32 v56, 0
    v_mov_b32 v57, 0
    v_mov_b32 v58, 0
    v_mov_b32 v59, 0
    v_mov_b32 v60, 0
    v_mov_b32 v61, 0
    v_mov_b32 v62, 0
    v_mov_b32 v63, 0
    v_mov_b32 v210, 0
    v_mov_b32 v211, 0
    v_mov_b32 v208, v214
    ds_read_b128 v[176:179], v208 offset:0
    ds_read_b128 v[180:183], v208 offset:1024
    ds_read_b128 v[184:187], v208 offset:2048
    ds_read_b128 v[188:191], v208 offset:3072
    ds_read_b128 v[192:195], v208 offset:4096
    ds_read_b128 v[196:199], v208 offset:5120
    ds_read_b128 v[200:203], v208 offset:6144
    ds_read_b128 v[204:207], v208 offset:7168
    s_waitcnt lgkmcnt(4)
    v_mfma_f32_32x32x16_bf16 v[64:79], v[176:179], v[128:131], v[160:175]
    ds_read_b128 v[176:179], v208 offset:8192
    v_mfma_f32_32x32x16_bf16 v[64:79], v[180:183], v[132:135], v[64:79]
    ds_read_b128 v[180:183], v208 offset:9216
    v_mfma_f32_32x32x16_bf16 v[64:79], v[184:187], v[136:139], v[64:79]
    ds_read_b128 v[184:187], v208 offset:10240
    v_mfma_f32_32x32x16_bf16 v[64:79], v[188:191], v[140:143], v[64:79]
    ds_read_b128 v[188:191], v208 offset:11264
    s_waitcnt lgkmcnt(4)
    v_mfma_f32_32x32x16_bf16 v[64:79], v[192:195], v[144:147], v[64:79]
    ds_read_b128 v[192:195], v208 offset:12288
    v_mfma_f32_32x32x16_bf16 v[64:79], v[196:199], v[148:151], v[64:79]
    ds_read_b128 v[196:199], v208 offset:13312
    v_mfma_f32_32x32x16_bf16 v[64:79], v[200:203], v[152:155], v[64:79]
    ds_read_b128 v[200:203], v208 offset:14336
    v_mfma_f32_32x32x16_bf16 v[64:79], v[204:207], v[156:159], v[64:79]
    ds_read_b128 v[204:207], v208 offset:15360
    s_waitcnt lgkmcnt(4)
    v_mfma_f32_32x32x16_bf16 v[80:95], v[176:179], v[128:131], v[160:175]
    v_mfma_f32_32x32x16_bf16 v[80:95], v[180:183], v[132:135], v[80:95]
    v_mfma_f32_32x32x16_bf16 v[80:95], v[184:187], v[136:139], v[80:95]
    v_mfma_f32_32x32x16_bf16 v[80:95], v[188:191], v[140:143], v[80:95]
    s_waitcnt lgkmcnt(0)
    v_mfma_f32_32x32x16_bf16 v[80:95], v[192:195], v[144:147], v[80:95]
    v_mfma_f32_32x32x16_bf16 v[80:95], v[196:199], v[148:151], v[80:95]
    v_mfma_f32_32x32x16_bf16 v[80:95], v[200:203], v[152:155], v[80:95]
    v_mfma_f32_32x32x16_bf16 v[80:95], v[204:207], v[156:159], v[80:95]
    v_mov_b32 v209, v208
    v_add_u32 v208, 32768, v208
    ds_read_b128 v[176:179], v208 offset:0
    ds_read_b128 v[180:183], v208 offset:1024
    ds_read_b128 v[184:187], v208 offset:2048
    ds_read_b128 v[188:191], v208 offset:3072
    ds_read_b128 v[192:195], v209 offset:16384
    ds_read_b128 v[196:199], v209 offset:17408
    ds_read_b128 v[200:203], v209 offset:18432
    ds_read_b128 v[204:207], v209 offset:19456
    s_sub_u32 s17, s8, 2
    s_lshl_b32 s17, s17, 6
    v_add_u32 v218, s17, v212
    s_nop 4
    v_exp_f32 v64, v64
    v_exp_f32 v65, v65
    v_cmp_le_i32 s[20:21], 0, v218
    v_cmp_le_i32 s[22:23], 1, v218
    s_nop 1
    v_exp_f32 v66, v66
    v_exp_f32 v67, v67
    v_cmp_le_i32 s[24:25], 2, v218
    v_cmp_le_i32 s[26:27], 3, v218
    s_nop 1
    v_cndmask_b32 v64, 0, v64, s[20:21]
    v_cndmask_b32 v65, 0, v65, s[22:23]
    v_cndmask_b32 v66, 0, v66, s[24:25]
    v_cndmask_b32 v67, 0, v67, s[26:27]
    v_add_f32 v210, v210, v64
    v_add_f32 v211, v211, v65
    v_add_f32 v210, v210, v66
    v_add_f32 v211, v211, v67
    s_nop 1
    v_cvt_pk_bf16_f32 v64, v64, v65
    v_cvt_pk_bf16_f32 v65, v66, v67
    s_nop 1
    v_exp_f32 v68, v68
    v_exp_f32 v69, v69
    v_cmp_le_i32 s[20:21], 8, v218
    v_cmp_le_i32 s[22:23], 9, v218
    s_nop 1
    v_exp_f32 v70, v70
    v_exp_f32 v71, v71
    v_cmp_le_i32 s[24:25], 10, v218
    v_cmp_le_i32 s[26:27], 11, v218
    s_nop 1
    v_cndmask_b32 v68, 0, v68, s[20:21]
    v_cndmask_b32 v69, 0, v69, s[22:23]
    v_cndmask_b32 v70, 0, v70, s[24:25]
    v_cndmask_b32 v71, 0, v71, s[26:27]
    v_add_f32 v210, v210, v68
    v_add_f32 v211, v211, v69
    v_add_f32 v210, v210, v70
    v_add_f32 v211, v211, v71
    s_nop 1
    v_cvt_pk_bf16_f32 v66, v68, v69
    v_cvt_pk_bf16_f32 v67, v70, v71
    s_nop 1
    v_exp_f32 v72, v72
    v_exp_f32 v73, v73
    v_cmp_le_i32 s[20:21], 16, v218
    v_cmp_le_i32 s[22:23], 17, v218
    s_nop 1
    v_exp_f32 v74, v74
    v_exp_f32 v75, v75
    v_cmp_le_i32 s[24:25], 18, v218
    v_cmp_le_i32 s[26:27], 19, v218
    s_nop 1
    v_cndmask_b32 v72, 0, v72, s[20:21]
    v_cndmask_b32 v73, 0, v73, s[22:23]
    v_cndmask_b32 v74, 0, v74, s[24:25]
    v_cndmask_b32 v75, 0, v75, s[26:27]
    v_add_f32 v210, v210, v72
    v_add_f32 v211, v211, v73
    v_add_f32 v210, v210, v74
    v_add_f32 v211, v211, v75
    s_nop 1
    v_cvt_pk_bf16_f32 v72, v72, v73
    v_cvt_pk_bf16_f32 v73, v74, v75
    s_nop 1
    v_exp_f32 v76, v76
    v_exp_f32 v77, v77
    v_cmp_le_i32 s[20:21], 24, v218
    v_cmp_le_i32 s[22:23], 25, v218
    s_nop 1
    v_exp_f32 v78, v78
    v_exp_f32 v79, v79
    v_cmp_le_i32 s[24:25], 26, v218
    v_cmp_le_i32 s[26:27], 27, v218
    s_nop 1
    v_cndmask_b32 v76, 0, v76, s[20:21]
    v_cndmask_b32 v77, 0, v77, s[22:23]
    v_cndmask_b32 v78, 0, v78, s[24:25]
    v_cndmask_b32 v79, 0, v79, s[26:27]
    v_add_f32 v210, v210, v76
    v_add_f32 v211, v211, v77
    v_add_f32 v210, v210, v78
    v_add_f32 v211, v211, v79
    s_nop 1
    v_cvt_pk_bf16_f32 v74, v76, v77
    v_cvt_pk_bf16_f32 v75, v78, v79
    s_nop 1
    s_sub_u32 s14, s8, 4
    s_lshr_b32 s14, s14, 1
    s_cmp_eq_u32 s8, 2
    s_cbranch_scc1 fa_V2
fa_loop:
    s_cmp_lt_u32 s40, 12
    s_cbranch_scc1 fa_side
fa_loop_b:
    s_waitcnt lgkmcnt(4)
    v_mfma_f32_32x32x16_bf16 v[96:111], v[176:179], v[128:131], v[160:175]
    ds_read_b128 v[176:179], v208 offset:4096
    v_exp_f32 v80, v80
    v_exp_f32 v81, v81
    v_mfma_f32_32x32x16_bf16 v[96:111], v[180:183], v[132:135], v[96:111]
    ds_read_b128 v[180:183], v208 offset:5120
    v_exp_f32 v82, v82
    v_exp_f32 v83, v83
    v_mfma_f32_32x32x16_bf16 v[96:111], v[184:187], v[136:139], v[96:111]
    ds_read_b128 v[184:187], v208 offset:6144
    v_add_f32 v210, v210, v80
    v_add_f32 v211, v211, v81
    v_add_f32 v210, v210, v82
    v_add_f32 v211, v211, v83
    v_mfma_f32_32x32x16_bf16 v[96:111], v[188:191], v[140:143], v[96:111]
    ds_read_b128 v[188:191], v208 offset:7168
    v_cvt_pk_bf16_f32 v80, v80, v81
    v_cvt_pk_bf16_f32 v81, v82, v83
    s_waitcnt lgkmcnt(4)
    v_mfma_f32_32x32x16_bf16 v[0:15], v[192:195], v[64:67], v[0:15]
    ds_read_b128 v[192:195], v209 offset:20480
    v_exp_f32 v84, v84
    v_exp_f32 v85, v85
    v_mfma_f32_32x32x16_bf16 v[16:31], v[196:199], v[64:67], v[16:31]
    ds_read_b128 v[196:199], v209 offset:21504
    v_exp_f32 v86, v86
    v_exp_f32 v87, v87
    v_mfma_f32_32x32x16_bf16 v[32:47], v[200:203], v[64:67], v[32:47]
    ds_read_b128 v[200:203], v209 offset:22528
    v_add_f32 v210, v210, v84
    v_add_f32 v211, v211, v85
    v_add_f32 v210, v210, v86
    v_add_f32 v211, v211, v87
    v_mfma_f32_32x32x16_bf16 v[48:63], v[204:207], v[64:67], v[48:63]
    ds_read_b128 v[204:207], v209 offset:23552
    v_cvt_pk_bf16_f32 v82, v84, v85
    v_cvt_pk_bf16_f32 v83, v86, v87
    s_waitcnt lgkmcnt(4)
    v_mfma_f32_32x32x16_bf16 v[96:111], v[176:179], v[144:147], v[96:111]
    ds_read_b128 v[176:179], v208 offset:8192
    v_exp_f32 v88, v88
    v_exp_f32 v89, v89
    v_mfma_f32_32x32x16_bf16 v[96:111], v[180:183], v[148:151], v[96:111]
    ds_read_b128 v[180:183], v208 offset:9216
    v_exp_f32 v90, v90
    v_exp_f32 v91, v91
    v_mfma_f32_32x32x16_bf16 v[96:111], v[184:187], v[152:155], v[96:111]
    ds_read_b128 v[184:187], v208 offset:10240
    v_add_f32 v210, v210, v88
    v_add_f32 v211, v211, v89
    v_add_f32 v210, v210, v90
    v_add_f32 v211, v211, v91
    v_mfma_f32_32x32x16_bf16 v[96:111], v[188:191], v[156:159], v[96:111]
    ds_read_b128 v[188:191], v208 offset:11264
    v_cvt_pk_bf16_f32 v88, v88, v89
    v_cvt_pk_bf16_f32 v89, v90, v91
    s_waitcnt lgkmcnt(4)
    v_mfma_f32_32x32x16_bf16 v[0:15], v[192:195], v[72:75], v[0:15]
    ds_read_b128 v[192:195], v209 offset:24576
    v_exp_f32 v92, v92
    v_exp_f32 v93, v93
    v_mfma_f32_32x32x16_bf16 v[16:31], v[196:199], v[72:75], v[16:31]
    ds_read_b128 v[196:199], v209 offset:25600
    v_exp_f32 v94, v94
    v_exp_f32 v95, v95
    v_mfma_f32_32x32x16_bf16 v[32:47], v[200:203], v[72:75], v[32:47]
    ds_read_b128 v[200:203], v209 offset:26624
    v_add_f32 v210, v210, v92
    v_add_f32 v211, v211, v93
    v_add_f32 v210, v210, v94
    v_add_f32 v211, v211, v95
    v_mfma_f32_32x32x16_bf16 v[48:63], v[204:207], v[72:75], v[48:63]
    ds_read_b128 v[204:207], v209 offset:27648
    v_cvt_pk_bf16_f32 v90, v92, v93
    v_cvt_pk_bf16_f32 v91, v94, v95
    s_waitcnt lgkmcnt(4)
    v_mfma_f32_32x32x16_bf16 v[112:127], v[176:179], v[128:131], v[160:175]
    ds_read_b128 v[176:179], v208 offset:12288
    v_exp_f32 v96, v96
    v_exp_f32 v97, v97
    v_mfma_f32_32x32x16_bf16 v[112:127], v[180:183], v[132:135], v[112:127]
    ds_read_b128 v[180:183], v208 offset:13312
    v_exp_f32 v98, v98
    v_exp_f32 v99, v99
    v_mfma_f32_32x32x16_bf16 v[112:127], v[184:187], v[136:139], v[112:127]
    ds_read_b128 v[184:187], v208 offset:14336
    v_add_f32 v210, v210, v96
    v_add_f32 v211, v211, v97
    v_add_f32 v210, v210, v98
    v_add_f32 v211, v211, v99
    v_mfma_f32_32x32x16_bf16 v[112:127], v[188:191], v[140:143], v[112:127]
    ds_read_b128 v[188:191], v208 offset:15360
    v_cvt_pk_bf16_f32 v96, v96, v97
    v_cvt_pk_bf16_f32 v97, v98, v99
    s_waitcnt lgkmcnt(4)
    v_mfma_f32_32x32x16_bf16 v[0:15], v[192:195], v[80:83], v[0:15]
    ds_read_b128 v[192:195], v209 offset:28672
    v_exp_f32 v100, v100
    v_exp_f32 v101, v101
    v_mfma_f32_32x32x16_bf16 v[16:31], v[196:199], v[80:83], v[16:31]
    ds_read_b128 v[196:199], v209 offset:29696
    v_exp_f32 v102, v102
    v_exp_f32 v103, v103
    v_mov_b32 v219, v208
    v_mfma_f32_32x32x16_bf16 v[32:47], v[200:203], v[80:83], v[32:47]
    ds_read_b128 v[200:203], v209 offset:30720
    v_add_f32 v210, v210, v100
    v_add_f32 v211, v211, v101
    v_add_f32 v210, v210, v102
    v_add_f32 v211, v211, v103
    v_add_u32 v208, 32768, v208
    v_mfma_f32_32x32x16_bf16 v[48:63], v[204:207], v[80:83], v[48:63]
    ds_read_b128 v[204:207], v209 offset:31744
    v_cvt_pk_bf16_f32 v98, v100, v101
    v_cvt_pk_bf16_f32 v99, v102, v103
    v_and_b32 v208, 0x1ffff, v208
    s_waitcnt lgkmcnt(4)
    v_mfma_f32_32x32x16_bf16 v[112:127], v[176:179], v[144:147], v[112:127]
    v_exp_f32 v104, v104
    v_exp_f32 v105, v105
    v_mfma_f32_32x32x16_bf16 v[112:127], v[180:183], v[148:151], v[112:127]
    v_exp_f32 v106, v106
    v_exp_f32 v107, v107
    v_mfma_f32_32x32x16_bf16 v[112:127], v[184:187], v[152:155], v[112:127]
    v_add_f32 v210, v210, v104
    v_add_f32 v211, v211, v105
    v_add_f32 v210, v210, v106
    v_add_f32 v211, v211, v107
    v_mfma_f32_32x32x16_bf16 v[112:127], v[188:191], v[156:159], v[112:127]
    v_cvt_pk_bf16_f32 v104, v104, v105
    v_cvt_pk_bf16_f32 v105, v106, v107
    s_cmp_eq_u32 s10, 0
    s_cbranch_scc0 fa_bp_e
fa_bpr_e:
    s_waitcnt lgkmcnt(0)
    s_barrier
    s_cbranch_scc0 fa_bd_e
fa_bdr_e:
    ds_read_b128 v[176:179], v208 offset:0
    ds_read_b128 v[180:183], v208 offset:1024
    ds_read_b128 v[184:187], v208 offset:2048
    ds_read_b128 v[188:191], v208 offset:3072
    v_mov_b32 v209, v219
    v_mfma_f32_32x32x16_bf16 v[0:15], v[192:195], v[88:91], v[0:15]
    ds_read_b128 v[192:195], v209 offset:16384
    v_exp_f32 v108, v108
    v_exp_f32 v109, v109
    v_mfma_f32_32x32x16_bf16 v[16:31], v[196:199], v[88:91], v[16:31]
    ds_read_b128 v[196:199], v209 offset:17408
    v_exp_f32 v110, v110
    v_exp_f32 v111, v111
    v_mfma_f32_32x32x16_bf16 v[32:47], v[200:203], v[88:91], v[32:47]
    ds_read_b128 v[200:203], v209 offset:18432
    v_add_f32 v210, v210, v108
    v_add_f32 v211, v211, v109
    v_add_f32 v210, v210, v110
    v_add_f32 v211, v211, v111
    v_mfma_f32_32x32x16_bf16 v[48:63], v[204:207], v[88:91], v[48:63]
    ds_read_b128 v[204:207], v209 offset:19456
    v_cvt_pk_bf16_f32 v106, v108, v109
    v_cvt_pk_bf16_f32 v107, v110, v111
    s_cmp_eq_u32 s14, 0
    s_cbranch_scc1 fa_V1
    s_waitcnt lgkmcnt(4)
    v_mfma_f32_32x32x16_bf16 v[64:79], v[176:179], v[128:131], v[160:175]
    ds_read_b128 v[176:179], v208 offset:4096
    v_exp_f32 v112, v112
    v_exp_f32 v113, v113
    v_mfma_f32_32x32x16_bf16 v[64:79], v[180:183], v[132:135], v[64:79]
    ds_read_b128 v[180:183], v208 offset:5120
    v_exp_f32 v114, v114
    v_exp_f32 v115, v115
    v_mfma_f32_32x32x16_bf16 v[64:79], v[184:187], v[136:139], v[64:79]
    ds_read_b128 v[184:187], v208 offset:6144
    v_add_f32 v210, v210, v112
    v_add_f32 v211, v211, v113
    v_add_f32 v210, v210, v114
    v_add_f32 v211, v211, v115
    v_mfma_f32_32x32x16_bf16 v[64:79], v[188:191], v[140:143], v[64:79]
    ds_read_b128 v[188:191], v208 offset:7168
    v_cvt_pk_bf16_f32 v112, v112, v113
    v_cvt_pk_bf16_f32 v113, v114, v115
    s_waitcnt lgkmcnt(4)
    v_mfma_f32_32x32x16_bf16 v[0:15], v[192:195], v[96:99], v[0:15]
    ds_read_b128 v[192:195], v209 offset:20480
    v_exp_f32 v116, v116
    v_exp_f32 v117, v117
    v_mfma_f32_32x32x16_bf16 v[16:31], v[196:199], v[96:99], v[16:31]
    ds_read_b128 v[196:199], v209 offset:21504
    v_exp_f32 v118, v118
    v_exp_f32 v119, v119
    v_mfma_f32_32x32x16_bf16 v[32:47], v[200:203], v[96:99], v[32:47]
    ds_read_b128 v[200:203], v209 offset:22528
    v_add_f32 v210, v210, v116
    v_add_f32 v211, v211, v117
    v_add_f32 v210, v210, v118
    v_add_f32 v211, v211, v119
    v_mfma_f32_32x32x16_bf16 v[48:63], v[204:207], v[96:99], v[48:63]
    ds_read_b128 v[204:207], v209 offset:23552
    v_cvt_pk_bf16_f32 v114, v116, v117
    v_cvt_pk_bf16_f32 v115, v118, v119
    s_waitcnt lgkmcnt(4)
    v_mfma_f32_32x32x16_bf16 v[64:79], v[176:179], v[144:147], v[64:79]
    ds_read_b128 v[176:179], v208 offset:8192
    v_exp_f32 v120, v120
    v_exp_f32 v121, v121
    v_mfma_f32_32x32x16_bf16 v[64:79], v[180:183], v[148:151], v[64:79]
    ds_read_b128 v[180:183], v208 offset:9216
    v_exp_f32 v122, v122
    v_exp_f32 v123, v123
    v_mfma_f32_32x32x16_bf16 v[64:79], v[184:187], v[152:155], v[64:79]
    ds_read_b128 v[184:187], v208 offset:10240
    v_add_f32 v210, v210, v120
    v_add_f32 v211, v211, v121
    v_add_f32 v210, v210, v122
    v_add_f32 v211, v211, v123
    v_mfma_f32_32x32x16_bf16 v[64:79], v[188:191], v[156:159], v[64:79]
    ds_read_b128 v[188:191], v208 offset:11264
    v_cvt_pk_bf16_f32 v120, v120, v121
    v_cvt_pk_bf16_f32 v121, v122, v123
    s_waitcnt lgkmcnt(4)
    v_mfma_f32_32x32x16_bf16 v[0:15], v[192:195], v[104:107], v[0:15]
    ds_read_b128 v[192:195], v209 offset:24576
    v_exp_f32 v124, v124
    v_exp_f32 v125, v125
    v_mfma_f32_32x32x16_bf16 v[16:31], v[196:199], v[104:107], v[16:31]
    ds_read_b128 v[196:199], v209 offset:25600
    v_exp_f32 v126, v126
    v_exp_f32 v127, v127
    v_mfma_f32_32x32x16_bf16 v[32:47], v[200:203], v[104:107], v[32:47]
    ds_read_b128 v[200:203], v209 offset:26624
    v_add_f32 v210, v210, v124
    v_add_f32 v211, v211, v125
    v_add_f32 v210, v210, v126
    v_add_f32 v211, v211, v127
    v_mfma_f32_32x32x16_bf16 v[48:63], v[204:207], v[104:107], v[48:63]
    ds_read_b128 v[204:207], v209 offset:27648
    v_cvt_pk_bf16_f32 v122, v124, v125
    v_cvt_pk_bf16_f32 v123, v126, v127
    s_waitcnt lgkmcnt(4)
    v_mfma_f32_32x32x16_bf16 v[80:95], v[176:179], v[128:131], v[160:175]
    ds_read_b128 v[176:179], v208 offset:12288
    v_exp_f32 v64, v64
    v_exp_f32 v65, v65
    v_mfma_f32_32x32x16_bf16 v[80:95], v[180:183], v[132:135], v[80:95]
    ds_read_b128 v[180:183], v208 offset:13312
    v_exp_f32 v66, v66
    v_exp_f32 v67, v67
    v_mfma_f32_32x32x16_bf16 v[80:95], v[184:187], v[136:139], v[80:95]
    ds_read_b128 v[184:187], v208 offset:14336
    v_add_f32 v210, v210, v64
    v_add_f32 v211, v211, v65
    v_add_f32 v210, v210, v66
    v_add_f32 v211, v211, v67
    v_mfma_f32_32x32x16_bf16 v[80:95], v[188:191], v[140:143], v[80:95]
    ds_read_b128 v[188:191], v208 offset:15360
    v_cvt_pk_bf16_f32 v64, v64, v65
    v_cvt_pk_bf16_f32 v65, v66, v67
    s_waitcnt lgkmcnt(4)
    v_mfma_f32_32x32x16_bf16 v[0:15], v[192:195], v[112:115], v[0:15]
    ds_read_b128 v[192:195], v209 offset:28672
    v_exp_f32 v68, v68
    v_exp_f32 v69, v69
    v_mfma_f32_32x32x16_bf16 v[16:31], v[196:199], v[112:115], v[16:31]
    ds_read_b128 v[196:199], v209 offset:29696
    v_exp_f32 v70, v70
    v_exp_f32 v71, v71
    v_mov_b32 v219, v208
    v_mfma_f32_32x32x16_bf16 v[32:47], v[200:203], v[112:115], v[32:47]
    ds_read_b128 v[200:203], v209 offset:30720
    v_add_f32 v210, v210, v68
    v_add_f32 v211, v211, v69
    v_add_f32 v210, v210, v70
    v_add_f32 v211, v211, v71
    v_add_u32 v208, 32768, v208
    v_mfma_f32_32x32x16_bf16 v[48:63], v[204:207], v[112:115], v[48:63]
    ds_read_b128 v[204:207], v209 offset:31744
    v_cvt_pk_bf16_f32 v66, v68, v69
    v_cvt_pk_bf16_f32 v67, v70, v71
    v_and_b32 v208, 0x1ffff, v208
    s_waitcnt lgkmcnt(4)
    v_mfma_f32_32x32x16_bf16 v[80:95], v[176:179], v[144:147], v[80:95]
    ds_read_b128 v[176:179], v208 offset:0
    v_exp_f32 v72, v72
    v_exp_f32 v73, v73
    v_mfma_f32_32x32x16_bf16 v[80:95], v[180:183], v[148:151], v[80:95]
    ds_read_b128 v[180:183], v208 offset:1024
    v_exp_f32 v74, v74
    v_exp_f32 v75, v75
    v_mfma_f32_32x32x16_bf16 v[80:95], v[184:187], v[152:155], v[80:95]
    ds_read_b128 v[184:187], v208 offset:2048
    v_add_f32 v210, v210, v72
    v_add_f32 v211, v211, v73
    v_add_f32 v210, v210, v74
    v_add_f32 v211, v211, v75
    v_mfma_f32_32x32x16_bf16 v[80:95], v[188:191], v[156:159], v[80:95]
    ds_read_b128 v[188:191], v208 offset:3072
    v_cvt_pk_bf16_f32 v72, v72, v73
    v_cvt_pk_bf16_f32 v73, v74, v75
    v_mov_b32 v209, v219
    s_waitcnt lgkmcnt(4)
    v_mfma_f32_32x32x16_bf16 v[0:15], v[192:195], v[120:123], v[0:15]
    ds_read_b128 v[192:195], v209 offset:16384
    v_exp_f32 v76, v76
    v_exp_f32 v77, v77
    v_mfma_f32_32x32x16_bf16 v[16:31], v[196:199], v[120:123], v[16:31]
    ds_read_b128 v[196:199], v209 offset:17408
    v_exp_f32 v78, v78
    v_exp_f32 v79, v79
    v_mfma_f32_32x32x16_bf16 v[32:47], v[200:203], v[120:123], v[32:47]
    ds_read_b128 v[200:203], v209 offset:18432
    v_add_f32 v210, v210, v76
    v_add_f32 v211, v211, v77
    v_add_f32 v210, v210, v78
    v_add_f32 v211, v211, v79
    v_mfma_f32_32x32x16_bf16 v[48:63], v[204:207], v[120:123], v[48:63]
    ds_read_b128 v[204:207], v209 offset:19456
    v_cvt_pk_bf16_f32 v74, v76, v77
    v_cvt_pk_bf16_f32 v75, v78, v79
    s_sub_u32 s14, s14, 1
    s_branch fa_loop
fa_V1:
    s_waitcnt lgkmcnt(4)
    v_mfma_f32_32x32x16_bf16 v[64:79], v[176:179], v[128:131], v[160:175]
    ds_read_b128 v[176:179], v208 offset:4096
    v_exp_f32 v112, v112
    v_exp_f32 v113, v113
    v_mfma_f32_32x32x16_bf16 v[64:79], v[180:183], v[132:135], v[64:79]
    ds_read_b128 v[180:183], v208 offset:5120
    v_exp_f32 v114, v114
    v_exp_f32 v115, v115
    v_mfma_f32_32x32x16_bf16 v[64:79], v[184:187], v[136:139], v[64:79]
    ds_read_b128 v[184:187], v208 offset:6144
    v_add_f32 v210, v210, v112
    v_add_f32 v211, v211, v113
    v_add_f32 v210, v210, v114
    v_add_f32 v211, v211, v115
    v_mfma_f32_32x32x16_bf16 v[64:79], v[188:191], v[140:143], v[64:79]
    ds_read_b128 v[188:191], v208 offset:7168
    v_cvt_pk_bf16_f32 v112, v112, v113
    v_cvt_pk_bf16_f32 v113, v114, v115
    s_waitcnt lgkmcnt(4)
    v_mfma_f32_32x32x16_bf16 v[0:15], v[192:195], v[96:99], v[0:15]
    ds_read_b128 v[192:195], v209 offset:20480
    v_exp_f32 v116, v116
    v_exp_f32 v117, v117
    v_mfma_f32_32x32x16_bf16 v[16:31], v[196:199], v[96:99], v[16:31]
    ds_read_b128 v[196:199], v209 offset:21504
    v_exp_f32 v118, v118
    v_exp_f32 v119, v119
    v_mfma_f32_32x32x16_bf16 v[32:47], v[200:203], v[96:99], v[32:47]
    ds_read_b128 v[200:203], v209 offset:22528
    v_add_f32 v210, v210, v116
    v_add_f32 v211, v211, v117
    v_add_f32 v210, v210, v118
    v_add_f32 v211, v211, v119
    v_mfma_f32_32x32x16_bf16 v[48:63], v[204:207], v[96:99], v[48:63]
    ds_read_b128 v[204:207], v209 offset:23552
    v_cvt_pk_bf16_f32 v114, v116, v117
    v_cvt_pk_bf16_f32 v115, v118, v119
    s_waitcnt lgkmcnt(4)
    v_mfma_f32_32x32x16_bf16 v[64:79], v[176:179], v[144:147], v[64:79]
    ds_read_b128 v[176:179], v208 offset:8192
    v_exp_f32 v120, v120
    v_exp_f32 v121, v121
    v_mfma_f32_32x32x16_bf16 v[64:79], v[180:183], v[148:151], v[64:79]
    ds_read_b128 v[180:183], v208 offset:9216
    v_exp_f32 v122, v122
    v_exp_f32 v123, v123
    v_mfma_f32_32x32x16_bf16 v[64:79], v[184:187], v[152:155], v[64:79]
    ds_read_b128 v[184:187], v208 offset:10240
    v_add_f32 v210, v210, v120
    v_add_f32 v211, v211, v121
    v_add_f32 v210, v210, v122
    v_add_f32 v211, v211, v123
    v_mfma_f32_32x32x16_bf16 v[64:79], v[188:191], v[156:159], v[64:79]
    ds_read_b128 v[188:191], v208 offset:11264
    v_cvt_pk_bf16_f32 v120, v120, v121
    v_cvt_pk_bf16_f32 v121, v122, v123
    s_waitcnt lgkmcnt(4)
    v_mfma_f32_32x32x16_bf16 v[0:15], v[192:195], v[104:107], v[0:15]
    ds_read_b128 v[192:195], v209 offset:24576
    v_exp_f32 v124, v124
    v_exp_f32 v125, v125
    v_mfma_f32_32x32x16_bf16 v[16:31], v[196:199], v[104:107], v[16:31]
    ds_read_b128 v[196:199], v209 offset:25600
    v_exp_f32 v126, v126
    v_exp_f32 v127, v127
    v_mfma_f32_32x32x16_bf16 v[32:47], v[200:203], v[104:107], v[32:47]
    ds_read_b128 v[200:203], v209 offset:26624
    v_add_f32 v210, v210, v124
    v_add_f32 v211, v211, v125
    v_add_f32 v210, v210, v126
    v_add_f32 v211, v211, v127
    v_mfma_f32_32x32x16_bf16 v[48:63], v[204:207], v[104:107], v[48:63]
    ds_read_b128 v[204:207], v209 offset:27648
    v_cvt_pk_bf16_f32 v122, v124, v125
    v_cvt_pk_bf16_f32 v123, v126, v127
    s_waitcnt lgkmcnt(4)
    v_mfma_f32_32x32x16_bf16 v[80:95], v[176:179], v[128:131], v[160:175]
    ds_read_b128 v[176:179], v208 offset:12288
    v_exp_f32 v64, v64
    v_exp_f32 v65, v65
    v_cmp_le_i32 s[20:21], 0, v212
    v_cmp_le_i32 s[22:23], 1, v212
    v_mfma_f32_32x32x16_bf16 v[80:95], v[180:183], v[132:135], v[80:95]
    ds_read_b128 v[180:183], v208 offset:13312
    v_exp_f32 v66, v66
    v_exp_f32 v67, v67
    v_cmp_le_i32 s[24:25], 2, v212
    v_cmp_le_i32 s[26:27], 3, v212
    v_mfma_f32_32x32x16_bf16 v[80:95], v[184:187], v[136:139], v[80:95]
    ds_read_b128 v[184:187], v208 offset:14336
    v_cndmask_b32 v64, 0, v64, s[20:21]
    v_cndmask_b32 v65, 0, v65, s[22:23]
    v_cndmask_b32 v66, 0, v66, s[24:25]
    v_cndmask_b32 v67, 0, v67, s[26:27]
    v_add_f32 v210, v210, v64
    v_add_f32 v211, v211, v65
    v_add_f32 v210, v210, v66
    v_add_f32 v211, v211, v67
    v_mfma_f32_32x32x16_bf16 v[80:95], v[188:191], v[140:143], v[80:95]
    ds_read_b128 v[188:191], v208 offset:15360
    v_cvt_pk_bf16_f32 v64, v64, v65
    v_cvt_pk_bf16_f32 v65, v66, v67
    s_waitcnt lgkmcnt(4)
    v_mfma_f32_32x32x16_bf16 v[0:15], v[192:195], v[112:115], v[0:15]
    ds_read_b128 v[192:195], v209 offset:28672
    v_exp_f32 v68, v68
    v_exp_f32 v69, v69
    v_cmp_le_i32 s[20:21], 8, v212
    v_cmp_le_i32 s[22:23], 9, v212
    v_mfma_f32_32x32x16_bf16 v[16:31], v[196:199], v[112:115], v[16:31]
    ds_read_b128 v[196:199], v209 offset:29696
    v_exp_f32 v70, v70
    v_exp_f32 v71, v71
    v_cmp_le_i32 s[24:25], 10, v212
    v_cmp_le_i32 s[26:27], 11, v212
    v_mov_b32 v219, v208
    v_mfma_f32_32x32x16_bf16 v[32:47], v[200:203], v[112:115], v[32:47]
    ds_read_b128 v[200:203], v209 offset:30720
    v_cndmask_b32 v68, 0, v68, s[20:21]
    v_cndmask_b32 v69, 0, v69, s[22:23]
    v_cndmask_b32 v70, 0, v70, s[24:25]
    v_cndmask_b32 v71, 0, v71, s[26:27]
    v_add_f32 v210, v210, v68
    v_add_f32 v211, v211, v69
    v_add_f32 v210, v210, v70
    v_add_f32 v211, v211, v71
    v_add_u32 v208, 32768, v208
    v_mfma_f32_32x32x16_bf16 v[48:63], v[204:207], v[112:115], v[48:63]
    ds_read_b128 v[204:207], v209 offset:31744
    v_cvt_pk_bf16_f32 v66, v68, v69
    v_cvt_pk_bf16_f32 v67, v70, v71
    v_and_b32 v208, 0x1ffff, v208
    s_waitcnt lgkmcnt(4)
    v_mfma_f32_32x32x16_bf16 v[80:95], v[176:179], v[144:147], v[80:95]
    ds_read_b128 v[176:179], v208 offset:0
    v_exp_f32 v72, v72
    v_exp_f32 v73, v73
    v_cmp_le_i32 s[20:21], 16, v212
    v_cmp_le_i32 s[22:23], 17, v212
    v_mfma_f32_32x32x16_bf16 v[80:95], v[180:183], v[148:151], v[80:95]
    ds_read_b128 v[180:183], v208 offset:1024
    v_exp_f32 v74, v74
    v_exp_f32 v75, v75
    v_cmp_le_i32 s[24:25], 18, v212
    v_cmp_le_i32 s[26:27], 19, v212
    v_mfma_f32_32x32x16_bf16 v[80:95], v[184:187], v[152:155], v[80:95]
    ds_read_b128 v[184:187], v208 offset:2048
    v_cndmask_b32 v72, 0, v72, s[20:21]
    v_cndmask_b32 v73, 0, v73, s[22:23]
    v_cndmask_b32 v74, 0, v74, s[24:25]
    v_cndmask_b32 v75, 0, v75, s[26:27]
    v_add_f32 v210, v210, v72
    v_add_f32 v211, v211, v73
    v_add_f32 v210, v210, v74
    v_add_f32 v211, v211, v75
    v_mfma_f32_32x32x16_bf16 v[80:95], v[188:191], v[156:159], v[80:95]
    ds_read_b128 v[188:191], v208 offset:3072
    v_cvt_pk_bf16_f32 v72, v72, v73
    v_cvt_pk_bf16_f32 v73, v74, v75
    v_mov_b32 v209, v219
    s_waitcnt lgkmcnt(4)
    v_mfma_f32_32x32x16_bf16 v[0:15], v[192:195], v[120:123], v[0:15]
    ds_read_b128 v[192:195], v209 offset:16384
    v_exp_f32 v76, v76
    v_exp_f32 v77, v77
    v_cmp_le_i32 s[20:21], 24, v212
    v_cmp_le_i32 s[22:23], 25, v212
    v_mfma_f32_32x32x16_bf16 v[16:31], v[196:199], v[120:123], v[16:31]
    ds_read_b128 v[196:199], v209 offset:17408
    v_exp_f32 v78, v78
    v_exp_f32 v79, v79
    v_cmp_le_i32 s[24:25], 26, v212
    v_cmp_le_i32 s[26:27], 27, v212
    v_mfma_f32_32x32x16_bf16 v[32:47], v[200:203], v[120:123], v[32:47]
    ds_read_b128 v[200:203], v209 offset:18432
    v_cndmask_b32 v76, 0, v76, s[20:21]
    v_cndmask_b32 v77, 0, v77, s[22:23]
    v_cndmask_b32 v78, 0, v78, s[24:25]
    v_cndmask_b32 v79, 0, v79, s[26:27]
    v_add_f32 v210, v210, v76
    v_add_f32 v211, v211, v77
    v_add_f32 v210, v210, v78
    v_add_f32 v211, v211, v79
    v_mfma_f32_32x32x16_bf16 v[48:63], v[204:207], v[120:123], v[48:63]
    ds_read_b128 v[204:207], v209 offset:19456
    v_cvt_pk_bf16_f32 v74, v76, v77
    v_cvt_pk_bf16_f32 v75, v78, v79
fa_V2:
    s_waitcnt lgkmcnt(4)
    v_mfma_f32_32x32x16_bf16 v[96:111], v[176:179], v[128:131], v[160:175]
    ds_read_b128 v[176:179], v208 offset:4096
    v_exp_f32 v80, v80
    v_exp_f32 v81, v81
    v_cmp_le_i32 s[20:21], 32, v212
    v_cmp_le_i32 s[22:23], 33, v212
    v_mfma_f32_32x32x16_bf16 v[96:111], v[180:183], v[132:135], v[96:111]
    ds_read_b128 v[180:183], v208 offset:5120
    v_exp_f32 v82, v82
    v_exp_f32 v83, v83
    v_cmp_le_i32 s[24:25], 34, v212
    v_cmp_le_i32 s[26:27], 35, v212
    v_mfma_f32_32x32x16_bf16 v[96:111], v[184:187], v[136:139], v[96:111]
    ds_read_b128 v[184:187], v208 offset:6144
    v_cndmask_b32 v80, 0, v80, s[20:21]
    v_cndmask_b32 v81, 0, v81, s[22:23]
    v_cndmask_b32 v82, 0, v82, s[24:25]
    v_cndmask_b32 v83, 0, v83, s[26:27]
    v_add_f32 v210, v210, v80
    v_add_f32 v211, v211, v81
    v_add_f32 v210, v210, v82
    v_add_f32 v211, v211, v83
    v_mfma_f32_32x32x16_bf16 v[96:111], v[188:191], v[140:143], v[96:111]
    ds_read_b128 v[188:191], v208 offset:7168
    v_cvt_pk_bf16_f32 v80, v80, v81
    v_cvt_pk_bf16_f32 v81, v82, v83
    s_waitcnt lgkmcnt(4)
    v_mfma_f32_32x32x16_bf16 v[0:15], v[192:195], v[64:67], v[0:15]
    ds_read_b128 v[192:195], v209 offset:20480
    v_exp_f32 v84, v84
    v_exp_f32 v85, v85
    v_cmp_le_i32 s[20:21], 40, v212
    v_cmp_le_i32 s[22:23], 41, v212
    v_mfma_f32_32x32x16_bf16 v[16:31], v[196:199], v[64:67], v[16:31]
    ds_read_b128 v[196:199], v209 offset:21504
    v_exp_f32 v86, v86
    v_exp_f32 v87, v87
    v_cmp_le_i32 s[24:25], 42, v212
    v_cmp_le_i32 s[26:27], 43, v212
    v_mfma_f32_32x32x16_bf16 v[32:47], v[200:203], v[64:67], v[32:47]
    ds_read_b128 v[200:203], v209 offset:22528
    v_cndmask_b32 v84, 0, v84, s[20:21]
    v_cndmask_b32 v85, 0, v85, s[22:23]
    v_cndmask_b32 v86, 0, v86, s[24:25]
    v_cndmask_b32 v87, 0, v87, s[26:27]
    v_add_f32 v210, v210, v84
    v_add_f32 v211, v211, v85
    v_add_f32 v210, v210, v86
    v_add_f32 v211, v211, v87
    v_mfma_f32_32x32x16_bf16 v[48:63], v[204:207], v[64:67], v[48:63]
    ds_read_b128 v[204:207], v209 offset:23552
    v_cvt_pk_bf16_f32 v82, v84, v85
    v_cvt_pk_bf16_f32 v83, v86, v87
    s_waitcnt lgkmcnt(4)
    v_mfma_f32_32x32x16_bf16 v[96:111], v[176:179], v[144:147], v[96:111]
    ds_read_b128 v[176:179], v208 offset:8192
    v_exp_f32 v88, v88
    v_exp_f32 v89, v89
    v_cmp_le_i32 s[20:21], 48, v212
    v_cmp_le_i32 s[22:23], 49, v212
    v_mfma_f32_32x32x16_bf16 v[96:111], v[180:183], v[148:151], v[96:111]
    ds_read_b128 v[180:183], v208 offset:9216
    v_exp_f32 v90, v90
    v_exp_f32 v91, v91
    v_cmp_le_i32 s[24:25], 50, v212
    v_cmp_le_i32 s[26:27], 51, v212
    v_mfma_f32_32x32x16_bf16 v[96:111], v[184:187], v[152:155], v[96:111]
    ds_read_b128 v[184:187], v208 offset:10240
    v_cndmask_b32 v88, 0, v88, s[20:21]
    v_cndmask_b32 v89, 0, v89, s[22:23]
    v_cndmask_b32 v90, 0, v90, s[24:25]
    v_cndmask_b32 v91, 0, v91, s[26:27]
    v_add_f32 v210, v210, v88
    v_add_f32 v211, v211, v89
    v_add_f32 v210, v210, v90
    v_add_f32 v211, v211, v91
    v_mfma_f32_32x32x16_bf16 v[96:111], v[188:191], v[156:159], v[96:111]
    ds_read_b128 v[188:191], v208 offset:11264
    v_cvt_pk_bf16_f32 v88, v88, v89
    v_cvt_pk_bf16_f32 v89, v90, v91
    s_waitcnt lgkmcnt(4)
    v_mfma_f32_32x32x16_bf16 v[0:15], v[192:195], v[72:75], v[0:15]
    ds_read_b128 v[192:195], v209 offset:24576
    v_exp_f32 v92, v92
    v_exp_f32 v93, v93
    v_cmp_le_i32 s[20:21], 56, v212
    v_cmp_le_i32 s[22:23], 57, v212
    v_mfma_f32_32x32x16_bf16 v[16:31], v[196:199], v[72:75], v[16:31]
    ds_read_b128 v[196:199], v209 offset:25600
    v_exp_f32 v94, v94
    v_exp_f32 v95, v95
    v_cmp_le_i32 s[24:25], 58, v212
    v_cmp_le_i32 s[26:27], 59, v212
    v_mfma_f32_32x32x16_bf16 v[32:47], v[200:203], v[72:75], v[32:47]
    ds_read_b128 v[200:203], v209 offset:26624
    v_cndmask_b32 v92, 0, v92, s[20:21]
    v_cndmask_b32 v93, 0, v93, s[22:23]
    v_cndmask_b32 v94, 0, v94, s[24:25]
    v_cndmask_b32 v95, 0, v95, s[26:27]
    v_add_f32 v210, v210, v92
    v_add_f32 v211, v211, v93
    v_add_f32 v210, v210, v94
    v_add_f32 v211, v211, v95
    v_mfma_f32_32x32x16_bf16 v[48:63], v[204:207], v[72:75], v[48:63]
    ds_read_b128 v[204:207], v209 offset:27648
    v_cvt_pk_bf16_f32 v90, v92, v93
    v_cvt_pk_bf16_f32 v91, v94, v95
    s_waitcnt lgkmcnt(4)
    v_mfma_f32_32x32x16_bf16 v[112:127], v[176:179], v[128:131], v[160:175]
    ds_read_b128 v[176:179], v208 offset:12288
    v_exp_f32 v96, v96
    v_exp_f32 v97, v97
    v_cmp_le_i32 s[20:21], 0, v213
    v_cmp_le_i32 s[22:23], 1, v213
    v_mfma_f32_32x32x16_bf16 v[112:127], v[180:183], v[132:135], v[112:127]
    ds_read_b128 v[180:183], v208 offset:13312
    v_exp_f32 v98, v98
    v_exp_f32 v99, v99
    v_cmp_le_i32 s[24:25], 2, v213
    v_cmp_le_i32 s[26:27], 3, v213
    v_mfma_f32_32x32x16_bf16 v[112:127], v[184:187], v[136:139], v[112:127]
    ds_read_b128 v[184:187], v208 offset:14336
    v_cndmask_b32 v96, 0, v96, s[20:21]
    v_cndmask_b32 v97, 0, v97, s[22:23]
    v_cndmask_b32 v98, 0, v98, s[24:25]
    v_cndmask_b32 v99, 0, v99, s[26:27]
    v_add_f32 v210, v210, v96
    v_add_f32 v211, v211, v97
    v_add_f32 v210, v210, v98
    v_add_f32 v211, v211, v99
    v_mfma_f32_32x32x16_bf16 v[112:127], v[188:191], v[140:143], v[112:127]
    ds_read_b128 v[188:191], v208 offset:15360
    v_cvt_pk_bf16_f32 v96, v96, v97
    v_cvt_pk_bf16_f32 v97, v98, v99
    s_waitcnt lgkmcnt(4)
    v_mfma_f32_32x32x16_bf16 v[0:15], v[192:195], v[80:83], v[0:15]
    ds_read_b128 v[192:195], v209 offset:28672
    v_exp_f32 v100, v100
    v_exp_f32 v101, v101
    v_cmp_le_i32 s[20:21], 8, v213
    v_cmp_le_i32 s[22:23], 9, v213
    v_mfma_f32_32x32x16_bf16 v[16:31], v[196:199], v[80:83], v[16:31]
    ds_read_b128 v[196:199], v209 offset:29696
    v_exp_f32 v102, v102
    v_exp_f32 v103, v103
    v_cmp_le_i32 s[24:25], 10, v213
    v_cmp_le_i32 s[26:27], 11, v213
    v_mov_b32 v219, v208
    v_mfma_f32_32x32x16_bf16 v[32:47], v[200:203], v[80:83], v[32:47]
    ds_read_b128 v[200:203], v209 offset:30720
    v_cndmask_b32 v100, 0, v100, s[20:21]
    v_cndmask_b32 v101, 0, v101, s[22:23]
    v_cndmask_b32 v102, 0, v102, s[24:25]
    v_cndmask_b32 v103, 0, v103, s[26:27]
    v_add_f32 v210, v210, v100
    v_add_f32 v211, v211, v101
    v_add_f32 v210, v210, v102
    v_add_f32 v211, v211, v103
    v_add_u32 v208, 32768, v208
    v_mfma_f32_32x32x16_bf16 v[48:63], v[204:207], v[80:83], v[48:63]
    ds_read_b128 v[204:207], v209 offset:31744
    v_cvt_pk_bf16_f32 v98, v100, v101
    v_cvt_pk_bf16_f32 v99, v102, v103
    v_and_b32 v208, 0x1ffff, v208
    s_waitcnt lgkmcnt(4)
    v_mfma_f32_32x32x16_bf16 v[112:127], v[176:179], v[144:147], v[112:127]
    v_exp_f32 v104, v104
    v_exp_f32 v105, v105
    v_cmp_le_i32 s[20:21], 16, v213
    v_cmp_le_i32 s[22:23], 17, v213
    v_mfma_f32_32x32x16_bf16 v[112:127], v[180:183], v[148:151], v[112:127]
    v_exp_f32 v106, v106
    v_exp_f32 v107, v107
    v_cmp_le_i32 s[24:25], 18, v213
    v_cmp_le_i32 s[26:27], 19, v213
    v_mfma_f32_32x32x16_bf16 v[112:127], v[184:187], v[152:155], v[112:127]
    v_cndmask_b32 v104, 0, v104, s[20:21]
    v_cndmask_b32 v105, 0, v105, s[22:23]
    v_cndmask_b32 v106, 0, v106, s[24:25]
    v_cndmask_b32 v107, 0, v107, s[26:27]
    v_add_f32 v210, v210, v104
    v_add_f32 v211, v211, v105
    v_add_f32 v210, v210, v106
    v_add_f32 v211, v211, v107
    v_mfma_f32_32x32x16_bf16 v[112:127], v[188:191], v[156:159], v[112:127]
    v_cvt_pk_bf16_f32 v104, v104, v105
    v_cvt_pk_bf16_f32 v105, v106, v107
    s_cmp_eq_u32 s10, 0
    s_cbranch_scc0 fa_bp_v2
fa_bpr_v2:
    s_waitcnt lgkmcnt(0)
    s_barrier
    s_cbranch_scc0 fa_bd_v2
fa_bdr_v2:
    v_mov_b32 v209, v219
    v_mfma_f32_32x32x16_bf16 v[0:15], v[192:195], v[88:91], v[0:15]
    ds_read_b128 v[192:195], v209 offset:16384
    v_exp_f32 v108, v108
    v_exp_f32 v109, v109
    v_cmp_le_i32 s[20:21], 24, v213
    v_cmp_le_i32 s[22:23], 25, v213
    v_mfma_f32_32x32x16_bf16 v[16:31], v[196:199], v[88:91], v[16:31]
    ds_read_b128 v[196:199], v209 offset:17408
    v_exp_f32 v110, v110
    v_exp_f32 v111, v111
    v_cmp_le_i32 s[24:25], 26, v213
    v_cmp_le_i32 s[26:27], 27, v213
    v_mfma_f32_32x32x16_bf16 v[32:47], v[200:203], v[88:91], v[32:47]
    ds_read_b128 v[200:203], v209 offset:18432
    v_cndmask_b32 v108, 0, v108, s[20:21]
    v_cndmask_b32 v109, 0, v109, s[22:23]
    v_cndmask_b32 v110, 0, v110, s[24:25]
    v_cndmask_b32 v111, 0, v111, s[26:27]
    v_add_f32 v210, v210, v108
    v_add_f32 v211, v211, v109
    v_add_f32 v210, v210, v110
    v_add_f32 v211, v211, v111
    v_mfma_f32_32x32x16_bf16 v[48:63], v[204:207], v[88:91], v[48:63]
    ds_read_b128 v[204:207], v209 offset:19456
    v_cvt_pk_bf16_f32 v106, v108, v109
    v_cvt_pk_bf16_f32 v107, v110, v111
    v_exp_f32 v112, v112
    v_exp_f32 v113, v113
    v_cmp_le_i32 s[20:21], 32, v213
    v_cmp_le_i32 s[22:23], 33, v213
    s_nop 0
    v_exp_f32 v114, v114
    v_exp_f32 v115, v115
    v_cmp_le_i32 s[24:25], 34, v213
    v_cmp_le_i32 s[26:27], 35, v213
    s_nop 0
    v_cndmask_b32 v112, 0, v112, s[20:21]
    v_cndmask_b32 v113, 0, v113, s[22:23]
    v_cndmask_b32 v114, 0, v114, s[24:25]
    v_cndmask_b32 v115, 0, v115, s[26:27]
    v_add_f32 v210, v210, v112
    v_add_f32 v211, v211, v113
    v_add_f32 v210, v210, v114
    v_add_f32 v211, v211, v115
    s_nop 0
    v_cvt_pk_bf16_f32 v112, v112, v113
    v_cvt_pk_bf16_f32 v113, v114, v115
    s_waitcnt lgkmcnt(0)
    v_mfma_f32_32x32x16_bf16 v[0:15], v[192:195], v[96:99], v[0:15]
    ds_read_b128 v[192:195], v209 offset:20480
    v_exp_f32 v116, v116
    v_exp_f32 v117, v117
    v_cmp_le_i32 s[20:21], 40, v213
    v_cmp_le_i32 s[22:23], 41, v213
    v_mfma_f32_32x32x16_bf16 v[16:31], v[196:199], v[96:99], v[16:31]
    ds_read_b128 v[196:199], v209 offset:21504
    v_exp_f32 v118, v118
    v_exp_f32 v119, v119
    v_cmp_le_i32 s[24:25], 42, v213
    v_cmp_le_i32 s[26:27], 43, v213
    v_mfma_f32_32x32x16_bf16 v[32:47], v[200:203], v[96:99], v[32:47]
    ds_read_b128 v[200:203], v209 offset:22528
    v_cndmask_b32 v116, 0, v116, s[20:21]
    v_cndmask_b32 v117, 0, v117, s[22:23]
    v_cndmask_b32 v118, 0, v118, s[24:25]
    v_cndmask_b32 v119, 0, v119, s[26:27]
    v_add_f32 v210, v210, v116
    v_add_f32 v211, v211, v117
    v_add_f32 v210, v210, v118
    v_add_f32 v211, v211, v119
    v_mfma_f32_32x32x16_bf16 v[48:63], v[204:207], v[96:99], v[48:63]
    ds_read_b128 v[204:207], v209 offset:23552
    v_cvt_pk_bf16_f32 v114, v116, v117
    v_cvt_pk_bf16_f32 v115, v118, v119
    v_exp_f32 v120, v120
    v_exp_f32 v121, v121
    v_cmp_le_i32 s[20:21], 48, v213
    v_cmp_le_i32 s[22:23], 49, v213
    s_nop 0
    v_exp_f32 v122, v122
    v_exp_f32 v123, v123
    v_cmp_le_i32 s[24:25], 50, v213
    v_cmp_le_i32 s[26:27], 51, v213
    s_nop 0
    v_cndmask_b32 v120, 0, v120, s[20:21]
    v_cndmask_b32 v121, 0, v121, s[22:23]
    v_cndmask_b32 v122, 0, v122, s[24:25]
    v_cndmask_b32 v123, 0, v123, s[26:27]
    v_add_f32 v210, v210, v120
    v_add_f32 v211, v211, v121
    v_add_f32 v210, v210, v122
    v_add_f32 v211, v211, v123
    s_nop 0
    v_cvt_pk_bf16_f32 v120, v120, v121
    v_cvt_pk_bf16_f32 v121, v122, v123
    s_waitcnt lgkmcnt(0)
    v_mfma_f32_32x32x16_bf16 v[0:15], v[192:195], v[104:107], v[0:15]
    ds_read_b128 v[192:195], v209 offset:24576
    v_exp_f32 v124, v124
    v_exp_f32 v125, v125
    v_cmp_le_i32 s[20:21], 56, v213
    v_cmp_le_i32 s[22:23], 57, v213
    v_mfma_f32_32x32x16_bf16 v[16:31], v[196:199], v[104:107], v[16:31]
    ds_read_b128 v[196:199], v209 offset:25600
    v_exp_f32 v126, v126
    v_exp_f32 v127, v127
    v_cmp_le_i32 s[24:25], 58, v213
    v_cmp_le_i32 s[26:27], 59, v213
    v_mfma_f32_32x32x16_bf16 v[32:47], v[200:203], v[104:107], v[32:47]
    ds_read_b128 v[200:203], v209 offset:26624
    v_cndmask_b32 v124, 0, v124, s[20:21]
    v_cndmask_b32 v125, 0, v125, s[22:23]
    v_cndmask_b32 v126, 0, v126, s[24:25]
    v_cndmask_b32 v127, 0, v127, s[26:27]
    v_add_f32 v210, v210, v124
    v_add_f32 v211, v211, v125
    v_add_f32 v210, v210, v126
    v_add_f32 v211, v211, v127
    v_mfma_f32_32x32x16_bf16 v[48:63], v[204:207], v[104:107], v[48:63]
    ds_read_b128 v[204:207], v209 offset:27648
    v_cvt_pk_bf16_f32 v122, v124, v125
    v_cvt_pk_bf16_f32 v123, v126, v127
    s_waitcnt lgkmcnt(0)
    v_mfma_f32_32x32x16_bf16 v[0:15], v[192:195], v[112:115], v[0:15]
    ds_read_b128 v[192:195], v209 offset:28672
    v_mfma_f32_32x32x16_bf16 v[16:31], v[196:199], v[112:115], v[16:31]
    ds_read_b128 v[196:199], v209 offset:29696
    v_mfma_f32_32x32x16_bf16 v[32:47], v[200:203], v[112:115], v[32:47]
    ds_read_b128 v[200:203], v209 offset:30720
    v_mfma_f32_32x32x16_bf16 v[48:63], v[204:207], v[112:115], v[48:63]
    ds_read_b128 v[204:207], v209 offset:31744
    s_waitcnt lgkmcnt(0)
    v_mfma_f32_32x32x16_bf16 v[0:15], v[192:195], v[120:123], v[0:15]
    v_mfma_f32_32x32x16_bf16 v[16:31], v[196:199], v[120:123], v[16:31]
    v_mfma_f32_32x32x16_bf16 v[32:47], v[200:203], v[120:123], v[32:47]
    v_mfma_f32_32x32x16_bf16 v[48:63], v[204:207], v[120:123], v[48:63]
    v_add_f32 v210, v210, v211
    v_mov_b32 v211, v210
    s_nop 1
    v_permlane32_swap_b32 v210, v211
    s_nop 1
    v_add_f32 v210, v210, v211
    s_cmp_lg_u32 s15, 0
    s_cbranch_scc1 fa_ok
    v_mov_b32 v218, 0x21800000
    v_mov_b32 v219, 0x5d800000
    v_cmp_ge_f32 s[20:21], v210, v218
    v_cmp_le_f32 s[22:23], v210, v219
    s_nop 1
    s_and_b64 s[20:21], s[20:21], s[22:23]
    s_not_b64 s[20:21], s[20:21]
    s_cmp_eq_u64 s[20:21], 0
    s_cbranch_scc1 fa_ok
    v_mov_b32 v218, 131072
    v_mov_b32 v219, 1
    ds_write_b32 v218, v219
fa_ok:
    s_cmp_eq_u32 s10, 0
    s_cbranch_scc1 fa_fin
    v_rcp_f32 v210, v210
    v_sub_f32 v218, 1.0, v215
    v_mul_f32 v210, v210, v218
    s_mul_i32 s17, s47, 294912
    s_lshl_b32 s18, s37, 13
    s_add_u32 s17, s17, s18
    s_add_u32 s17, s17, 50331648
    v_mul_f32 v0, v210, v0
    v_mul_f32 v1, v210, v1
    v_mul_f32 v2, v210, v2
    v_mul_f32 v3, v210, v3
    v_mul_f32 v4, v210, v4
    v_mul_f32 v5, v210, v5
    v_mul_f32 v6, v210, v6
    v_mul_f32 v7, v210, v7
    v_mul_f32 v8, v210, v8
    v_mul_f32 v9, v210, v9
    v_mul_f32 v10, v210, v10
    v_mul_f32 v11, v210, v11
    v_mul_f32 v12, v210, v12
    v_mul_f32 v13, v210, v13
    v_mul_f32 v14, v210, v14
    v_mul_f32 v15, v210, v15
    v_cvt_pk_bf16_f32 v0, v0, v1
    v_cvt_pk_bf16_f32 v1, v2, v3
    v_cvt_pk_bf16_f32 v2, v4, v5
    v_cvt_pk_bf16_f32 v3, v6, v7
    v_cvt_pk_bf16_f32 v8, v8, v9
    v_cvt_pk_bf16_f32 v9, v10, v11
    v_cvt_pk_bf16_f32 v10, v12, v13
    v_cvt_pk_bf16_f32 v11, v14, v15
    buffer_store_dwordx4 v[0:3], v214, s[28:31], s17 offen offset:0 sc1
    buffer_store_dwordx4 v[8:11], v214, s[28:31], s17 offen offset:1024 sc1
    v_mul_f32 v16, v210, v16
    v_mul_f32 v17, v210, v17
    v_mul_f32 v18, v210, v18
    v_mul_f32 v19, v210, v19
    v_mul_f32 v20, v210, v20
    v_mul_f32 v21, v210, v21
    v_mul_f32 v22, v210, v22
    v_mul_f32 v23, v210, v23
    v_mul_f32 v24, v210, v24
    v_mul_f32 v25, v210, v25
    v_mul_f32 v26, v210, v26
    v_mul_f32 v27, v210, v27
    v_mul_f32 v28, v210, v28
    v_mul_f32 v29, v210, v29
    v_mul_f32 v30, v210, v30
    v_mul_f32 v31, v210, v31
    v_cvt_pk_bf16_f32 v16, v16, v17
    v_cvt_pk_bf16_f32 v17, v18, v19
    v_cvt_pk_bf16_f32 v18, v20, v21
    v_cvt_pk_bf16_f32 v19, v22, v23
    v_cvt_pk_bf16_f32 v24, v24, v25
    v_cvt_pk_bf16_f32 v25, v26, v27
    v_cvt_pk_bf16_f32 v26, v28, v29
    v_cvt_pk_bf16_f32 v27, v30, v31
    buffer_store_dwordx4 v[16:19], v214, s[28:31], s17 offen offset:2048 sc1
    buffer_store_dwordx4 v[24:27], v214, s[28:31], s17 offen offset:3072 sc1
    v_mul_f32 v32, v210, v32
    v_mul_f32 v33, v210, v33
    v_mul_f32 v34, v210, v34
    v_mul_f32 v35, v210, v35
    v_mul_f32 v36, v210, v36
    v_mul_f32 v37, v210, v37
    v_mul_f32 v38, v210, v38
    v_mul_f32 v39, v210, v39
    v_mul_f32 v40, v210, v40
    v_mul_f32 v41, v210, v41
    v_mul_f32 v42, v210, v42
    v_mul_f32 v43, v210, v43
    v_mul_f32 v44, v210, v44
    v_mul_f32 v45, v210, v45
    v_mul_f32 v46, v210, v46
    v_mul_f32 v47, v210, v47
    v_cvt_pk_bf16_f32 v32, v32, v33
    v_cvt_pk_bf16_f32 v33, v34, v35
    v_cvt_pk_bf16_f32 v34, v36, v37
    v_cvt_pk_bf16_f32 v35, v38, v39
    v_cvt_pk_bf16_f32 v40, v40, v41
    v_cvt_pk_bf16_f32 v41, v42, v43
    v_cvt_pk_bf16_f32 v42, v44, v45
    v_cvt_pk_bf16_f32 v43, v46, v47
    s_add_u32 s17, s17, 4096
    buffer_store_dwordx4 v[32:35], v214, s[28:31], s17 offen offset:0 sc1
    buffer_store_dwordx4 v[40:43], v214, s[28:31], s17 offen offset:1024 sc1
    v_mul_f32 v48, v210, v48
    v_mul_f32 v49, v210, v49
    v_mul_f32 v50, v210, v50
    v_mul_f32 v51, v210, v51
    v_mul_f32 v52, v210, v52
    v_mul_f32 v53, v210, v53
    v_mul_f32 v54, v210, v54
    v_mul_f32 v55, v210, v55
    v_mul_f32 v56, v210, v56
    v_mul_f32 v57, v210, v57
    v_mul_f32 v58, v210, v58
    v_mul_f32 v59, v210, v59
    v_mul_f32 v60, v210, v60
    v_mul_f32 v61, v210, v61
    v_mul_f32 v62, v210, v62
    v_mul_f32 v63, v210, v63
    v_cvt_pk_bf16_f32 v48, v48, v49
    v_cvt_pk_bf16_f32 v49, v50, v51
    v_cvt_pk_bf16_f32 v50, v52, v53
    v_cvt_pk_bf16_f32 v51, v54, v55
    v_cvt_pk_bf16_f32 v56, v56, v57
    v_cvt_pk_bf16_f32 v57, v58, v59
    v_cvt_pk_bf16_f32 v58, v60, v61
    v_cvt_pk_bf16_f32 v59, v62, v63
    buffer_store_dwordx4 v[48:51], v214, s[28:31], s17 offen offset:2048 sc1
    buffer_store_dwordx4 v[56:59], v214, s[28:31], s17 offen offset:3072 sc1
    s_waitcnt vmcnt(8)
    s_barrier
    s_add_u32 s18, s13, 98304
    s_and_b32 s18, s18, 0x1ffff
    s_sub_u32 s17, s12, 16384
    s_min_u32 s17, s17, s42
    s_add_u32 m0, s18, 16384
    s_add_u32 s19, s17, 0
    buffer_load_dwordx4 v214, s[28:31], s19 offen offset:0 lds
    buffer_load_dwordx4 v214, s[28:31], s19 offen offset:1024 lds
    buffer_load_dwordx4 v214, s[28:31], s19 offen offset:2048 lds
    buffer_load_dwordx4 v214, s[28:31], s19 offen offset:3072 lds
    s_min_u32 s17, s12, s41
    s_add_u32 m0, s13, 0
    s_add_u32 s19, s17, 0
    buffer_load_dwordx4 v214, s[28:31], s19 offen offset:0 lds
    buffer_load_dwordx4 v214, s[28:31], s19 offen offset:1024 lds
    buffer_load_dwordx4 v214, s[28:31], s19 offen offset:2048 lds
    buffer_load_dwordx4 v214, s[28:31], s19 offen offset:3072 lds
    s_add_u32 s17, s12, 16384
    s_min_u32 s17, s17, s42
    s_add_u32 m0, s13, 16384
    s_add_u32 s19, s17, 0
    buffer_load_dwordx4 v214, s[28:31], s19 offen offset:0 lds
    buffer_load_dwordx4 v214, s[28:31], s19 offen offset:1024 lds
    buffer_load_dwordx4 v214, s[28:31], s19 offen offset:2048 lds
    buffer_load_dwordx4 v214, s[28:31], s19 offen offset:3072 lds
    s_add_u32 s17, s12, 32768
    s_min_u32 s17, s17, s41
    s_add_u32 m0, s13, 32768
    s_add_u32 s19, s17, 0
    buffer_load_dwordx4 v214, s[28:31], s19 offen offset:0 lds
    buffer_load_dwordx4 v214, s[28:31], s19 offen offset:1024 lds
    buffer_load_dwordx4 v214, s[28:31], s19 offen offset:2048 lds
    buffer_load_dwordx4 v214, s[28:31], s19 offen offset:3072 lds
    s_add_u32 s12, s12, 65536
    s_add_u32 s13, s13, 65536
    s_and_b32 s13, s13, 0x1ffff
    s_sub_u32 s14, s9, s8
    s_lshr_b32 s14, s14, 1
    s_sub_u32 s14, s14, 1
    s_cmp_eq_u32 s14, 0
    s_cbranch_scc1 fa_fin
fa_ld:
    s_waitcnt vmcnt(0)
    s_barrier
    s_add_u32 s18, s13, 98304
    s_and_b32 s18, s18, 0x1ffff
    s_sub_u32 s17, s12, 16384
    s_min_u32 s17, s17, s42
    s_add_u32 m0, s18, 16384
    s_add_u32 s19, s17, 0
    buffer_load_dwordx4 v214, s[28:31], s19 offen offset:0 lds
    buffer_load_dwordx4 v214, s[28:31], s19 offen offset:1024 lds
    buffer_load_dwordx4 v214, s[28:31], s19 offen offset:2048 lds
    buffer_load_dwordx4 v214, s[28:31], s19 offen offset:3072 lds
    s_min_u32 s17, s12, s41
    s_add_u32 m0, s13, 0
    s_add_u32 s19, s17, 0
    buffer_load_dwordx4 v214, s[28:31], s19 offen offset:0 lds
    buffer_load_dwordx4 v214, s[28:31], s19 offen offset:1024 lds
    buffer_load_dwordx4 v214, s[28:31], s19 offen offset:2048 lds
    buffer_load_dwordx4 v214, s[28:31], s19 offen offset:3072 lds
    s_add_u32 s17, s12, 16384
    s_min_u32 s17, s17, s42
    s_add_u32 m0, s13, 16384
    s_add_u32 s19, s17, 0
    buffer_load_dwordx4 v214, s[28:31], s19 offen offset:0 lds
    buffer_load_dwordx4 v214, s[28:31], s19 offen offset:1024 lds
    buffer_load_dwordx4 v214, s[28:31], s19 offen offset:2048 lds
    buffer_load_dwordx4 v214, s[28:31], s19 offen offset:3072 lds
    s_add_u32 s17, s12, 32768
    s_min_u32 s17, s17, s41
    s_add_u32 m0, s13, 32768
    s_add_u32 s19, s17, 0
    buffer_load_dwordx4 v214, s[28:31], s19 offen offset:0 lds
    buffer_load_dwordx4 v214, s[28:31], s19 offen offset:1024 lds
    buffer_load_dwordx4 v214, s[28:31], s19 offen offset:2048 lds
    buffer_load_dwordx4 v214, s[28:31], s19 offen offset:3072 lds
    s_add_u32 s12, s12, 65536
    s_add_u32 s13, s13, 65536
    s_and_b32 s13, s13, 0x1ffff
    s_sub_u32 s14, s14, 1
    s_cmp_lg_u32 s14, 0
    s_cbranch_scc1 fa_ld
fa_fin:
    s_waitcnt vmcnt(0) lgkmcnt(0)
    s_barrier
    s_cmp_lg_u32 s15, 0
    s_cbranch_scc1 fa_epi
    v_mov_b32 v218, 131072
    ds_read_b32 v219, v218
    s_waitcnt lgkmcnt(0)
    v_readfirstlane_b32 s17, v219
    s_cmp_eq_u32 s17, 0
    s_cbranch_scc1 fa_epi
    s_mov_b32 s15, 1
    v_mov_b32 v220, 0xff7fffff
    v_mov_b32 v222, 0xff7fffff
    s_sub_u32 s17, s8, 2
    s_lshl_b32 s17, s17, 6
    v_add_u32 v221, s17, v212
    s_lshl_b32 s18, s37, 20
    s_mov_b32 s14, s8
fa_mx:
    s_add_u32 s19, s18, 0
    buffer_load_dwordx4 v[0:3], v214, s[28:31], s19 offen
    s_add_u32 s19, s18, 1024
    buffer_load_dwordx4 v[4:7], v214, s[28:31], s19 offen
    s_add_u32 s19, s18, 2048
    buffer_load_dwordx4 v[8:11], v214, s[28:31], s19 offen
    s_add_u32 s19, s18, 3072
    buffer_load_dwordx4 v[12:15], v214, s[28:31], s19 offen
    s_add_u32 s19, s18, 4096
    buffer_load_dwordx4 v[16:19], v214, s[28:31], s19 offen
    s_add_u32 s19, s18, 5120
    buffer_load_dwordx4 v[20:23], v214, s[28:31], s19 offen
    s_add_u32 s19, s18, 6144
    buffer_load_dwordx4 v[24:27], v214, s[28:31], s19 offen
    s_add_u32 s19, s18, 7168
    buffer_load_dwordx4 v[28:31], v214, s[28:31], s19 offen
    s_waitcnt vmcnt(0)
    v_mfma_f32_32x32x16_bf16 v[64:79], v[0:3], v[128:131], 0
    v_mfma_f32_32x32x16_bf16 v[64:79], v[4:7], v[132:135], v[64:79]
    v_mfma_f32_32x32x16_bf16 v[64:79], v[8:11], v[136:139], v[64:79]
    v_mfma_f32_32x32x16_bf16 v[64:79], v[12:15], v[140:143], v[64:79]
    v_mfma_f32_32x32x16_bf16 v[64:79], v[16:19], v[144:147], v[64:79]
    v_mfma_f32_32x32x16_bf16 v[64:79], v[20:23], v[148:151], v[64:79]
    v_mfma_f32_32x32x16_bf16 v[64:79], v[24:27], v[152:155], v[64:79]
    v_mfma_f32_32x32x16_bf16 v[64:79], v[28:31], v[156:159], v[64:79]
    s_nop 7
    s_nop 7
    v_cmp_le_i32 vcc, 0, v221
    s_nop 1
    v_cndmask_b32 v64, v222, v64, vcc
    v_max_f32 v220, v220, v64
    v_cmp_le_i32 vcc, 1, v221
    s_nop 1
    v_cndmask_b32 v65, v222, v65, vcc
    v_max_f32 v220, v220, v65
    v_cmp_le_i32 vcc, 2, v221
    s_nop 1
    v_cndmask_b32 v66, v222, v66, vcc
    v_max_f32 v220, v220, v66
    v_cmp_le_i32 vcc, 3, v221
    s_nop 1
    v_cndmask_b32 v67, v222, v67, vcc
    v_max_f32 v220, v220, v67
    v_cmp_le_i32 vcc, 8, v221
    s_nop 1
    v_cndmask_b32 v68, v222, v68, vcc
    v_max_f32 v220, v220, v68
    v_cmp_le_i32 vcc, 9, v221
    s_nop 1
    v_cndmask_b32 v69, v222, v69, vcc
    v_max_f32 v220, v220, v69
    v_cmp_le_i32 vcc, 10, v221
    s_nop 1
    v_cndmask_b32 v70, v222, v70, vcc
    v_max_f32 v220, v220, v70
    v_cmp_le_i32 vcc, 11, v221
    s_nop 1
    v_cndmask_b32 v71, v222, v71, vcc
    v_max_f32 v220, v220, v71
    v_cmp_le_i32 vcc, 16, v221
    s_nop 1
    v_cndmask_b32 v72, v222, v72, vcc
    v_max_f32 v220, v220, v72
    v_cmp_le_i32 vcc, 17, v221
    s_nop 1
    v_cndmask_b32 v73, v222, v73, vcc
    v_max_f32 v220, v220, v73
    v_cmp_le_i32 vcc, 18, v221
    s_nop 1
    v_cndmask_b32 v74, v222, v74, vcc
    v_max_f32 v220, v220, v74
    v_cmp_le_i32 vcc, 19, v221
    s_nop 1
    v_cndmask_b32 v75, v222, v75, vcc
    v_max_f32 v220, v220, v75
    v_cmp_le_i32 vcc, 24, v221
    s_nop 1
    v_cndmask_b32 v76, v222, v76, vcc
    v_max_f32 v220, v220, v76
    v_cmp_le_i32 vcc, 25, v221
    s_nop 1
    v_cndmask_b32 v77, v222, v77, vcc
    v_max_f32 v220, v220, v77
    v_cmp_le_i32 vcc, 26, v221
    s_nop 1
    v_cndmask_b32 v78, v222, v78, vcc
    v_max_f32 v220, v220, v78
    v_cmp_le_i32 vcc, 27, v221
    s_nop 1
    v_cndmask_b32 v79, v222, v79, vcc
    v_max_f32 v220, v220, v79
    s_add_u32 s19, s18, 8192
    buffer_load_dwordx4 v[0:3], v214, s[28:31], s19 offen
    s_add_u32 s19, s18, 9216
    buffer_load_dwordx4 v[4:7], v214, s[28:31], s19 offen
    s_add_u32 s19, s18, 10240
    buffer_load_dwordx4 v[8:11], v214, s[28:31], s19 offen
    s_add_u32 s19, s18, 11264
    buffer_load_dwordx4 v[12:15], v214, s[28:31], s19 offen
    s_add_u32 s19, s18, 12288
    buffer_load_dwordx4 v[16:19], v214, s[28:31], s19 offen
    s_add_u32 s19, s18, 13312
    buffer_load_dwordx4 v[20:23], v214, s[28:31], s19 offen
    s_add_u32 s19, s18, 14336
    buffer_load_dwordx4 v[24:27], v214, s[28:31], s19 offen
    s_add_u32 s19, s18, 15360
    buffer_load_dwordx4 v[28:31], v214, s[28:31], s19 offen
    s_waitcnt vmcnt(0)
    v_mfma_f32_32x32x16_bf16 v[64:79], v[0:3], v[128:131], 0
    v_mfma_f32_32x32x16_bf16 v[64:79], v[4:7], v[132:135], v[64:79]
    v_mfma_f32_32x32x16_bf16 v[64:79], v[8:11], v[136:139], v[64:79]
    v_mfma_f32_32x32x16_bf16 v[64:79], v[12:15], v[140:143], v[64:79]
    v_mfma_f32_32x32x16_bf16 v[64:79], v[16:19], v[144:147], v[64:79]
    v_mfma_f32_32x32x16_bf16 v[64:79], v[20:23], v[148:151], v[64:79]
    v_mfma_f32_32x32x16_bf16 v[64:79], v[24:27], v[152:155], v[64:79]
    v_mfma_f32_32x32x16_bf16 v[64:79], v[28:31], v[156:159], v[64:79]
    s_nop 7
    s_nop 7
    v_cmp_le_i32 vcc, 32, v221
    s_nop 1
    v_cndmask_b32 v64, v222, v64, vcc
    v_max_f32 v220, v220, v64
    v_cmp_le_i32 vcc, 33, v221
    s_nop 1
    v_cndmask_b32 v65, v222, v65, vcc
    v_max_f32 v220, v220, v65
    v_cmp_le_i32 vcc, 34, v221
    s_nop 1
    v_cndmask_b32 v66, v222, v66, vcc
    v_max_f32 v220, v220, v66
    v_cmp_le_i32 vcc, 35, v221
    s_nop 1
    v_cndmask_b32 v67, v222, v67, vcc
    v_max_f32 v220, v220, v67
    v_cmp_le_i32 vcc, 40, v221
    s_nop 1
    v_cndmask_b32 v68, v222, v68, vcc
    v_max_f32 v220, v220, v68
    v_cmp_le_i32 vcc, 41, v221
    s_nop 1
    v_cndmask_b32 v69, v222, v69, vcc
    v_max_f32 v220, v220, v69
    v_cmp_le_i32 vcc, 42, v221
    s_nop 1
    v_cndmask_b32 v70, v222, v70, vcc
    v_max_f32 v220, v220, v70
    v_cmp_le_i32 vcc, 43, v221
    s_nop 1
    v_cndmask_b32 v71, v222, v71, vcc
    v_max_f32 v220, v220, v71
    v_cmp_le_i32 vcc, 48, v221
    s_nop 1
    v_cndmask_b32 v72, v222, v72, vcc
    v_max_f32 v220, v220, v72
    v_cmp_le_i32 vcc, 49, v221
    s_nop 1
    v_cndmask_b32 v73, v222, v73, vcc
    v_max_f32 v220, v220, v73
    v_cmp_le_i32 vcc, 50, v221
    s_nop 1
    v_cndmask_b32 v74, v222, v74, vcc
    v_max_f32 v220, v220, v74
    v_cmp_le_i32 vcc, 51, v221
    s_nop 1
    v_cndmask_b32 v75, v222, v75, vcc
    v_max_f32 v220, v220, v75
    v_cmp_le_i32 vcc, 56, v221
    s_nop 1
    v_cndmask_b32 v76, v222, v76, vcc
    v_max_f32 v220, v220, v76
    v_cmp_le_i32 vcc, 57, v221
    s_nop 1
    v_cndmask_b32 v77, v222, v77, vcc
    v_max_f32 v220, v220, v77
    v_cmp_le_i32 vcc, 58, v221
    s_nop 1
    v_cndmask_b32 v78, v222, v78, vcc
    v_max_f32 v220, v220, v78
    v_cmp_le_i32 vcc, 59, v221
    s_nop 1
    v_cndmask_b32 v79, v222, v79, vcc
    v_max_f32 v220, v220, v79
    v_subrev_u32 v221, 64, v221
    s_add_u32 s18, s18, 32768
    s_sub_u32 s14, s14, 1
    s_cmp_lg_u32 s14, 0
    s_cbranch_scc1 fa_mx
    v_mov_b32 v222, v220
    s_nop 1
    v_permlane32_swap_b32 v220, v222
    s_nop 1
    v_max_f32 v220, v220, v222
    v_sub_f32 v160, 0, v220
    v_sub_f32 v161, 0, v220
    v_sub_f32 v162, 0, v220
    v_sub_f32 v163, 0, v220
    v_sub_f32 v164, 0, v220
    v_sub_f32 v165, 0, v220
    v_sub_f32 v166, 0, v220
    v_sub_f32 v167, 0, v220
    v_sub_f32 v168, 0, v220
    v_sub_f32 v169, 0, v220
    v_sub_f32 v170, 0, v220
    v_sub_f32 v171, 0, v220
    v_sub_f32 v172, 0, v220
    v_sub_f32 v173, 0, v220
    v_sub_f32 v174, 0, v220
    v_sub_f32 v175, 0, v220
    s_branch fa_restart
fa_epi:
    v_add_u32 v222, 131328, v214
    ds_read_b128 v[64:67], v222
    ds_read_b128 v[68:71], v222 offset:1024
    s_waitcnt lgkmcnt(0)
    v_mfma_f32_32x32x16_bf16 v[80:95], v[64:67], v[242:245], 0
    v_mfma_f32_32x32x16_bf16 v[80:95], v[68:71], v[246:249], v[80:95]
    s_cmp_lg_u32 s10, 0
    s_cbranch_scc1 fa_afin
    v_rcp_f32 v210, v210
    v_sub_f32 v218, 1.0, v215
    v_mul_f32 v210, v210, v218
    s_mul_i32 s17, s47, 294912
    s_lshl_b32 s18, s37, 13
    s_add_u32 s17, s17, s18
    s_add_u32 s17, s17, 50331648
    v_mul_f32 v0, v210, v0
    v_mul_f32 v1, v210, v1
    v_mul_f32 v2, v210, v2
    v_mul_f32 v3, v210, v3
    v_mul_f32 v4, v210, v4
    v_mul_f32 v5, v210, v5
    v_mul_f32 v6, v210, v6
    v_mul_f32 v7, v210, v7
    v_mul_f32 v8, v210, v8
    v_mul_f32 v9, v210, v9
    v_mul_f32 v10, v210, v10
    v_mul_f32 v11, v210, v11
    v_mul_f32 v12, v210, v12
    v_mul_f32 v13, v210, v13
    v_mul_f32 v14, v210, v14
    v_mul_f32 v15, v210, v15
    v_cvt_pk_bf16_f32 v0, v0, v1
    v_cvt_pk_bf16_f32 v1, v2, v3
    v_cvt_pk_bf16_f32 v2, v4, v5
    v_cvt_pk_bf16_f32 v3, v6, v7
    v_cvt_pk_bf16_f32 v8, v8, v9
    v_cvt_pk_bf16_f32 v9, v10, v11
    v_cvt_pk_bf16_f32 v10, v12, v13
    v_cvt_pk_bf16_f32 v11, v14, v15
    buffer_store_dwordx4 v[0:3], v214, s[28:31], s17 offen offset:0 sc1
    buffer_store_dwordx4 v[8:11], v214, s[28:31], s17 offen offset:1024 sc1
    v_mul_f32 v16, v210, v16
    v_mul_f32 v17, v210, v17
    v_mul_f32 v18, v210, v18
    v_mul_f32 v19, v210, v19
    v_mul_f32 v20, v210, v20
    v_mul_f32 v21, v210, v21
    v_mul_f32 v22, v210, v22
    v_mul_f32 v23, v210, v23
    v_mul_f32 v24, v210, v24
    v_mul_f32 v25, v210, v25
    v_mul_f32 v26, v210, v26
    v_mul_f32 v27, v210, v27
    v_mul_f32 v28, v210, v28
    v_mul_f32 v29, v210, v29
    v_mul_f32 v30, v210, v30
    v_mul_f32 v31, v210, v31
    v_cvt_pk_bf16_f32 v16, v16, v17
    v_cvt_pk_bf16_f32 v17, v18, v19
    v_cvt_pk_bf16_f32 v18, v20, v21
    v_cvt_pk_bf16_f32 v19, v22, v23
    v_cvt_pk_bf16_f32 v24, v24, v25
    v_cvt_pk_bf16_f32 v25, v26, v27
    v_cvt_pk_bf16_f32 v26, v28, v29
    v_cvt_pk_bf16_f32 v27, v30, v31
    buffer_store_dwordx4 v[16:19], v214, s[28:31], s17 offen offset:2048 sc1
    buffer_store_dwordx4 v[24:27], v214, s[28:31], s17 offen offset:3072 sc1
    v_mul_f32 v32, v210, v32
    v_mul_f32 v33, v210, v33
    v_mul_f32 v34, v210, v34
    v_mul_f32 v35, v210, v35
    v_mul_f32 v36, v210, v36
    v_mul_f32 v37, v210, v37
    v_mul_f32 v38, v210, v38
    v_mul_f32 v39, v210, v39
    v_mul_f32 v40, v210, v40
    v_mul_f32 v41, v210, v41
    v_mul_f32 v42, v210, v42
    v_mul_f32 v43, v210, v43
    v_mul_f32 v44, v210, v44
    v_mul_f32 v45, v210, v45
    v_mul_f32 v46, v210, v46
    v_mul_f32 v47, v210, v47
    v_cvt_pk_bf16_f32 v32, v32, v33
    v_cvt_pk_bf16_f32 v33, v34, v35
    v_cvt_pk_bf16_f32 v34, v36, v37
    v_cvt_pk_bf16_f32 v35, v38, v39
    v_cvt_pk_bf16_f32 v40, v40, v41
    v_cvt_pk_bf16_f32 v41, v42, v43
    v_cvt_pk_bf16_f32 v42, v44, v45
    v_cvt_pk_bf16_f32 v43, v46, v47
    s_add_u32 s17, s17, 4096
    buffer_store_dwordx4 v[32:35], v214, s[28:31], s17 offen offset:0 sc1
    buffer_store_dwordx4 v[40:43], v214, s[28:31], s17 offen offset:1024 sc1
    v_mul_f32 v48, v210, v48
    v_mul_f32 v49, v210, v49
    v_mul_f32 v50, v210, v50
    v_mul_f32 v51, v210, v51
    v_mul_f32 v52, v210, v52
    v_mul_f32 v53, v210, v53
    v_mul_f32 v54, v210, v54
    v_mul_f32 v55, v210, v55
    v_mul_f32 v56, v210, v56
    v_mul_f32 v57, v210, v57
    v_mul_f32 v58, v210, v58
    v_mul_f32 v59, v210, v59
    v_mul_f32 v60, v210, v60
    v_mul_f32 v61, v210, v61
    v_mul_f32 v62, v210, v62
    v_mul_f32 v63, v210, v63
    v_cvt_pk_bf16_f32 v48, v48, v49
    v_cvt_pk_bf16_f32 v49, v50, v51
    v_cvt_pk_bf16_f32 v50, v52, v53
    v_cvt_pk_bf16_f32 v51, v54, v55
    v_cvt_pk_bf16_f32 v56, v56, v57
    v_cvt_pk_bf16_f32 v57, v58, v59
    v_cvt_pk_bf16_f32 v58, v60, v61
    v_cvt_pk_bf16_f32 v59, v62, v63
    buffer_store_dwordx4 v[48:51], v214, s[28:31], s17 offen offset:2048 sc1
    buffer_store_dwordx4 v[56:59], v214, s[28:31], s17 offen offset:3072 sc1
fa_afin:
    s_nop 7
    s_nop 7
    v_add_f32 v88, 0x358637bd, v88
    v_rcp_f32 v88, v88
    s_mul_i32 s17, s47, 294912
    v_mul_f32 v88, v215, v88
    s_lshl_b32 s18, s37, 10
    v_mul_f32 v80, v88, v80
    v_mul_f32 v81, v88, v81
    v_mul_f32 v82, v88, v82
    v_mul_f32 v83, v88, v83
    v_mul_f32 v84, v88, v84
    v_mul_f32 v85, v88, v85
    v_mul_f32 v86, v88, v86
    v_mul_f32 v87, v88, v87
    v_cvt_pk_bf16_f32 v80, v80, v81
    v_cvt_pk_bf16_f32 v81, v82, v83
    v_cvt_pk_bf16_f32 v82, v84, v85
    v_cvt_pk_bf16_f32 v83, v86, v87
    s_add_u32 s17, s17, s18
    s_add_u32 s17, s17, 50593792
    buffer_store_dwordx4 v[80:83], v214, s[28:31], s17 offen sc1
    s_waitcnt vmcnt(0)
    s_branch fa_done
fa_side:
    s_bitcmp1_b32 s40, 0
    s_cbranch_scc0 fa_sact
    s_add_u32 s40, s40, 1
    s_branch fa_loop_b
fa_sact:
    s_cmp_eq_u32 s40, 2
    s_cbranch_scc1 fa_s1
    s_cmp_eq_u32 s40, 4
    s_cbranch_scc1 fa_s2
    s_cmp_eq_u32 s40, 6
    s_cbranch_scc1 fa_s3
    s_cmp_eq_u32 s40, 8
    s_cbranch_scc1 fa_s4
    s_cmp_eq_u32 s40, 10
    s_cbranch_scc1 fa_s5
    s_waitcnt vmcnt(0)
    s_add_u32 s40, s44, 0
    s_branch fa_loop_b
fa_s1:
    s_cmp_lg_u32 s36, 0
    s_cbranch_scc1 fa_noat2
    s_lshl_b32 s17, s37, 3
    v_mov_b32 v222, s17
    v_mov_b32 v223, 1
    s_mov_b64 s[64:65], exec
    s_mov_b64 exec, 1
    buffer_atomic_add v223, v222, s[4:7], 0 offen offset:4 sc1
    s_mov_b64 exec, s[64:65]
fa_noat2:
    v_lshrrev_b32 v240, 2, v217
    v_lshlrev_b32 v240, 10, v240
    v_and_b32 v220, 3, v217
    v_lshl_add_u32 v240, v220, 4, v240
    v_bfe_u32 v221, v217, 2, 2
    v_lshrrev_b32 v222, 5, v217
    v_lshl_add_u32 v221, v222, 2, v221
    v_lshlrev_b32 v221, 6, v221
    v_bfe_u32 v222, v217, 4, 1
    v_lshl_add_u32 v221, v222, 5, v221
    v_lshl_add_u32 v221, v220, 3, v221
    s_mul_i32 s99, s11, 5120
    s_add_u32 s99, s99, 133632
    v_add_u32 v241, s99, v221
    s_lshr_b32 s64, s2, 4
    s_and_b32 s65, s2, 15
    s_mul_i32 s65, s65, 18
    s_add_u32 s65, s65, s11
    s_add_u32 s66, s65, 0
    s_cmp_lt_u32 s66, 256
    s_cselect_b32 s32, s56, s58
    s_cselect_b32 s33, s57, s59
    s_cselect_b32 s67, 0, 256
    s_cselect_b32 s34, 8, 1
    s_lshl_b32 s34, s34, 19
    s_and_b32 s33, s33, 0xffff
    s_mov_b32 s35, 0x00020000
    s_sub_u32 s67, s66, s67
    s_lshl_b32 s67, s67, 14
    s_lshl_b32 s68, s64, 6
    s_add_u32 s67, s67, s68
    s_mul_i32 s68, s64, 288
    s_add_u32 s68, s68, s66
    s_lshl_b32 s68, s68, 10
    s_add_u32 s92, s68, 71303168
    s_add_u32 m0, s99, 0
    s_nop 0
    buffer_load_dwordx4 v240, s[32:35], s67 offen lds
    s_add_u32 s66, s65, 4
    s_cmp_lt_u32 s66, 256
    s_cselect_b32 s32, s56, s58
    s_cselect_b32 s33, s57, s59
    s_cselect_b32 s67, 0, 256
    s_cselect_b32 s34, 8, 1
    s_lshl_b32 s34, s34, 19
    s_and_b32 s33, s33, 0xffff
    s_mov_b32 s35, 0x00020000
    s_sub_u32 s67, s66, s67
    s_lshl_b32 s67, s67, 14
    s_lshl_b32 s68, s64, 6
    s_add_u32 s67, s67, s68
    s_mul_i32 s68, s64, 288
    s_add_u32 s68, s68, s66
    s_lshl_b32 s68, s68, 10
    s_add_u32 s93, s68, 71303168
    s_add_u32 m0, s99, 1024
    s_nop 0
    buffer_load_dwordx4 v240, s[32:35], s67 offen lds
    s_add_u32 s66, s65, 8
    s_cmp_lt_u32 s66, 256
    s_cselect_b32 s32, s56, s58
    s_cselect_b32 s33, s57, s59
    s_cselect_b32 s67, 0, 256
    s_cselect_b32 s34, 8, 1
    s_lshl_b32 s34, s34, 19
    s_and_b32 s33, s33, 0xffff
    s_mov_b32 s35, 0x00020000
    s_sub_u32 s67, s66, s67
    s_lshl_b32 s67, s67, 14
    s_lshl_b32 s68, s64, 6
    s_add_u32 s67, s67, s68
    s_mul_i32 s68, s64, 288
    s_add_u32 s68, s68, s66
    s_lshl_b32 s68, s68, 10
    s_add_u32 s94, s68, 71303168
    s_add_u32 m0, s99, 2048
    s_nop 0
    buffer_load_dwordx4 v240, s[32:35], s67 offen lds
    s_add_u32 s66, s65, 12
    s_cmp_lt_u32 s66, 256
    s_cselect_b32 s32, s56, s58
    s_cselect_b32 s33, s57, s59
    s_cselect_b32 s67, 0, 256
    s_cselect_b32 s34, 8, 1
    s_lshl_b32 s34, s34, 19
    s_and_b32 s33, s33, 0xffff
    s_mov_b32 s35, 0x00020000
    s_sub_u32 s67, s66, s67
    s_lshl_b32 s67, s67, 14
    s_lshl_b32 s68, s64, 6
    s_add_u32 s67, s67, s68
    s_mul_i32 s68, s64, 288
    s_add_u32 s68, s68, s66
    s_lshl_b32 s68, s68, 10
    s_add_u32 s95, s68, 71303168
    s_add_u32 m0, s99, 3072
    s_nop 0
    buffer_load_dwordx4 v240, s[32:35], s67 offen lds
    s_add_u32 s66, s65, 16
    s_cmp_lt_u32 s66, 256
    s_cselect_b32 s32, s56, s58
    s_cselect_b32 s33, s57, s59
    s_cselect_b32 s67, 0, 256
    s_cselect_b32 s34, 8, 1
    s_lshl_b32 s34, s34, 19
    s_and_b32 s33, s33, 0xffff
    s_mov_b32 s35, 0x00020000
    s_sub_u32 s67, s66, s67
    s_lshl_b32 s67, s67, 14
    s_lshl_b32 s68, s64, 6
    s_add_u32 s67, s67, s68
    s_mul_i32 s68, s64, 288
    s_add_u32 s68, s68, s66
    s_lshl_b32 s68, s68, 10
    s_add_u32 s96, s68, 71303168
    s_cmp_ge_u32 s11, 2
    s_cselect_b32 s67, 0x40000000, s67
    s_cselect_b32 s96, 0x40000000, s96
    s_add_u32 m0, s99, 4096
    s_nop 0
    buffer_load_dwordx4 v240, s[32:35], s67 offen lds
    s_add_u32 s40, s44, 2
    s_branch fa_loop_b
fa_s2:
    s_waitcnt vmcnt(0)
    ds_read_b64_tr_b16 v[220:221], v241 offset:0
    ds_read_b64_tr_b16 v[222:223], v241 offset:512
    ds_read_b64_tr_b16 v[224:225], v241 offset:1024
    ds_read_b64_tr_b16 v[226:227], v241 offset:1536
    ds_read_b64_tr_b16 v[228:229], v241 offset:2048
    ds_read_b64_tr_b16 v[230:231], v241 offset:2560
    ds_read_b64_tr_b16 v[232:233], v241 offset:3072
    ds_read_b64_tr_b16 v[234:235], v241 offset:3584
    ds_read_b64_tr_b16 v[236:237], v241 offset:4096
    ds_read_b64_tr_b16 v[238:239], v241 offset:4608
    s_waitcnt lgkmcnt(0)
    buffer_store_dwordx4 v[220:223], v214, s[28:31], s92 offen sc1
    buffer_store_dwordx4 v[224:227], v214, s[28:31], s93 offen sc1
    buffer_store_dwordx4 v[228:231], v214, s[28:31], s94 offen sc1
    buffer_store_dwordx4 v[232:235], v214, s[28:31], s95 offen sc1
    buffer_store_dwordx4 v[236:239], v214, s[28:31], s96 offen sc1
    s_lshl_b32 s17, s37, 3
    v_mov_b32 v221, s17
    buffer_load_dword v220, v221, s[4:7], 0 offen offset:4 sc1
    s_add_u32 s40, s44, 4
    s_branch fa_loop_b
fa_s3:
    s_mov_b32 s18, 40000
fa_s1_spin:
    s_waitcnt vmcnt(0)
    v_readfirstlane_b32 s17, v220
    s_cmp_ge_u32 s17, 8
    s_cbranch_scc1 fa_s1_ok
    buffer_load_dword v220, v221, s[4:7], 0 offen offset:4 sc1
    s_sub_u32 s18, s18, 1
    s_cmp_lg_u32 s18, 0
    s_cbranch_scc1 fa_s1_spin
    s_waitcnt vmcnt(0)
fa_s1_ok:
    v_lshlrev_b32 v221, 4, v216
    s_lshl_b32 s17, s37, 15
    s_add_u32 s17, s17, 81788928
    buffer_load_dwordx4 v[222:225], v221, s[28:31], s17 offen sc1
    s_add_u32 s17, s17, 4096
    buffer_load_dwordx4 v[226:229], v221, s[28:31], s17 offen sc1
    s_add_u32 s17, s17, 4096
    buffer_load_dwordx4 v[230:233], v221, s[28:31], s17 offen sc1
    s_add_u32 s17, s17, 4096
    buffer_load_dwordx4 v[234:237], v221, s[28:31], s17 offen sc1
    s_add_u32 s40, s44, 6
    s_branch fa_loop_b
fa_s4:
    s_waitcnt vmcnt(0)
    v_add_f32 v238, v222, v226
    v_add_f32 v230, v230, v234
    v_add_f32 v239, v223, v227
    v_add_f32 v231, v231, v235
    v_add_f32 v240, v224, v228
    v_add_f32 v232, v232, v236
    v_add_f32 v241, v225, v229
    v_add_f32 v233, v233, v237
    v_add_f32 v238, v238, v230
    v_add_f32 v239, v239, v231
    v_add_f32 v240, v240, v232
    v_add_f32 v241, v241, v233
    s_lshl_b32 s17, s37, 15
    s_add_u32 s17, s17, 81805312
    buffer_load_dwordx4 v[222:225], v221, s[28:31], s17 offen sc1
    s_add_u32 s17, s17, 4096
    buffer_load_dwordx4 v[226:229], v221, s[28:31], s17 offen sc1
    s_add_u32 s17, s17, 4096
    buffer_load_dwordx4 v[230:233], v221, s[28:31], s17 offen sc1
    s_add_u32 s17, s17, 4096
    buffer_load_dwordx4 v[234:237], v221, s[28:31], s17 offen sc1
    s_add_u32 s40, s44, 8
    s_branch fa_loop_b
fa_s5:
    s_waitcnt vmcnt(0)
    v_add_f32 v222, v222, v226
    v_add_f32 v230, v230, v234
    v_add_f32 v223, v223, v227
    v_add_f32 v231, v231, v235
    v_add_f32 v224, v224, v228
    v_add_f32 v232, v232, v236
    v_add_f32 v225, v225, v229
    v_add_f32 v233, v233, v237
    v_add_f32 v238, v238, v222
    v_add_f32 v239, v239, v223
    v_add_f32 v240, v240, v224
    v_add_f32 v241, v241, v225
    v_add_f32 v238, v238, v230
    v_add_f32 v239, v239, v231
    v_add_f32 v240, v240, v232
    v_add_f32 v241, v241, v233
    v_cvt_pk_bf16_f32 v238, v238, v239
    v_cvt_pk_bf16_f32 v239, v240, v241
    v_bfe_u32 v222, v216, 1, 1
    v_lshlrev_b32 v222, 10, v222
    v_lshrrev_b32 v223, 2, v216
    v_lshl_add_u32 v222, v223, 4, v222
    v_and_b32 v223, 1, v216
    v_lshl_add_u32 v222, v223, 3, v222
    v_add_u32 v222, 131328, v222
    ds_write_b64 v222, v[238:239]
    s_waitcnt lgkmcnt(0)
    s_add_u32 s40, s44, 10
    s_branch fa_loop_b
fa_bp_e:
    s_waitcnt vmcnt(0)
    s_branch fa_bpr_e
fa_bd_e:
    s_add_u32 s18, s13, 98304
    s_and_b32 s18, s18, 0x1ffff
    s_sub_u32 s17, s12, 16384
    s_min_u32 s17, s17, s42
    s_add_u32 m0, s18, 16384
    s_add_u32 s19, s17, 0
    buffer_load_dwordx4 v214, s[28:31], s19 offen offset:0 lds
    buffer_load_dwordx4 v214, s[28:31], s19 offen offset:1024 lds
    buffer_load_dwordx4 v214, s[28:31], s19 offen offset:2048 lds
    buffer_load_dwordx4 v214, s[28:31], s19 offen offset:3072 lds
    s_min_u32 s17, s12, s41
    s_add_u32 m0, s13, 0
    s_add_u32 s19, s17, 0
    buffer_load_dwordx4 v214, s[28:31], s19 offen offset:0 lds
    buffer_load_dwordx4 v214, s[28:31], s19 offen offset:1024 lds
    buffer_load_dwordx4 v214, s[28:31], s19 offen offset:2048 lds
    buffer_load_dwordx4 v214, s[28:31], s19 offen offset:3072 lds
    s_add_u32 s17, s12, 16384
    s_min_u32 s17, s17, s42
    s_add_u32 m0, s13, 16384
    s_add_u32 s19, s17, 0
    buffer_load_dwordx4 v214, s[28:31], s19 offen offset:0 lds
    buffer_load_dwordx4 v214, s[28:31], s19 offen offset:1024 lds
    buffer_load_dwordx4 v214, s[28:31], s19 offen offset:2048 lds
    buffer_load_dwordx4 v214, s[28:31], s19 offen offset:3072 lds
    s_add_u32 s17, s12, 32768
    s_min_u32 s17, s17, s41
    s_add_u32 m0, s13, 32768
    s_add_u32 s19, s17, 0
    buffer_load_dwordx4 v214, s[28:31], s19 offen offset:0 lds
    buffer_load_dwordx4 v214, s[28:31], s19 offen offset:1024 lds
    buffer_load_dwordx4 v214, s[28:31], s19 offen offset:2048 lds
    buffer_load_dwordx4 v214, s[28:31], s19 offen offset:3072 lds
    s_add_u32 s12, s12, 65536
    s_add_u32 s13, s13, 65536
    s_and_b32 s13, s13, 0x1ffff
    s_branch fa_bdr_e
fa_bp_v2:
    s_waitcnt vmcnt(0)
    s_branch fa_bpr_v2
fa_bd_v2:
    s_add_u32 s18, s13, 98304
    s_and_b32 s18, s18, 0x1ffff
    s_sub_u32 s17, s12, 16384
    s_min_u32 s17, s17, s42
    s_add_u32 m0, s18, 16384
    s_add_u32 s19, s17, 0
    buffer_load_dwordx4 v214, s[28:31], s19 offen offset:0 lds
    buffer_load_dwordx4 v214, s[28:31], s19 offen offset:1024 lds
    buffer_load_dwordx4 v214, s[28:31], s19 offen offset:2048 lds
    buffer_load_dwordx4 v214, s[28:31], s19 offen offset:3072 lds
    s_min_u32 s17, s12, s41
    s_add_u32 m0, s13, 0
    s_add_u32 s19, s17, 0
    buffer_load_dwordx4 v214, s[28:31], s19 offen offset:0 lds
    buffer_load_dwordx4 v214, s[28:31], s19 offen offset:1024 lds
    buffer_load_dwordx4 v214, s[28:31], s19 offen offset:2048 lds
    buffer_load_dwordx4 v214, s[28:31], s19 offen offset:3072 lds
    s_add_u32 s17, s12, 16384
    s_min_u32 s17, s17, s42
    s_add_u32 m0, s13, 16384
    s_add_u32 s19, s17, 0
    buffer_load_dwordx4 v214, s[28:31], s19 offen offset:0 lds
    buffer_load_dwordx4 v214, s[28:31], s19 offen offset:1024 lds
    buffer_load_dwordx4 v214, s[28:31], s19 offen offset:2048 lds
    buffer_load_dwordx4 v214, s[28:31], s19 offen offset:3072 lds
    s_add_u32 s17, s12, 32768
    s_min_u32 s17, s17, s41
    s_add_u32 m0, s13, 32768
    s_add_u32 s19, s17, 0
    buffer_load_dwordx4 v214, s[28:31], s19 offen offset:0 lds
    buffer_load_dwordx4 v214, s[28:31], s19 offen offset:1024 lds
    buffer_load_dwordx4 v214, s[28:31], s19 offen offset:2048 lds
    buffer_load_dwordx4 v214, s[28:31], s19 offen offset:3072 lds
    s_add_u32 s12, s12, 65536
    s_add_u32 s13, s13, 65536
    s_and_b32 s13, s13, 0x1ffff
    s_branch fa_bdr_v2
fa_done:
f_end:
    s_endpgm
.section .rodata,"a"
.p2align 6
.amdhsa_kernel f_kernel
  .amdhsa_next_free_vgpr 256
  .amdhsa_next_free_sgpr 102
  .amdhsa_accum_offset 256
  .amdhsa_group_segment_fixed_size 0
  .amdhsa_kernarg_size 112
  .amdhsa_user_sgpr_count 2
  .amdhsa_user_sgpr_kernarg_segment_ptr 1
  .amdhsa_system_sgpr_workgroup_id_x 1
.end_amdhsa_kernel
.text
.globl k3_kernel
.p2align 8
.type k3_kernel,@function
k3_kernel:
    s_cmp_ge_u32 s2, 256
    s_cbranch_scc1 k3_end
    s_load_dwordx2 s[8:9], s[0:1], 104
    s_load_dwordx2 s[12:13], s[0:1], 88
    v_mov_b32 v193, v0
    v_lshrrev_b32 v1, 6, v0
    v_and_b32 v192, 63, v0
    v_lshlrev_b32 v192, 4, v192
    v_readfirstlane_b32 s16, v1
    s_and_b32 s24, s2, 7
    s_lshr_b32 s25, s2, 3
    s_and_b32 s18, s25, 7
    s_lshr_b32 s25, s25, 3
    s_lshl_b32 s17, s24, 2
    s_add_u32 s17, s17, s25
    s_mul_i32 s24, s16, 36864
    s_mul_i32 s20, s18, 589824
    s_add_u32 s20, s20, s24
    s_add_u32 s20, s20, 71303168
    s_add_u32 s21, s20, 294912
    s_mul_i32 s22, s17, 589824
    s_add_u32 s22, s22, s24
    s_add_u32 s22, s22, 50331648
    s_add_u32 s23, s22, 294912
    s_waitcnt lgkmcnt(0)
    s_and_b32 s9, s9, 0xffff
    s_mov_b32 s10, 268435456
    s_mov_b32 s11, 0x00020000
    s_and_b32 s13, s13, 0xffff
    s_mov_b32 s14, 2097152
    s_mov_b32 s15, 0x00020000
    buffer_load_dwordx4 v[64:67], v192, s[8:11], s20 offen offset:0
    buffer_load_dwordx4 v[68:71], v192, s[8:11], s21 offen offset:0
    buffer_load_dwordx4 v[72:75], v192, s[8:11], s22 offen offset:0
    buffer_load_dwordx4 v[76:79], v192, s[8:11], s23 offen offset:0
    buffer_load_dwordx4 v[80:83], v192, s[8:11], s20 offen offset:1024
    buffer_load_dwordx4 v[84:87], v192, s[8:11], s21 offen offset:1024
    buffer_load_dwordx4 v[88:91], v192, s[8:11], s22 offen offset:1024
    buffer_load_dwordx4 v[92:95], v192, s[8:11], s23 offen offset:1024
    buffer_load_dwordx4 v[96:99], v192, s[8:11], s20 offen offset:2048
    buffer_load_dwordx4 v[100:103], v192, s[8:11], s21 offen offset:2048
    buffer_load_dwordx4 v[104:107], v192, s[8:11], s22 offen offset:2048
    buffer_load_dwordx4 v[108:111], v192, s[8:11], s23 offen offset:2048
    buffer_load_dwordx4 v[112:115], v192, s[8:11], s20 offen offset:3072
    buffer_load_dwordx4 v[116:119], v192, s[8:11], s21 offen offset:3072
    buffer_load_dwordx4 v[120:123], v192, s[8:11], s22 offen offset:3072
    buffer_load_dwordx4 v[124:127], v192, s[8:11], s23 offen offset:3072
    s_add_u32 s20, s20, 4096
    s_add_u32 s21, s21, 4096
    s_add_u32 s22, s22, 4096
    s_add_u32 s23, s23, 4096
    buffer_load_dwordx4 v[128:131], v192, s[8:11], s20 offen offset:0
    buffer_load_dwordx4 v[132:135], v192, s[8:11], s21 offen offset:0
    buffer_load_dwordx4 v[136:139], v192, s[8:11], s22 offen offset:0
    buffer_load_dwordx4 v[140:143], v192, s[8:11], s23 offen offset:0
    buffer_load_dwordx4 v[144:147], v192, s[8:11], s20 offen offset:1024
    buffer_load_dwordx4 v[148:151], v192, s[8:11], s21 offen offset:1024
    buffer_load_dwordx4 v[152:155], v192, s[8:11], s22 offen offset:1024
    buffer_load_dwordx4 v[156:159], v192, s[8:11], s23 offen offset:1024
    buffer_load_dwordx4 v[160:163], v192, s[8:11], s20 offen offset:2048
    buffer_load_dwordx4 v[164:167], v192, s[8:11], s21 offen offset:2048
    buffer_load_dwordx4 v[168:171], v192, s[8:11], s22 offen offset:2048
    buffer_load_dwordx4 v[172:175], v192, s[8:11], s23 offen offset:2048
    buffer_load_dwordx4 v[176:179], v192, s[8:11], s20 offen offset:3072
    buffer_load_dwordx4 v[180:183], v192, s[8:11], s21 offen offset:3072
    buffer_load_dwordx4 v[184:187], v192, s[8:11], s22 offen offset:3072
    buffer_load_dwordx4 v[188:191], v192, s[8:11], s23 offen offset:3072
    s_add_u32 s20, s20, 4096
    s_add_u32 s21, s21, 4096
    s_add_u32 s22, s22, 4096
    s_add_u32 s23, s23, 4096
    s_waitcnt vmcnt(28)
    v_mfma_f32_32x32x16_bf16 v[0:15], v[64:67], v[72:75], 0
    v_mfma_f32_32x32x16_bf16 v[16:31], v[64:67], v[76:79], 0
    v_mfma_f32_32x32x16_bf16 v[32:47], v[68:71], v[72:75], 0
    v_mfma_f32_32x32x16_bf16 v[48:63], v[68:71], v[76:79], 0
    buffer_load_dwordx4 v[64:67], v192, s[8:11], s20 offen offset:0
    buffer_load_dwordx4 v[68:71], v192, s[8:11], s21 offen offset:0
    buffer_load_dwordx4 v[72:75], v192, s[8:11], s22 offen offset:0
    buffer_load_dwordx4 v[76:79], v192, s[8:11], s23 offen offset:0
    s_waitcnt vmcnt(28)
    v_mfma_f32_32x32x16_bf16 v[0:15], v[80:83], v[88:91], v[0:15]
    v_mfma_f32_32x32x16_bf16 v[16:31], v[80:83], v[92:95], v[16:31]
    v_mfma_f32_32x32x16_bf16 v[32:47], v[84:87], v[88:91], v[32:47]
    v_mfma_f32_32x32x16_bf16 v[48:63], v[84:87], v[92:95], v[48:63]
    buffer_load_dwordx4 v[80:83], v192, s[8:11], s20 offen offset:1024
    buffer_load_dwordx4 v[84:87], v192, s[8:11], s21 offen offset:1024
    buffer_load_dwordx4 v[88:91], v192, s[8:11], s22 offen offset:1024
    buffer_load_dwordx4 v[92:95], v192, s[8:11], s23 offen offset:1024
    s_waitcnt vmcnt(28)
    v_mfma_f32_32x32x16_bf16 v[0:15], v[96:99], v[104:107], v[0:15]
    v_mfma_f32_32x32x16_bf16 v[16:31], v[96:99], v[108:111], v[16:31]
    v_mfma_f32_32x32x16_bf16 v[32:47], v[100:103], v[104:107], v[32:47]
    v_mfma_f32_32x32x16_bf16 v[48:63], v[100:103], v[108:111], v[48:63]
    buffer_load_dwordx4 v[96:99], v192, s[8:11], s20 offen offset:2048
    buffer_load_dwordx4 v[100:103], v192, s[8:11], s21 offen offset:2048
    buffer_load_dwordx4 v[104:107], v192, s[8:11], s22 offen offset:2048
    buffer_load_dwordx4 v[108:111], v192, s[8:11], s23 offen offset:2048
    s_waitcnt vmcnt(28)
    v_mfma_f32_32x32x16_bf16 v[0:15], v[112:115], v[120:123], v[0:15]
    v_mfma_f32_32x32x16_bf16 v[16:31], v[112:115], v[124:127], v[16:31]
    v_mfma_f32_32x32x16_bf16 v[32:47], v[116:119], v[120:123], v[32:47]
    v_mfma_f32_32x32x16_bf16 v[48:63], v[116:119], v[124:127], v[48:63]
    buffer_load_dwordx4 v[112:115], v192, s[8:11], s20 offen offset:3072
    buffer_load_dwordx4 v[116:119], v192, s[8:11], s21 offen offset:3072
    buffer_load_dwordx4 v[120:123], v192, s[8:11], s22 offen offset:3072
    buffer_load_dwordx4 v[124:127], v192, s[8:11], s23 offen offset:3072
    s_add_u32 s20, s20, 4096
    s_add_u32 s21, s21, 4096
    s_add_u32 s22, s22, 4096
    s_add_u32 s23, s23, 4096
    s_waitcnt vmcnt(28)
    v_mfma_f32_32x32x16_bf16 v[0:15], v[128:131], v[136:139], v[0:15]
    v_mfma_f32_32x32x16_bf16 v[16:31], v[128:131], v[140:143], v[16:31]
    v_mfma_f32_32x32x16_bf16 v[32:47], v[132:135], v[136:139], v[32:47]
    v_mfma_f32_32x32x16_bf16 v[48:63], v[132:135], v[140:143], v[48:63]
    buffer_load_dwordx4 v[128:131], v192, s[8:11], s20 offen offset:0
    buffer_load_dwordx4 v[132:135], v192, s[8:11], s21 offen offset:0
    buffer_load_dwordx4 v[136:139], v192, s[8:11], s22 offen offset:0
    buffer_load_dwordx4 v[140:143], v192, s[8:11], s23 offen offset:0
    s_waitcnt vmcnt(28)
    v_mfma_f32_32x32x16_bf16 v[0:15], v[144:147], v[152:155], v[0:15]
    v_mfma_f32_32x32x16_bf16 v[16:31], v[144:147], v[156:159], v[16:31]
    v_mfma_f32_32x32x16_bf16 v[32:47], v[148:151], v[152:155], v[32:47]
    v_mfma_f32_32x32x16_bf16 v[48:63], v[148:151], v[156:159], v[48:63]
    buffer_load_dwordx4 v[144:147], v192, s[8:11], s20 offen offset:1024
    buffer_load_dwordx4 v[148:151], v192, s[8:11], s21 offen offset:1024
    buffer_load_dwordx4 v[152:155], v192, s[8:11], s22 offen offset:1024
    buffer_load_dwordx4 v[156:159], v192, s[8:11], s23 offen offset:1024
    s_waitcnt vmcnt(28)
    v_mfma_f32_32x32x16_bf16 v[0:15], v[160:163], v[168:171], v[0:15]
    v_mfma_f32_32x32x16_bf16 v[16:31], v[160:163], v[172:175], v[16:31]
    v_mfma_f32_32x32x16_bf16 v[32:47], v[164:167], v[168:171], v[32:47]
    v_mfma_f32_32x32x16_bf16 v[48:63], v[164:167], v[172:175], v[48:63]
    buffer_load_dwordx4 v[160:163], v192, s[8:11], s20 offen offset:2048
    buffer_load_dwordx4 v[164:167], v192, s[8:11], s21 offen offset:2048
    buffer_load_dwordx4 v[168:171], v192, s[8:11], s22 offen offset:2048
    buffer_load_dwordx4 v[172:175], v192, s[8:11], s23 offen offset:2048
    s_waitcnt vmcnt(28)
    v_mfma_f32_32x32x16_bf16 v[0:15], v[176:179], v[184:187], v[0:15]
    v_mfma_f32_32x32x16_bf16 v[16:31], v[176:179], v[188:191], v[16:31]
    v_mfma_f32_32x32x16_bf16 v[32:47], v[180:183], v[184:187], v[32:47]
    v_mfma_f32_32x32x16_bf16 v[48:63], v[180:183], v[188:191], v[48:63]
    buffer_load_dwordx4 v[176:179], v192, s[8:11], s20 offen offset:3072
    buffer_load_dwordx4 v[180:183], v192, s[8:11], s21 offen offset:3072
    buffer_load_dwordx4 v[184:187], v192, s[8:11], s22 offen offset:3072
    buffer_load_dwordx4 v[188:191], v192, s[8:11], s23 offen offset:3072
    s_add_u32 s20, s20, 4096
    s_add_u32 s21, s21, 4096
    s_add_u32 s22, s22, 4096
    s_add_u32 s23, s23, 4096
    s_waitcnt vmcnt(28)
    v_mfma_f32_32x32x16_bf16 v[0:15], v[64:67], v[72:75], v[0:15]
    v_mfma_f32_32x32x16_bf16 v[16:31], v[64:67], v[76:79], v[16:31]
    v_mfma_f32_32x32x16_bf16 v[32:47], v[68:71], v[72:75], v[32:47]
    v_mfma_f32_32x32x16_bf16 v[48:63], v[68:71], v[76:79], v[48:63]
    buffer_load_dwordx4 v[64:67], v192, s[8:11], s20 offen offset:0
    buffer_load_dwordx4 v[68:71], v192, s[8:11], s21 offen offset:0
    buffer_load_dwordx4 v[72:75], v192, s[8:11], s22 offen offset:0
    buffer_load_dwordx4 v[76:79], v192, s[8:11], s23 offen offset:0
    s_waitcnt vmcnt(28)
    v_mfma_f32_32x32x16_bf16 v[0:15], v[80:83], v[88:91], v[0:15]
    v_mfma_f32_32x32x16_bf16 v[16:31], v[80:83], v[92:95], v[16:31]
    v_mfma_f32_32x32x16_bf16 v[32:47], v[84:87], v[88:91], v[32:47]
    v_mfma_f32_32x32x16_bf16 v[48:63], v[84:87], v[92:95], v[48:63]
    buffer_load_dwordx4 v[80:83], v192, s[8:11], s20 offen offset:1024
    buffer_load_dwordx4 v[84:87], v192, s[8:11], s21 offen offset:1024
    buffer_load_dwordx4 v[88:91], v192, s[8:11], s22 offen offset:1024
    buffer_load_dwordx4 v[92:95], v192, s[8:11], s23 offen offset:1024
    s_waitcnt vmcnt(28)
    v_mfma_f32_32x32x16_bf16 v[0:15], v[96:99], v[104:107], v[0:15]
    v_mfma_f32_32x32x16_bf16 v[16:31], v[96:99], v[108:111], v[16:31]
    v_mfma_f32_32x32x16_bf16 v[32:47], v[100:103], v[104:107], v[32:47]
    v_mfma_f32_32x32x16_bf16 v[48:63], v[100:103], v[108:111], v[48:63]
    buffer_load_dwordx4 v[96:99], v192, s[8:11], s20 offen offset:2048
    buffer_load_dwordx4 v[100:103], v192, s[8:11], s21 offen offset:2048
    buffer_load_dwordx4 v[104:107], v192, s[8:11], s22 offen offset:2048
    buffer_load_dwordx4 v[108:111], v192, s[8:11], s23 offen offset:2048
    s_waitcnt vmcnt(28)
    v_mfma_f32_32x32x16_bf16 v[0:15], v[112:115], v[120:123], v[0:15]
    v_mfma_f32_32x32x16_bf16 v[16:31], v[112:115], v[124:127], v[16:31]
    v_mfma_f32_32x32x16_bf16 v[32:47], v[116:119], v[120:123], v[32:47]
    v_mfma_f32_32x32x16_bf16 v[48:63], v[116:119], v[124:127], v[48:63]
    buffer_load_dwordx4 v[112:115], v192, s[8:11], s20 offen offset:3072
    buffer_load_dwordx4 v[116:119], v192, s[8:11], s21 offen offset:3072
    buffer_load_dwordx4 v[120:123], v192, s[8:11], s22 offen offset:3072
    buffer_load_dwordx4 v[124:127], v192, s[8:11], s23 offen offset:3072
    s_add_u32 s20, s20, 4096
    s_add_u32 s21, s21, 4096
    s_add_u32 s22, s22, 4096
    s_add_u32 s23, s23, 4096
    s_waitcnt vmcnt(28)
    v_mfma_f32_32x32x16_bf16 v[0:15], v[128:131], v[136:139], v[0:15]
    v_mfma_f32_32x32x16_bf16 v[16:31], v[128:131], v[140:143], v[16:31]
    v_mfma_f32_32x32x16_bf16 v[32:47], v[132:135], v[136:139], v[32:47]
    v_mfma_f32_32x32x16_bf16 v[48:63], v[132:135], v[140:143], v[48:63]
    buffer_load_dwordx4 v[128:131], v192, s[8:11], s20 offen offset:0
    buffer_load_dwordx4 v[132:135], v192, s[8:11], s21 offen offset:0
    buffer_load_dwordx4 v[136:139], v192, s[8:11], s22 offen offset:0
    buffer_load_dwordx4 v[140:143], v192, s[8:11], s23 offen offset:0
    s_waitcnt vmcnt(28)
    v_mfma_f32_32x32x16_bf16 v[0:15], v[144:147], v[152:155], v[0:15]
    v_mfma_f32_32x32x16_bf16 v[16:31], v[144:147], v[156:159], v[16:31]
    v_mfma_f32_32x32x16_bf16 v[32:47], v[148:151], v[152:155], v[32:47]
    v_mfma_f32_32x32x16_bf16 v[48:63], v[148:151], v[156:159], v[48:63]
    buffer_load_dwordx4 v[144:147], v192, s[8:11], s20 offen offset:1024
    buffer_load_dwordx4 v[148:151], v192, s[8:11], s21 offen offset:1024
    buffer_load_dwordx4 v[152:155], v192, s[8:11], s22 offen offset:1024
    buffer_load_dwordx4 v[156:159], v192, s[8:11], s23 offen offset:1024
    s_waitcnt vmcnt(28)
    v_mfma_f32_32x32x16_bf16 v[0:15], v[160:163], v[168:171], v[0:15]
    v_mfma_f32_32x32x16_bf16 v[16:31], v[160:163], v[172:175], v[16:31]
    v_mfma_f32_32x32x16_bf16 v[32:47], v[164:167], v[168:171], v[32:47]
    v_mfma_f32_32x32x16_bf16 v[48:63], v[164:167], v[172:175], v[48:63]
    buffer_load_dwordx4 v[160:163], v192, s[8:11], s20 offen offset:2048
    buffer_load_dwordx4 v[164:167], v192, s[8:11], s21 offen offset:2048
    buffer_load_dwordx4 v[168:171], v192, s[8:11], s22 offen offset:2048
    buffer_load_dwordx4 v[172:175], v192, s[8:11], s23 offen offset:2048
    s_waitcnt vmcnt(28)
    v_mfma_f32_32x32x16_bf16 v[0:15], v[176:179], v[184:187], v[0:15]
    v_mfma_f32_32x32x16_bf16 v[16:31], v[176:179], v[188:191], v[16:31]
    v_mfma_f32_32x32x16_bf16 v[32:47], v[180:183], v[184:187], v[32:47]
    v_mfma_f32_32x32x16_bf16 v[48:63], v[180:183], v[188:191], v[48:63]
    buffer_load_dwordx4 v[176:179], v192, s[8:11], s20 offen offset:3072
    buffer_load_dwordx4 v[180:183], v192, s[8:11], s21 offen offset:3072
    buffer_load_dwordx4 v[184:187], v192, s[8:11], s22 offen offset:3072
    buffer_load_dwordx4 v[188:191], v192, s[8:11], s23 offen offset:3072
    s_add_u32 s20, s20, 4096
    s_add_u32 s21, s21, 4096
    s_add_u32 s22, s22, 4096
    s_add_u32 s23, s23, 4096
    s_waitcnt vmcnt(28)
    v_mfma_f32_32x32x16_bf16 v[0:15], v[64:67], v[72:75], v[0:15]
    v_mfma_f32_32x32x16_bf16 v[16:31], v[64:67], v[76:79], v[16:31]
    v_mfma_f32_32x32x16_bf16 v[32:47], v[68:71], v[72:75], v[32:47]
    v_mfma_f32_32x32x16_bf16 v[48:63], v[68:71], v[76:79], v[48:63]
    buffer_load_dwordx4 v[64:67], v192, s[8:11], s20 offen offset:0
    buffer_load_dwordx4 v[68:71], v192, s[8:11], s21 offen offset:0
    buffer_load_dwordx4 v[72:75], v192, s[8:11], s22 offen offset:0
    buffer_load_dwordx4 v[76:79], v192, s[8:11], s23 offen offset:0
    s_waitcnt vmcnt(28)
    v_mfma_f32_32x32x16_bf16 v[0:15], v[80:83], v[88:91], v[0:15]
    v_mfma_f32_32x32x16_bf16 v[16:31], v[80:83], v[92:95], v[16:31]
    v_mfma_f32_32x32x16_bf16 v[32:47], v[84:87], v[88:91], v[32:47]
    v_mfma_f32_32x32x16_bf16 v[48:63], v[84:87], v[92:95], v[48:63]
    buffer_load_dwordx4 v[80:83], v192, s[8:11], s20 offen offset:1024
    buffer_load_dwordx4 v[84:87], v192, s[8:11], s21 offen offset:1024
    buffer_load_dwordx4 v[88:91], v192, s[8:11], s22 offen offset:1024
    buffer_load_dwordx4 v[92:95], v192, s[8:11], s23 offen offset:1024
    s_waitcnt vmcnt(28)
    v_mfma_f32_32x32x16_bf16 v[0:15], v[96:99], v[104:107], v[0:15]
    v_mfma_f32_32x32x16_bf16 v[16:31], v[96:99], v[108:111], v[16:31]
    v_mfma_f32_32x32x16_bf16 v[32:47], v[100:103], v[104:107], v[32:47]
    v_mfma_f32_32x32x16_bf16 v[48:63], v[100:103], v[108:111], v[48:63]
    buffer_load_dwordx4 v[96:99], v192, s[8:11], s20 offen offset:2048
    buffer_load_dwordx4 v[100:103], v192, s[8:11], s21 offen offset:2048
    buffer_load_dwordx4 v[104:107], v192, s[8:11], s22 offen offset:2048
    buffer_load_dwordx4 v[108:111], v192, s[8:11], s23 offen offset:2048
    s_waitcnt vmcnt(28)
    v_mfma_f32_32x32x16_bf16 v[0:15], v[112:115], v[120:123], v[0:15]
    v_mfma_f32_32x32x16_bf16 v[16:31], v[112:115], v[124:127], v[16:31]
    v_mfma_f32_32x32x16_bf16 v[32:47], v[116:119], v[120:123], v[32:47]
    v_mfma_f32_32x32x16_bf16 v[48:63], v[116:119], v[124:127], v[48:63]
    buffer_load_dwordx4 v[112:115], v192, s[8:11], s20 offen offset:3072
    buffer_load_dwordx4 v[116:119], v192, s[8:11], s21 offen offset:3072
    buffer_load_dwordx4 v[120:123], v192, s[8:11], s22 offen offset:3072
    buffer_load_dwordx4 v[124:127], v192, s[8:11], s23 offen offset:3072
    s_add_u32 s20, s20, 4096
    s_add_u32 s21, s21, 4096
    s_add_u32 s22, s22, 4096
    s_add_u32 s23, s23, 4096
    s_waitcnt vmcnt(28)
    v_mfma_f32_32x32x16_bf16 v[0:15], v[128:131], v[136:139], v[0:15]
    v_mfma_f32_32x32x16_bf16 v[16:31], v[128:131], v[140:143], v[16:31]
    v_mfma_f32_32x32x16_bf16 v[32:47], v[132:135], v[136:139], v[32:47]
    v_mfma_f32_32x32x16_bf16 v[48:63], v[132:135], v[140:143], v[48:63]
    buffer_load_dwordx4 v[128:131], v192, s[8:11], s20 offen offset:0
    buffer_load_dwordx4 v[132:135], v192, s[8:11], s21 offen offset:0
    buffer_load_dwordx4 v[136:139], v192, s[8:11], s22 offen offset:0
    buffer_load_dwordx4 v[140:143], v192, s[8:11], s23 offen offset:0
    s_waitcnt vmcnt(28)
    v_mfma_f32_32x32x16_bf16 v[0:15], v[144:147], v[152:155], v[0:15]
    v_mfma_f32_32x32x16_bf16 v[16:31], v[144:147], v[156:159], v[16:31]
    v_mfma_f32_32x32x16_bf16 v[32:47], v[148:151], v[152:155], v[32:47]
    v_mfma_f32_32x32x16_bf16 v[48:63], v[148:151], v[156:159], v[48:63]
    buffer_load_dwordx4 v[144:147], v192, s[8:11], s20 offen offset:1024
    buffer_load_dwordx4 v[148:151], v192, s[8:11], s21 offen offset:1024
    buffer_load_dwordx4 v[152:155], v192, s[8:11], s22 offen offset:1024
    buffer_load_dwordx4 v[156:159], v192, s[8:11], s23 offen offset:1024
    s_waitcnt vmcnt(28)
    v_mfma_f32_32x32x16_bf16 v[0:15], v[160:163], v[168:171], v[0:15]
    v_mfma_f32_32x32x16_bf16 v[16:31], v[160:163], v[172:175], v[16:31]
    v_mfma_f32_32x32x16_bf16 v[32:47], v[164:167], v[168:171], v[32:47]
    v_mfma_f32_32x32x16_bf16 v[48:63], v[164:167], v[172:175], v[48:63]
    buffer_load_dwordx4 v[160:163], v192, s[8:11], s20 offen offset:2048
    buffer_load_dwordx4 v[164:167], v192, s[8:11], s21 offen offset:2048
    buffer_load_dwordx4 v[168:171], v192, s[8:11], s22 offen offset:2048
    buffer_load_dwordx4 v[172:175], v192, s[8:11], s23 offen offset:2048
    s_waitcnt vmcnt(28)
    v_mfma_f32_32x32x16_bf16 v[0:15], v[176:179], v[184:187], v[0:15]
    v_mfma_f32_32x32x16_bf16 v[16:31], v[176:179], v[188:191], v[16:31]
    v_mfma_f32_32x32x16_bf16 v[32:47], v[180:183], v[184:187], v[32:47]
    v_mfma_f32_32x32x16_bf16 v[48:63], v[180:183], v[188:191], v[48:63]
    buffer_load_dwordx4 v[176:179], v192, s[8:11], s20 offen offset:3072
    buffer_load_dwordx4 v[180:183], v192, s[8:11], s21 offen offset:3072
    buffer_load_dwordx4 v[184:187], v192, s[8:11], s22 offen offset:3072
    buffer_load_dwordx4 v[188:191], v192, s[8:11], s23 offen offset:3072
    s_add_u32 s20, s20, 4096
    s_add_u32 s21, s21, 4096
    s_add_u32 s22, s22, 4096
    s_add_u32 s23, s23, 4096
    s_waitcnt vmcnt(28)
    v_mfma_f32_32x32x16_bf16 v[0:15], v[64:67], v[72:75], v[0:15]
    v_mfma_f32_32x32x16_bf16 v[16:31], v[64:67], v[76:79], v[16:31]
    v_mfma_f32_32x32x16_bf16 v[32:47], v[68:71], v[72:75], v[32:47]
    v_mfma_f32_32x32x16_bf16 v[48:63], v[68:71], v[76:79], v[48:63]
    buffer_load_dwordx4 v[64:67], v192, s[8:11], s20 offen offset:0
    buffer_load_dwordx4 v[68:71], v192, s[8:11], s21 offen offset:0
    buffer_load_dwordx4 v[72:75], v192, s[8:11], s22 offen offset:0
    buffer_load_dwordx4 v[76:79], v192, s[8:11], s23 offen offset:0
    s_waitcnt vmcnt(28)
    v_mfma_f32_32x32x16_bf16 v[0:15], v[80:83], v[88:91], v[0:15]
    v_mfma_f32_32x32x16_bf16 v[16:31], v[80:83], v[92:95], v[16:31]
    v_mfma_f32_32x32x16_bf16 v[32:47], v[84:87], v[88:91], v[32:47]
    v_mfma_f32_32x32x16_bf16 v[48:63], v[84:87], v[92:95], v[48:63]
    buffer_load_dwordx4 v[80:83], v192, s[8:11], s20 offen offset:1024
    buffer_load_dwordx4 v[84:87], v192, s[8:11], s21 offen offset:1024
    buffer_load_dwordx4 v[88:91], v192, s[8:11], s22 offen offset:1024
    buffer_load_dwordx4 v[92:95], v192, s[8:11], s23 offen offset:1024
    s_waitcnt vmcnt(28)
    v_mfma_f32_32x32x16_bf16 v[0:15], v[96:99], v[104:107], v[0:15]
    v_mfma_f32_32x32x16_bf16 v[16:31], v[96:99], v[108:111], v[16:31]
    v_mfma_f32_32x32x16_bf16 v[32:47], v[100:103], v[104:107], v[32:47]
    v_mfma_f32_32x32x16_bf16 v[48:63], v[100:103], v[108:111], v[48:63]
    buffer_load_dwordx4 v[96:99], v192, s[8:11], s20 offen offset:2048
    buffer_load_dwordx4 v[100:103], v192, s[8:11], s21 offen offset:2048
    buffer_load_dwordx4 v[104:107], v192, s[8:11], s22 offen offset:2048
    buffer_load_dwordx4 v[108:111], v192, s[8:11], s23 offen offset:2048
    s_waitcnt vmcnt(28)
    v_mfma_f32_32x32x16_bf16 v[0:15], v[112:115], v[120:123], v[0:15]
    v_mfma_f32_32x32x16_bf16 v[16:31], v[112:115], v[124:127], v[16:31]
    v_mfma_f32_32x32x16_bf16 v[32:47], v[116:119], v[120:123], v[32:47]
    v_mfma_f32_32x32x16_bf16 v[48:63], v[116:119], v[124:127], v[48:63]
    buffer_load_dwordx4 v[112:115], v192, s[8:11], s20 offen offset:3072
    buffer_load_dwordx4 v[116:119], v192, s[8:11], s21 offen offset:3072
    buffer_load_dwordx4 v[120:123], v192, s[8:11], s22 offen offset:3072
    buffer_load_dwordx4 v[124:127], v192, s[8:11], s23 offen offset:3072
    s_add_u32 s20, s20, 4096
    s_add_u32 s21, s21, 4096
    s_add_u32 s22, s22, 4096
    s_add_u32 s23, s23, 4096
    s_waitcnt vmcnt(28)
    v_mfma_f32_32x32x16_bf16 v[0:15], v[128:131], v[136:139], v[0:15]
    v_mfma_f32_32x32x16_bf16 v[16:31], v[128:131], v[140:143], v[16:31]
    v_mfma_f32_32x32x16_bf16 v[32:47], v[132:135], v[136:139], v[32:47]
    v_mfma_f32_32x32x16_bf16 v[48:63], v[132:135], v[140:143], v[48:63]
    s_waitcnt vmcnt(24)
    v_mfma_f32_32x32x16_bf16 v[0:15], v[144:147], v[152:155], v[0:15]
    v_mfma_f32_32x32x16_bf16 v[16:31], v[144:147], v[156:159], v[16:31]
    v_mfma_f32_32x32x16_bf16 v[32:47], v[148:151], v[152:155], v[32:47]
    v_mfma_f32_32x32x16_bf16 v[48:63], v[148:151], v[156:159], v[48:63]
    s_waitcnt vmcnt(20)
    v_mfma_f32_32x32x16_bf16 v[0:15], v[160:163], v[168:171], v[0:15]
    v_mfma_f32_32x32x16_bf16 v[16:31], v[160:163], v[172:175], v[16:31]
    v_mfma_f32_32x32x16_bf16 v[32:47], v[164:167], v[168:171], v[32:47]
    v_mfma_f32_32x32x16_bf16 v[48:63], v[164:167], v[172:175], v[48:63]
    s_waitcnt vmcnt(16)
    v_mfma_f32_32x32x16_bf16 v[0:15], v[176:179], v[184:187], v[0:15]
    v_mfma_f32_32x32x16_bf16 v[16:31], v[176:179], v[188:191], v[16:31]
    v_mfma_f32_32x32x16_bf16 v[32:47], v[180:183], v[184:187], v[32:47]
    v_mfma_f32_32x32x16_bf16 v[48:63], v[180:183], v[188:191], v[48:63]
    s_waitcnt vmcnt(12)
    v_mfma_f32_32x32x16_bf16 v[0:15], v[64:67], v[72:75], v[0:15]
    v_mfma_f32_32x32x16_bf16 v[16:31], v[64:67], v[76:79], v[16:31]
    v_mfma_f32_32x32x16_bf16 v[32:47], v[68:71], v[72:75], v[32:47]
    v_mfma_f32_32x32x16_bf16 v[48:63], v[68:71], v[76:79], v[48:63]
    s_waitcnt vmcnt(8)
    v_mfma_f32_32x32x16_bf16 v[0:15], v[80:83], v[88:91], v[0:15]
    v_mfma_f32_32x32x16_bf16 v[16:31], v[80:83], v[92:95], v[16:31]
    v_mfma_f32_32x32x16_bf16 v[32:47], v[84:87], v[88:91], v[32:47]
    v_mfma_f32_32x32x16_bf16 v[48:63], v[84:87], v[92:95], v[48:63]
    s_waitcnt vmcnt(4)
    v_mfma_f32_32x32x16_bf16 v[0:15], v[96:99], v[104:107], v[0:15]
    v_mfma_f32_32x32x16_bf16 v[16:31], v[96:99], v[108:111], v[16:31]
    v_mfma_f32_32x32x16_bf16 v[32:47], v[100:103], v[104:107], v[32:47]
    v_mfma_f32_32x32x16_bf16 v[48:63], v[100:103], v[108:111], v[48:63]
    s_waitcnt vmcnt(0)
    v_mfma_f32_32x32x16_bf16 v[0:15], v[112:115], v[120:123], v[0:15]
    v_mfma_f32_32x32x16_bf16 v[16:31], v[112:115], v[124:127], v[16:31]
    v_mfma_f32_32x32x16_bf16 v[32:47], v[116:119], v[120:123], v[32:47]
    v_mfma_f32_32x32x16_bf16 v[48:63], v[116:119], v[124:127], v[48:63]
    s_nop 7
    s_nop 7
    s_lshl_b32 s24, s16, 14
    v_add_u32 v194, s24, v192
    ds_write_b128 v194, v[0:3] offset:0
    ds_write_b128 v194, v[4:7] offset:1024
    ds_write_b128 v194, v[8:11] offset:2048
    ds_write_b128 v194, v[12:15] offset:3072
    ds_write_b128 v194, v[16:19] offset:4096
    ds_write_b128 v194, v[20:23] offset:5120
    ds_write_b128 v194, v[24:27] offset:6144
    ds_write_b128 v194, v[28:31] offset:7168
    ds_write_b128 v194, v[32:35] offset:8192
    ds_write_b128 v194, v[36:39] offset:9216
    ds_write_b128 v194, v[40:43] offset:10240
    ds_write_b128 v194, v[44:47] offset:11264
    ds_write_b128 v194, v[48:51] offset:12288
    ds_write_b128 v194, v[52:55] offset:13312
    ds_write_b128 v194, v[56:59] offset:14336
    ds_write_b128 v194, v[60:63] offset:15360
    s_waitcnt lgkmcnt(0)
    s_barrier
    v_lshrrev_b32 v194, 5, v193
    v_lshlrev_b32 v194, 10, v194
    v_and_b32 v195, 31, v193
    v_lshl_add_u32 v194, v195, 4, v194
    v_add_u32 v196, 0x10000, v194
    ds_read_b128 v[0:3], v194 offset:0
    ds_read_b128 v[4:7], v194 offset:512
    ds_read_b128 v[8:11], v194 offset:16384
    ds_read_b128 v[12:15], v194 offset:16896
    ds_read_b128 v[16:19], v194 offset:32768
    ds_read_b128 v[20:23], v194 offset:33280
    ds_read_b128 v[24:27], v194 offset:49152
    ds_read_b128 v[28:31], v194 offset:49664
    ds_read_b128 v[32:35], v196 offset:0
    ds_read_b128 v[36:39], v196 offset:512
    ds_read_b128 v[40:43], v196 offset:16384
    ds_read_b128 v[44:47], v196 offset:16896
    ds_read_b128 v[48:51], v196 offset:32768
    ds_read_b128 v[52:55], v196 offset:33280
    ds_read_b128 v[56:59], v196 offset:49152
    ds_read_b128 v[60:63], v196 offset:49664
    s_waitcnt lgkmcnt(0)
    v_add_f32 v0, v0, v8
    v_add_f32 v1, v1, v9
    v_add_f32 v2, v2, v10
    v_add_f32 v3, v3, v11
    v_add_f32 v4, v4, v12
    v_add_f32 v5, v5, v13
    v_add_f32 v6, v6, v14
    v_add_f32 v7, v7, v15
    v_add_f32 v0, v0, v16
    v_add_f32 v1, v1, v17
    v_add_f32 v2, v2, v18
    v_add_f32 v3, v3, v19
    v_add_f32 v4, v4, v20
    v_add_f32 v5, v5, v21
    v_add_f32 v6, v6, v22
    v_add_f32 v7, v7, v23
    v_add_f32 v0, v0, v24
    v_add_f32 v1, v1, v25
    v_add_f32 v2, v2, v26
    v_add_f32 v3, v3, v27
    v_add_f32 v4, v4, v28
    v_add_f32 v5, v5, v29
    v_add_f32 v6, v6, v30
    v_add_f32 v7, v7, v31
    v_add_f32 v0, v0, v32
    v_add_f32 v1, v1, v33
    v_add_f32 v2, v2, v34
    v_add_f32 v3, v3, v35
    v_add_f32 v4, v4, v36
    v_add_f32 v5, v5, v37
    v_add_f32 v6, v6, v38
    v_add_f32 v7, v7, v39
    v_add_f32 v0, v0, v40
    v_add_f32 v1, v1, v41
    v_add_f32 v2, v2, v42
    v_add_f32 v3, v3, v43
    v_add_f32 v4, v4, v44
    v_add_f32 v5, v5, v45
    v_add_f32 v6, v6, v46
    v_add_f32 v7, v7, v47
    v_add_f32 v0, v0, v48
    v_add_f32 v1, v1, v49
    v_add_f32 v2, v2, v50
    v_add_f32 v3, v3, v51
    v_add_f32 v4, v4, v52
    v_add_f32 v5, v5, v53
    v_add_f32 v6, v6, v54
    v_add_f32 v7, v7, v55
    v_add_f32 v0, v0, v56
    v_add_f32 v1, v1, v57
    v_add_f32 v2, v2, v58
    v_add_f32 v3, v3, v59
    v_add_f32 v4, v4, v60
    v_add_f32 v5, v5, v61
    v_add_f32 v6, v6, v62
    v_add_f32 v7, v7, v63
    v_cvt_pk_bf16_f32 v0, v0, v1
    v_cvt_pk_bf16_f32 v1, v2, v3
    v_cvt_pk_bf16_f32 v2, v4, v5
    v_cvt_pk_bf16_f32 v3, v6, v7
    v_bfe_u32 v196, v193, 7, 1
    v_lshl_add_u32 v195, v196, 5, v195
    v_lshlrev_b32 v195, 10, v195
    v_lshrrev_b32 v196, 8, v193
    v_lshl_add_u32 v195, v196, 6, v195
    v_bfe_u32 v196, v193, 5, 2
    v_lshl_add_u32 v195, v196, 4, v195
    s_lshl_b32 s24, s17, 16
    s_lshl_b32 s25, s18, 7
    s_add_u32 s24, s24, s25
    buffer_store_dwordx4 v[0:3], v195, s[12:15], s24 offen
    s_waitcnt vmcnt(0)
k3_end:
    s_endpgm
.section .rodata,"a"
.p2align 6
.amdhsa_kernel k3_kernel
  .amdhsa_next_free_vgpr 200
  .amdhsa_next_free_sgpr 102
  .amdhsa_accum_offset 200
  .amdhsa_group_segment_fixed_size 0
  .amdhsa_kernarg_size 112
  .amdhsa_user_sgpr_count 2
  .amdhsa_user_sgpr_kernarg_segment_ptr 1
  .amdhsa_system_sgpr_workgroup_id_x 1
.end_amdhsa_kernel
```
